```python
import torch

def _softmax(x, axis=-1):
    return torch.softmax(x, dim=axis)
def _gelu(x):
    return torch.nn.functional.gelu(x, approximate="tanh")
def _silu(x):
    return torch.nn.functional.silu(x)
def _sigmoid(x):
    return torch.sigmoid(x)
def _layernorm(x, axis=-1, eps=1e-5):
    m = x.mean(dim=axis, keepdim=True)
    v = x.var(dim=axis, keepdim=True, unbiased=False)
    return (x - m) / torch.sqrt(v + eps)
def _scatter_add(tgt, idx, src, axis=0):
    return tgt.clone().index_add_(axis, idx, src)
def _segment_sum(src, seg, n):
    out = torch.zeros((n,) + src.shape[1:], dtype=src.dtype)
    return out.index_add_(0, seg, src)
def _pad(x, pw):
    flat = tuple(v for pair in reversed(pw) for v in pair)
    return torch.nn.functional.pad(x, flat)

kernel_name = 'interleave_layers__mha_block__glu_gated_reglu__prompt'

def setup_inputs():

    _w = (lambda a: (lambda t: t.to(torch.bfloat16) if t.is_floating_point() else t)(torch.as_tensor(a)))
    def _A_setup():
        B, S, D, H = 1, 2048, 640, 32
        return {
            "x": _w((lambda *s: torch.randn(*s, dtype=torch.bfloat16) * 0.05)(B, S, D)),
            "wqkv": _w((lambda *s: torch.randn(*s, dtype=torch.bfloat16) * 0.05)(D, 3 * D)),
            "wo": _w((lambda *s: torch.randn(*s, dtype=torch.bfloat16) * 0.05)(D, D)),
        }
    _A_in = _A_setup()

    def _B_setup():
        B, S, D, F = 1, 2048, 640, 1536
        return {
            "x": _w((lambda *s: torch.randn(*s, dtype=torch.bfloat16) * 0.05)(B, S, D)),
            "W_gate": _w((lambda *s: torch.randn(*s, dtype=torch.bfloat16) * 0.8)(D, F) * (2.0 / D) ** 0.5),
            "W_up": _w((lambda *s: torch.randn(*s, dtype=torch.bfloat16) * 0.8)(D, F) * (2.0 / D) ** 0.5),
            "W_down": _w((lambda *s: torch.randn(*s, dtype=torch.bfloat16) * 0.8)(F, D) * (1.0 / F) ** 0.5),
        }
    _B_in = _B_setup()

    return {
        "A_x": _A_in["x"],
        "A_wqkv": _A_in["wqkv"],
        "A_wo": _A_in["wo"],
        "B_x": _B_in["x"],
        "B_W_gate": _B_in["W_gate"],
        "B_W_up": _B_in["W_up"],
        "B_W_down": _B_in["W_down"],
    }

def reference(A_x, A_wqkv, A_wo, B_x, B_W_gate, B_W_up, B_W_down):
    def _A_ref(x, wqkv, wo):
        B, S, D = x.shape
        H = 32
        Dh = D // H
        qkv = (lambda x, *d: x.permute(*d))((x @ wqkv).reshape(B, S, 3, H, Dh), 2, 0, 3, 1, 4)
        q, k, v = qkv[0], qkv[1], qkv[2]
        scores = torch.einsum("bhqd,bhkd->bhqk", q, k) * (Dh ** -0.5)
        p = _softmax(scores, axis=-1)
        o = torch.einsum("bhqk,bhkd->bhqd", p, v)
        return (lambda x, *d: x.permute(*d))(o, 0, 2, 1, 3).reshape(B, S, D) @ wo

    def _B_ref(x, W_gate, W_up, W_down):
        gate = torch.einsum("bsd,df->bsf", x, W_gate)
        up = torch.einsum("bsd,df->bsf", x, W_up)
        gate = gate * (lambda x, dt: x.to(dt))(gate > 0, gate.dtype)
        h = gate * up
        return torch.einsum("bsf,fd->bsd", h, W_down)

    x = A_x
    x = x + _A_ref(_layernorm(x, axis=-1), A_wqkv, A_wo)
    x = x + _B_ref(_layernorm(x, axis=-1), B_W_gate, B_W_up, B_W_down)
    x = x + _A_ref(_layernorm(x, axis=-1), A_wqkv, A_wo)
    x = x + _B_ref(_layernorm(x, axis=-1), B_W_gate, B_W_up, B_W_down)
    return x
```

```asm
; @launch kernel=qkv0_kernel grid=(256,1,1) block=(512,1,1) lds=131072
; @launch kernel=attn0_kernel grid=(256,1,1) block=(1024,1,1) lds=163840
; @launch kernel=ch0_kernel grid=(256,1,1) block=(512,1,1) lds=163840
; @launch kernel=attn1_kernel grid=(256,1,1) block=(1024,1,1) lds=163840
; @launch kernel=ch1_kernel grid=(256,1,1) block=(512,1,1) lds=163840
.amdgcn_target "amdgcn-amd-amdhsa--gfx950"
.text
.globl qkv0_kernel
.p2align 8
.type qkv0_kernel,@function
qkv0_kernel:
    s_cmp_ge_u32 s2, 256
    s_cbranch_scc1 L_qkv0_kernel_end
    s_load_dwordx4 s[20:23], s[0:1], 0
    s_load_dwordx4 s[24:27], s[0:1], 32
    s_load_dwordx2 s[28:29], s[0:1], 72
    v_lshrrev_b32 v2, 6, v0
    s_and_b32 s30, s2, 7
    s_lshr_b32 s31, s2, 3
    v_and_b32 v1, 63, v0
    v_readfirstlane_b32 s64, v2
    v_and_b32 v2, 3, v2
    s_lshr_b32 s32, s30, 1
    s_lshl_b32 s32, s32, 2
    s_and_b32 s33, s31, 3
    s_mul_i32 s61, s33, 3
    s_add_u32 s32, s32, s33
    s_and_b32 s33, s30, 1
    s_lshl_b32 s33, s33, 3
    s_lshr_b32 s34, s31, 2
    s_add_u32 s33, s33, s34
    s_add_u32 s61, s61, s34
    s_add_u32 s61, s61, s30
    s_cmp_ge_u32 s33, 15
    s_cbranch_scc1 L_qkv0_kernel_spare
    s_and_b32 s35, s64, 3
    s_lshl_b32 s42, s32, 2
    s_add_u32 s42, s42, s35
    s_lshl_b32 s41, s35, 12
    s_add_u32 s41, s41, 16384
    s_cmp_lt_u32 s64, 4
    s_cbranch_scc1 L_qkv0_kernel_cons
    s_mul_i32 s62, s61, 26
    s_lshr_b32 s62, s62, 8
    s_mul_i32 s62, s62, 10
    s_sub_u32 s61, s61, s62
    s_mov_b32 s61, 0
    v_lshrrev_b32 v3, 4, v1
    v_lshl_add_u32 v4, v2, 4, v3
    v_mul_u32_u24 v4, 3840, v4
    v_lshlrev_b32 v3, 2, v3
    v_sub_u32 v3, v1, v3
    v_and_b32 v3, 15, v3
    v_lshl_add_u32 v8, v3, 4, v4
    v_add_u32 v9, 14336, v8
    v_add_u32 v10, 28672, v8
    v_add_u32 v11, 43008, v8
    v_lshrrev_b32 v3, 3, v1
    v_add_u32 v3, 0, v3
    v_lshrrev_b32 v4, 1, v3
    v_xor_b32 v4, v4, v1
    v_and_b32 v4, 7, v4
    v_mul_u32_u24 v3, 1280, v3
    v_lshl_add_u32 v14, v4, 4, v3
    v_lshrrev_b32 v3, 3, v1
    v_add_u32 v3, 8, v3
    v_lshrrev_b32 v4, 1, v3
    v_xor_b32 v4, v4, v1
    v_and_b32 v4, 7, v4
    v_mul_u32_u24 v3, 1280, v3
    v_lshl_add_u32 v15, v4, 4, v3
    v_subrev_u32 v15, 1024, v15
    v_lshrrev_b32 v3, 3, v1
    v_add_u32 v3, 16, v3
    v_lshrrev_b32 v4, 1, v3
    v_xor_b32 v4, v4, v1
    v_and_b32 v4, 7, v4
    v_mul_u32_u24 v3, 1280, v3
    v_lshl_add_u32 v16, v4, 4, v3
    v_subrev_u32 v16, 2048, v16
    v_lshrrev_b32 v3, 3, v1
    v_add_u32 v3, 24, v3
    v_lshrrev_b32 v4, 1, v3
    v_xor_b32 v4, v4, v1
    v_and_b32 v4, 7, v4
    v_mul_u32_u24 v3, 1280, v3
    v_lshl_add_u32 v17, v4, 4, v3
    v_subrev_u32 v17, 3072, v17
    s_mul_i32 s36, s33, 256
    s_mul_i32 s62, s61, 245760
    s_add_u32 s36, s36, s62
    s_mul_i32 s37, s42, 40960
    s_mul_i32 s62, s61, 128
    s_add_u32 s37, s37, s62
    s_mul_i32 s40, s35, 4096
    s_waitcnt lgkmcnt(0)
    s_mov_b32 s4, s20
    s_mov_b32 s5, s21
    s_mov_b32 s6, 0x280000
    s_mov_b32 s7, 0x00020000
    s_mov_b32 s8, s22
    s_mov_b32 s9, s23
    s_mov_b32 s10, 0x258000
    s_mov_b32 s11, 0x00020000
    s_add_u32 m0, s41, 0
    s_nop 0
    buffer_load_dwordx4 v14, s[4:7], s37 offen offset:0 lds
    buffer_load_dwordx4 v15, s[4:7], s37 offen offset:1024 lds
    buffer_load_dwordx4 v16, s[4:7], s37 offen offset:2048 lds
    buffer_load_dwordx4 v17, s[4:7], s37 offen offset:3072 lds
    s_add_u32 m0, s40, 0
    s_nop 0
    buffer_load_dwordx4 v8, s[8:11], s36 offen offset:0 lds
    buffer_load_dwordx4 v9, s[8:11], s36 offen offset:1024 lds
    buffer_load_dwordx4 v10, s[8:11], s36 offen offset:2048 lds
    buffer_load_dwordx4 v11, s[8:11], s36 offen offset:3072 lds
    s_add_u32 s36, s36, 245760
    s_add_u32 s37, s37, 128
    s_add_u32 s61, s61, 1
    s_cmp_eq_u32 s61, 10
    s_cselect_b32 s62, 2457600, 0
    s_cselect_b32 s63, 1280, 0
    s_sub_u32 s36, s36, s62
    s_sub_u32 s37, s37, s63
    s_add_u32 m0, s41, 32768
    s_nop 0
    buffer_load_dwordx4 v14, s[4:7], s37 offen offset:0 lds
    buffer_load_dwordx4 v15, s[4:7], s37 offen offset:1024 lds
    buffer_load_dwordx4 v16, s[4:7], s37 offen offset:2048 lds
    buffer_load_dwordx4 v17, s[4:7], s37 offen offset:3072 lds
    s_add_u32 m0, s40, 32768
    s_nop 0
    buffer_load_dwordx4 v8, s[8:11], s36 offen offset:0 lds
    v_and_b32 v3, 31, v1
    v_lshrrev_b32 v4, 1, v3
    v_and_b32 v4, 7, v4
    v_lshrrev_b32 v5, 5, v1
    v_xor_b32 v4, v4, v5
    v_lshlrev_b32 v4, 4, v4
    v_lshl_add_u32 v4, v3, 7, v4
    v_add_u32 v22, s41, v4
    v_xor_b32 v23, 32, v22
    v_xor_b32 v24, 64, v22
    v_xor_b32 v25, 96, v22
    v_mov_b32 v26, 0
    v_mov_b32 v27, 0
    v_mov_b32 v28, 0
    v_mov_b32 v29, 0
    s_waitcnt vmcnt(5)
    s_barrier
    buffer_load_dwordx4 v9, s[8:11], s36 offen offset:1024 lds
    buffer_load_dwordx4 v10, s[8:11], s36 offen offset:2048 lds
    buffer_load_dwordx4 v11, s[8:11], s36 offen offset:3072 lds
    s_add_u32 s36, s36, 245760
    s_add_u32 s37, s37, 128
    s_add_u32 s61, s61, 1
    s_cmp_eq_u32 s61, 10
    s_cselect_b32 s62, 2457600, 0
    s_cselect_b32 s63, 1280, 0
    s_sub_u32 s36, s36, s62
    s_sub_u32 s37, s37, s63
    s_mov_b32 s65, 0
    s_mov_b32 s66, 0x10000
    s_mov_b32 s67, 8
L_qkv0_kernel_pr_1:
    v_add_u32 v40, s65, v22
    v_add_u32 v41, s65, v23
    v_add_u32 v42, s65, v24
    v_add_u32 v43, s65, v25
    ds_read_b128 v[64:67], v40
    ds_read_b128 v[68:71], v41
    ds_read_b128 v[72:75], v42
    ds_read_b128 v[76:79], v43
    s_add_u32 m0, s41, s66
    s_nop 0
    buffer_load_dwordx4 v14, s[4:7], s37 offen offset:0 lds
    s_waitcnt lgkmcnt(3)
    v_lshlrev_b32 v48, 16, v64
    v_and_b32 v49, 0xffff0000, v64
    v_add_f32 v26, v26, v48
    v_add_f32 v27, v27, v49
    v_fmac_f32 v28, v48, v48
    v_fmac_f32 v29, v49, v49
    v_lshlrev_b32 v50, 16, v65
    v_and_b32 v51, 0xffff0000, v65
    v_add_f32 v26, v26, v50
    v_add_f32 v27, v27, v51
    v_fmac_f32 v28, v50, v50
    v_fmac_f32 v29, v51, v51
    buffer_load_dwordx4 v15, s[4:7], s37 offen offset:1024 lds
    v_lshlrev_b32 v52, 16, v66
    v_and_b32 v53, 0xffff0000, v66
    v_add_f32 v26, v26, v52
    v_add_f32 v27, v27, v53
    v_fmac_f32 v28, v52, v52
    v_fmac_f32 v29, v53, v53
    v_lshlrev_b32 v54, 16, v67
    v_and_b32 v55, 0xffff0000, v67
    v_add_f32 v26, v26, v54
    v_add_f32 v27, v27, v55
    v_fmac_f32 v28, v54, v54
    v_fmac_f32 v29, v55, v55
    buffer_load_dwordx4 v16, s[4:7], s37 offen offset:2048 lds
    s_waitcnt lgkmcnt(2)
    v_lshlrev_b32 v48, 16, v68
    v_and_b32 v49, 0xffff0000, v68
    v_add_f32 v26, v26, v48
    v_add_f32 v27, v27, v49
    v_fmac_f32 v28, v48, v48
    v_fmac_f32 v29, v49, v49
    v_lshlrev_b32 v50, 16, v69
    v_and_b32 v51, 0xffff0000, v69
    v_add_f32 v26, v26, v50
    v_add_f32 v27, v27, v51
    v_fmac_f32 v28, v50, v50
    v_fmac_f32 v29, v51, v51
    buffer_load_dwordx4 v17, s[4:7], s37 offen offset:3072 lds
    v_lshlrev_b32 v52, 16, v70
    v_and_b32 v53, 0xffff0000, v70
    v_add_f32 v26, v26, v52
    v_add_f32 v27, v27, v53
    v_fmac_f32 v28, v52, v52
    v_fmac_f32 v29, v53, v53
    v_lshlrev_b32 v54, 16, v71
    v_and_b32 v55, 0xffff0000, v71
    v_add_f32 v26, v26, v54
    v_add_f32 v27, v27, v55
    v_fmac_f32 v28, v54, v54
    v_fmac_f32 v29, v55, v55
    s_add_u32 m0, s40, s66
    s_nop 0
    buffer_load_dwordx4 v8, s[8:11], s36 offen offset:0 lds
    s_waitcnt lgkmcnt(1)
    v_lshlrev_b32 v48, 16, v72
    v_and_b32 v49, 0xffff0000, v72
    v_add_f32 v26, v26, v48
    v_add_f32 v27, v27, v49
    v_fmac_f32 v28, v48, v48
    v_fmac_f32 v29, v49, v49
    v_lshlrev_b32 v50, 16, v73
    v_and_b32 v51, 0xffff0000, v73
    v_add_f32 v26, v26, v50
    v_add_f32 v27, v27, v51
    v_fmac_f32 v28, v50, v50
    v_fmac_f32 v29, v51, v51
    buffer_load_dwordx4 v9, s[8:11], s36 offen offset:1024 lds
    v_lshlrev_b32 v52, 16, v74
    v_and_b32 v53, 0xffff0000, v74
    v_add_f32 v26, v26, v52
    v_add_f32 v27, v27, v53
    v_fmac_f32 v28, v52, v52
    v_fmac_f32 v29, v53, v53
    v_lshlrev_b32 v54, 16, v75
    v_and_b32 v55, 0xffff0000, v75
    v_add_f32 v26, v26, v54
    v_add_f32 v27, v27, v55
    v_fmac_f32 v28, v54, v54
    v_fmac_f32 v29, v55, v55
    buffer_load_dwordx4 v10, s[8:11], s36 offen offset:2048 lds
    s_waitcnt lgkmcnt(0)
    v_lshlrev_b32 v48, 16, v76
    v_and_b32 v49, 0xffff0000, v76
    v_add_f32 v26, v26, v48
    v_add_f32 v27, v27, v49
    v_fmac_f32 v28, v48, v48
    v_fmac_f32 v29, v49, v49
    v_lshlrev_b32 v50, 16, v77
    v_and_b32 v51, 0xffff0000, v77
    v_add_f32 v26, v26, v50
    v_add_f32 v27, v27, v51
    v_fmac_f32 v28, v50, v50
    v_fmac_f32 v29, v51, v51
    buffer_load_dwordx4 v11, s[8:11], s36 offen offset:3072 lds
    v_lshlrev_b32 v52, 16, v78
    v_and_b32 v53, 0xffff0000, v78
    v_add_f32 v26, v26, v52
    v_add_f32 v27, v27, v53
    v_fmac_f32 v28, v52, v52
    v_fmac_f32 v29, v53, v53
    v_lshlrev_b32 v54, 16, v79
    v_and_b32 v55, 0xffff0000, v79
    v_add_f32 v26, v26, v54
    v_add_f32 v27, v27, v55
    v_fmac_f32 v28, v54, v54
    v_fmac_f32 v29, v55, v55
    s_add_u32 s36, s36, 245760
    s_add_u32 s37, s37, 128
    s_add_u32 s65, s65, 32768
    s_and_b32 s65, s65, 0x1ffff
    s_add_u32 s66, s66, 32768
    s_and_b32 s66, s66, 0x1ffff
    s_waitcnt vmcnt(8)
    s_barrier
    s_sub_u32 s67, s67, 1
    s_cmp_lg_u32 s67, 0
    s_cbranch_scc1 L_qkv0_kernel_pr_1
    s_mov_b32 s67, 2
L_qkv0_kernel_pr_2:
    v_add_u32 v40, s65, v22
    v_add_u32 v41, s65, v23
    v_add_u32 v42, s65, v24
    v_add_u32 v43, s65, v25
    ds_read_b128 v[64:67], v40
    ds_read_b128 v[68:71], v41
    ds_read_b128 v[72:75], v42
    ds_read_b128 v[76:79], v43
    s_waitcnt lgkmcnt(3)
    v_lshlrev_b32 v48, 16, v64
    v_and_b32 v49, 0xffff0000, v64
    v_add_f32 v26, v26, v48
    v_add_f32 v27, v27, v49
    v_fmac_f32 v28, v48, v48
    v_fmac_f32 v29, v49, v49
    v_lshlrev_b32 v50, 16, v65
    v_and_b32 v51, 0xffff0000, v65
    v_add_f32 v26, v26, v50
    v_add_f32 v27, v27, v51
    v_fmac_f32 v28, v50, v50
    v_fmac_f32 v29, v51, v51
    v_lshlrev_b32 v52, 16, v66
    v_and_b32 v53, 0xffff0000, v66
    v_add_f32 v26, v26, v52
    v_add_f32 v27, v27, v53
    v_fmac_f32 v28, v52, v52
    v_fmac_f32 v29, v53, v53
    v_lshlrev_b32 v54, 16, v67
    v_and_b32 v55, 0xffff0000, v67
    v_add_f32 v26, v26, v54
    v_add_f32 v27, v27, v55
    v_fmac_f32 v28, v54, v54
    v_fmac_f32 v29, v55, v55
    s_waitcnt lgkmcnt(2)
    v_lshlrev_b32 v48, 16, v68
    v_and_b32 v49, 0xffff0000, v68
    v_add_f32 v26, v26, v48
    v_add_f32 v27, v27, v49
    v_fmac_f32 v28, v48, v48
    v_fmac_f32 v29, v49, v49
    v_lshlrev_b32 v50, 16, v69
    v_and_b32 v51, 0xffff0000, v69
    v_add_f32 v26, v26, v50
    v_add_f32 v27, v27, v51
    v_fmac_f32 v28, v50, v50
    v_fmac_f32 v29, v51, v51
    v_lshlrev_b32 v52, 16, v70
    v_and_b32 v53, 0xffff0000, v70
    v_add_f32 v26, v26, v52
    v_add_f32 v27, v27, v53
    v_fmac_f32 v28, v52, v52
    v_fmac_f32 v29, v53, v53
    v_lshlrev_b32 v54, 16, v71
    v_and_b32 v55, 0xffff0000, v71
    v_add_f32 v26, v26, v54
    v_add_f32 v27, v27, v55
    v_fmac_f32 v28, v54, v54
    v_fmac_f32 v29, v55, v55
    s_waitcnt lgkmcnt(1)
    v_lshlrev_b32 v48, 16, v72
    v_and_b32 v49, 0xffff0000, v72
    v_add_f32 v26, v26, v48
    v_add_f32 v27, v27, v49
    v_fmac_f32 v28, v48, v48
    v_fmac_f32 v29, v49, v49
    v_lshlrev_b32 v50, 16, v73
    v_and_b32 v51, 0xffff0000, v73
    v_add_f32 v26, v26, v50
    v_add_f32 v27, v27, v51
    v_fmac_f32 v28, v50, v50
    v_fmac_f32 v29, v51, v51
    v_lshlrev_b32 v52, 16, v74
    v_and_b32 v53, 0xffff0000, v74
    v_add_f32 v26, v26, v52
    v_add_f32 v27, v27, v53
    v_fmac_f32 v28, v52, v52
    v_fmac_f32 v29, v53, v53
    v_lshlrev_b32 v54, 16, v75
    v_and_b32 v55, 0xffff0000, v75
    v_add_f32 v26, v26, v54
    v_add_f32 v27, v27, v55
    v_fmac_f32 v28, v54, v54
    v_fmac_f32 v29, v55, v55
    s_waitcnt lgkmcnt(0)
    v_lshlrev_b32 v48, 16, v76
    v_and_b32 v49, 0xffff0000, v76
    v_add_f32 v26, v26, v48
    v_add_f32 v27, v27, v49
    v_fmac_f32 v28, v48, v48
    v_fmac_f32 v29, v49, v49
    v_lshlrev_b32 v50, 16, v77
    v_and_b32 v51, 0xffff0000, v77
    v_add_f32 v26, v26, v50
    v_add_f32 v27, v27, v51
    v_fmac_f32 v28, v50, v50
    v_fmac_f32 v29, v51, v51
    v_lshlrev_b32 v52, 16, v78
    v_and_b32 v53, 0xffff0000, v78
    v_add_f32 v26, v26, v52
    v_add_f32 v27, v27, v53
    v_fmac_f32 v28, v52, v52
    v_fmac_f32 v29, v53, v53
    v_lshlrev_b32 v54, 16, v79
    v_and_b32 v55, 0xffff0000, v79
    v_add_f32 v26, v26, v54
    v_add_f32 v27, v27, v55
    v_fmac_f32 v28, v54, v54
    v_fmac_f32 v29, v55, v55
    s_add_u32 s36, s36, 245760
    s_add_u32 s37, s37, 128
    s_add_u32 s65, s65, 32768
    s_and_b32 s65, s65, 0x1ffff
    s_add_u32 s66, s66, 32768
    s_and_b32 s66, s66, 0x1ffff
    s_waitcnt vmcnt(0)
    s_barrier
    s_sub_u32 s67, s67, 1
    s_cmp_lg_u32 s67, 0
    s_cbranch_scc1 L_qkv0_kernel_pr_2
    v_add_f32 v26, v26, v27
    v_add_f32 v27, v28, v29
    v_lshlrev_b32 v4, 3, v1
    s_lshl_b32 s46, s35, 9
    s_add_u32 s46, s46, 100352
    v_add_u32 v3, s46, v4
    ds_write_b64 v3, v[26:27]
    s_waitcnt lgkmcnt(0)
    s_barrier
    s_endpgm
L_qkv0_kernel_cons:
    s_setprio 3
    v_lshlrev_b32 v14, 4, v1
    s_cmp_lg_u32 s35, 3
    s_cbranch_scc1 L_qkv0_kernel_cpf_3
    s_getpc_b64 s[84:85]
L_qkv0_kernel_cpf_3a:
    s_sub_u32 s84, s84, L_qkv0_kernel_cpf_3a-qkv0_kernel
    s_subb_u32 s85, s85, 0
    s_mov_b32 s86, L_text_end-qkv0_kernel
    s_mov_b32 s87, 0x00020000
    s_lshl_b32 s62, s31, 11
    v_lshlrev_b32 v5, 7, v1
    s_mov_b64 exec, 0xffff
    buffer_load_dword v13, v5, s[84:87], s62 offen
    s_mov_b64 exec, -1
L_qkv0_kernel_cpf_3:
    v_lshrrev_b32 v3, 2, v1
    v_and_b32 v3, 3, v3
    v_and_b32 v4, 3, v1
    v_lshlrev_b32 v4, 3, v4
    v_lshl_add_u32 v4, v3, 6, v4
    v_and_b32 v5, 16, v1
    v_lshl_add_u32 v4, v5, 1, v4
    v_lshl_add_u32 v4, v2, 6, v4
    v_lshlrev_b32 v3, 8, v3
    v_lshrrev_b32 v5, 5, v1
    v_lshl_add_u32 v3, v5, 11, v3
    v_add_u32 v5, 0, v4
    v_and_b32 v5, 255, v5
    v_add_u32 v18, v5, v3
    v_add_u32 v5, 64, v4
    v_and_b32 v5, 255, v5
    v_add_u32 v19, v5, v3
    v_add_u32 v5, 128, v4
    v_and_b32 v5, 255, v5
    v_add_u32 v20, v5, v3
    v_add_u32 v5, 192, v4
    v_and_b32 v5, 255, v5
    v_add_u32 v21, v5, v3
    v_and_b32 v3, 31, v1
    v_lshrrev_b32 v4, 1, v3
    v_and_b32 v4, 7, v4
    v_lshrrev_b32 v5, 5, v1
    v_xor_b32 v4, v4, v5
    v_lshlrev_b32 v4, 4, v4
    v_lshl_add_u32 v4, v3, 7, v4
    v_add_u32 v22, s41, v4
    v_xor_b32 v23, 32, v22
    v_xor_b32 v24, 64, v22
    v_xor_b32 v25, 96, v22
    v_mov_b32 v72, 0
    v_mov_b32 v73, 0
    v_mov_b32 v74, 0
    v_mov_b32 v75, 0
    v_mov_b32 v76, 0
    v_mov_b32 v77, 0
    v_mov_b32 v78, 0
    v_mov_b32 v79, 0
    v_mov_b32 v80, 0
    v_mov_b32 v81, 0
    v_mov_b32 v82, 0
    v_mov_b32 v83, 0
    v_mov_b32 v84, 0
    v_mov_b32 v85, 0
    v_mov_b32 v86, 0
    v_mov_b32 v87, 0
    v_mov_b32 v88, 0
    v_mov_b32 v89, 0
    v_mov_b32 v90, 0
    v_mov_b32 v91, 0
    v_mov_b32 v92, 0
    v_mov_b32 v93, 0
    v_mov_b32 v94, 0
    v_mov_b32 v95, 0
    v_mov_b32 v96, 0
    v_mov_b32 v97, 0
    v_mov_b32 v98, 0
    v_mov_b32 v99, 0
    v_mov_b32 v100, 0
    v_mov_b32 v101, 0
    v_mov_b32 v102, 0
    v_mov_b32 v103, 0
    v_mov_b32 v104, 0
    v_mov_b32 v105, 0
    v_mov_b32 v106, 0
    v_mov_b32 v107, 0
    v_mov_b32 v108, 0
    v_mov_b32 v109, 0
    v_mov_b32 v110, 0
    v_mov_b32 v111, 0
    v_mov_b32 v112, 0
    v_mov_b32 v113, 0
    v_mov_b32 v114, 0
    v_mov_b32 v115, 0
    v_mov_b32 v116, 0
    v_mov_b32 v117, 0
    v_mov_b32 v118, 0
    v_mov_b32 v119, 0
    v_mov_b32 v120, 0
    v_mov_b32 v121, 0
    v_mov_b32 v122, 0
    v_mov_b32 v123, 0
    v_mov_b32 v124, 0
    v_mov_b32 v125, 0
    v_mov_b32 v126, 0
    v_mov_b32 v127, 0
    v_mov_b32 v128, 0
    v_mov_b32 v129, 0
    v_mov_b32 v130, 0
    v_mov_b32 v131, 0
    v_mov_b32 v132, 0
    v_mov_b32 v133, 0
    v_mov_b32 v134, 0
    v_mov_b32 v135, 0
    v_mov_b32 v192, 0
    v_mov_b32 v193, 0
    v_mov_b32 v194, 0
    v_mov_b32 v195, 0
    v_mov_b32 v196, 0
    v_mov_b32 v197, 0
    v_mov_b32 v198, 0
    v_mov_b32 v199, 0
    v_mov_b32 v200, 0
    v_mov_b32 v201, 0
    v_mov_b32 v202, 0
    v_mov_b32 v203, 0
    v_mov_b32 v204, 0
    v_mov_b32 v205, 0
    v_mov_b32 v206, 0
    v_mov_b32 v207, 0
    v_mov_b32 v208, 0x3f803f80
    v_mov_b32 v209, 0x3f803f80
    v_mov_b32 v210, 0x3f803f80
    v_mov_b32 v211, 0x3f803f80
    v_mov_b32 v26, 0
    v_mov_b32 v27, 0
    v_mov_b32 v28, 0
    v_mov_b32 v29, 0
    s_lshr_b32 s62, s31, 2
    s_lshl_b32 s62, s62, 4
    s_and_b32 s63, s35, 1
    s_lshl_b32 s65, s63, 3
    s_add_u32 s62, s62, s65
    v_add_u32 v5, s62, v1
    v_mul_u32_u24 v5, 1280, v5
    s_mul_i32 s66, s32, 163840
    s_lshl_b32 s62, s31, 1
    s_add_u32 s62, s62, s63
    s_mul_i32 s62, s62, 3840
    s_and_b32 s65, s30, 1
    s_lshl_b32 s65, s65, 11
    s_add_u32 s67, s62, s65
    v_lshlrev_b32 v6, 7, v1
    s_mov_b32 s68, 0xff
    s_mov_b32 s69, 0xffff
    s_cmp_lt_u32 s35, 2
    s_cselect_b32 s90, s66, s67
    s_cselect_b32 s88, s68, s69
    s_mov_b32 s89, 0
    s_cselect_b32 s91, 128, 0
    s_cselect_b32 s62, 0, 245760
    s_add_u32 s91, s91, s62
    s_cselect_b64 vcc, -1, 0
    s_cmp_lt_u32 s35, 2
    s_cselect_b64 vcc, -1, 0
    v_cndmask_b32 v12, v6, v5, vcc
    s_waitcnt lgkmcnt(0)
    s_mov_b32 s62, s20
    s_mov_b32 s63, s21
    s_mov_b32 s65, s22
    s_mov_b32 s66, s23
    s_cmp_lt_u32 s35, 2
    s_cselect_b32 s84, s62, s65
    s_cselect_b32 s85, s63, s66
    s_cselect_b32 s86, 0x280000, 0
    s_cselect_b32 s62, 0, 0x258000
    s_add_u32 s86, s86, s62
    s_mov_b32 s87, 0x00020000
    s_lshl_b32 s62, s91, 1
    s_add_u32 s90, s90, s62
    s_mov_b32 s97, 2
    s_add_u32 s52, s28, 0x2080000
    s_addc_u32 s53, s29, 0
    s_mov_b32 s54, 0x5000
    s_mov_b32 s55, 0x00020000
    s_cmp_ge_u32 s33, 10
    s_cbranch_scc1 L_qkv0_kernel_v
    s_cmp_ge_u32 s33, 5
    s_cselect_b32 s47, 5, 0
    s_sub_u32 s47, s33, s47
    s_cmp_ge_u32 s33, 5
    s_cbranch_scc1 L_qkv0_kernel_isk_4
    s_mov_b32 s16, s28
    s_mov_b32 s17, s29
    s_mov_b32 s18, 0x280000
    s_mov_b32 s19, 0x00020000
    v_lshrrev_b32 v5, 5, v1
    v_and_b32 v6, 31, v1
    s_lshl_b32 s46, s47, 5
    s_mul_i32 s48, s42, 1280
    v_lshlrev_b32 v190, 4, v6
    v_lshlrev_b32 v191, 3, v6
    v_sub_u32 v191, 0x800000, v191
    s_add_u32 s49, s35, 0
    s_and_b32 s49, s49, 3
    s_lshl_b32 s49, s49, 3
    s_add_u32 s49, s49, s46
    v_add3_u32 v3, s49, v5, 0
    v_mul_u32_u24 v4, 205, v3
    v_lshrrev_b32 v4, 10, v4
    v_mul_u32_u24 v7, 5, v4
    v_sub_u32 v3, v3, v7
    v_mul_u32_u24 v136, 81920, v4
    v_lshrrev_b32 v7, 1, v3
    v_lshl_add_u32 v136, v7, 9, v136
    v_and_b32 v7, 1, v3
    v_lshl_add_u32 v136, v7, 3, v136
    v_lshrrev_b32 v7, 2, v3
    v_mad_u32_u24 v7, v7, v191, v190
    v_add3_u32 v136, v136, v7, s48
    v_and_b32 v136, 0x7fffff, v136
    v_add3_u32 v3, s49, v5, 2
    v_mul_u32_u24 v4, 205, v3
    v_lshrrev_b32 v4, 10, v4
    v_mul_u32_u24 v7, 5, v4
    v_sub_u32 v3, v3, v7
    v_mul_u32_u24 v137, 81920, v4
    v_lshrrev_b32 v7, 1, v3
    v_lshl_add_u32 v137, v7, 9, v137
    v_and_b32 v7, 1, v3
    v_lshl_add_u32 v137, v7, 3, v137
    v_lshrrev_b32 v7, 2, v3
    v_mad_u32_u24 v7, v7, v191, v190
    v_add3_u32 v137, v137, v7, s48
    v_and_b32 v137, 0x7fffff, v137
    v_add3_u32 v3, s49, v5, 4
    v_mul_u32_u24 v4, 205, v3
    v_lshrrev_b32 v4, 10, v4
    v_mul_u32_u24 v7, 5, v4
    v_sub_u32 v3, v3, v7
    v_mul_u32_u24 v138, 81920, v4
    v_lshrrev_b32 v7, 1, v3
    v_lshl_add_u32 v138, v7, 9, v138
    v_and_b32 v7, 1, v3
    v_lshl_add_u32 v138, v7, 3, v138
    v_lshrrev_b32 v7, 2, v3
    v_mad_u32_u24 v7, v7, v191, v190
    v_add3_u32 v138, v138, v7, s48
    v_and_b32 v138, 0x7fffff, v138
    v_add3_u32 v3, s49, v5, 6
    v_mul_u32_u24 v4, 205, v3
    v_lshrrev_b32 v4, 10, v4
    v_mul_u32_u24 v7, 5, v4
    v_sub_u32 v3, v3, v7
    v_mul_u32_u24 v139, 81920, v4
    v_lshrrev_b32 v7, 1, v3
    v_lshl_add_u32 v139, v7, 9, v139
    v_and_b32 v7, 1, v3
    v_lshl_add_u32 v139, v7, 3, v139
    v_lshrrev_b32 v7, 2, v3
    v_mad_u32_u24 v7, v7, v191, v190
    v_add3_u32 v139, v139, v7, s48
    v_and_b32 v139, 0x7fffff, v139
    s_add_u32 s49, s35, 1
    s_and_b32 s49, s49, 3
    s_lshl_b32 s49, s49, 3
    s_add_u32 s49, s49, s46
    v_add3_u32 v3, s49, v5, 0
    v_mul_u32_u24 v4, 205, v3
    v_lshrrev_b32 v4, 10, v4
    v_mul_u32_u24 v7, 5, v4
    v_sub_u32 v3, v3, v7
    v_mul_u32_u24 v140, 81920, v4
    v_lshrrev_b32 v7, 1, v3
    v_lshl_add_u32 v140, v7, 9, v140
    v_and_b32 v7, 1, v3
    v_lshl_add_u32 v140, v7, 3, v140
    v_lshrrev_b32 v7, 2, v3
    v_mad_u32_u24 v7, v7, v191, v190
    v_add3_u32 v140, v140, v7, s48
    v_and_b32 v140, 0x7fffff, v140
    v_add3_u32 v3, s49, v5, 2
    v_mul_u32_u24 v4, 205, v3
    v_lshrrev_b32 v4, 10, v4
    v_mul_u32_u24 v7, 5, v4
    v_sub_u32 v3, v3, v7
    v_mul_u32_u24 v141, 81920, v4
    v_lshrrev_b32 v7, 1, v3
    v_lshl_add_u32 v141, v7, 9, v141
    v_and_b32 v7, 1, v3
    v_lshl_add_u32 v141, v7, 3, v141
    v_lshrrev_b32 v7, 2, v3
    v_mad_u32_u24 v7, v7, v191, v190
    v_add3_u32 v141, v141, v7, s48
    v_and_b32 v141, 0x7fffff, v141
    v_add3_u32 v3, s49, v5, 4
    v_mul_u32_u24 v4, 205, v3
    v_lshrrev_b32 v4, 10, v4
    v_mul_u32_u24 v7, 5, v4
    v_sub_u32 v3, v3, v7
    v_mul_u32_u24 v142, 81920, v4
    v_lshrrev_b32 v7, 1, v3
    v_lshl_add_u32 v142, v7, 9, v142
    v_and_b32 v7, 1, v3
    v_lshl_add_u32 v142, v7, 3, v142
    v_lshrrev_b32 v7, 2, v3
    v_mad_u32_u24 v7, v7, v191, v190
    v_add3_u32 v142, v142, v7, s48
    v_and_b32 v142, 0x7fffff, v142
    v_add3_u32 v3, s49, v5, 6
    v_mul_u32_u24 v4, 205, v3
    v_lshrrev_b32 v4, 10, v4
    v_mul_u32_u24 v7, 5, v4
    v_sub_u32 v3, v3, v7
    v_mul_u32_u24 v143, 81920, v4
    v_lshrrev_b32 v7, 1, v3
    v_lshl_add_u32 v143, v7, 9, v143
    v_and_b32 v7, 1, v3
    v_lshl_add_u32 v143, v7, 3, v143
    v_lshrrev_b32 v7, 2, v3
    v_mad_u32_u24 v7, v7, v191, v190
    v_add3_u32 v143, v143, v7, s48
    v_and_b32 v143, 0x7fffff, v143
    s_add_u32 s49, s35, 2
    s_and_b32 s49, s49, 3
    s_lshl_b32 s49, s49, 3
    s_add_u32 s49, s49, s46
    v_add3_u32 v3, s49, v5, 0
    v_mul_u32_u24 v4, 205, v3
    v_lshrrev_b32 v4, 10, v4
    v_mul_u32_u24 v7, 5, v4
    v_sub_u32 v3, v3, v7
    v_mul_u32_u24 v144, 81920, v4
    v_lshrrev_b32 v7, 1, v3
    v_lshl_add_u32 v144, v7, 9, v144
    v_and_b32 v7, 1, v3
    v_lshl_add_u32 v144, v7, 3, v144
    v_lshrrev_b32 v7, 2, v3
    v_mad_u32_u24 v7, v7, v191, v190
    v_add3_u32 v144, v144, v7, s48
    v_and_b32 v144, 0x7fffff, v144
    v_add3_u32 v3, s49, v5, 2
    v_mul_u32_u24 v4, 205, v3
    v_lshrrev_b32 v4, 10, v4
    v_mul_u32_u24 v7, 5, v4
    v_sub_u32 v3, v3, v7
    v_mul_u32_u24 v145, 81920, v4
    v_lshrrev_b32 v7, 1, v3
    v_lshl_add_u32 v145, v7, 9, v145
    v_and_b32 v7, 1, v3
    v_lshl_add_u32 v145, v7, 3, v145
    v_lshrrev_b32 v7, 2, v3
    v_mad_u32_u24 v7, v7, v191, v190
    v_add3_u32 v145, v145, v7, s48
    v_and_b32 v145, 0x7fffff, v145
    v_add3_u32 v3, s49, v5, 4
    v_mul_u32_u24 v4, 205, v3
    v_lshrrev_b32 v4, 10, v4
    v_mul_u32_u24 v7, 5, v4
    v_sub_u32 v3, v3, v7
    v_mul_u32_u24 v146, 81920, v4
    v_lshrrev_b32 v7, 1, v3
    v_lshl_add_u32 v146, v7, 9, v146
    v_and_b32 v7, 1, v3
    v_lshl_add_u32 v146, v7, 3, v146
    v_lshrrev_b32 v7, 2, v3
    v_mad_u32_u24 v7, v7, v191, v190
    v_add3_u32 v146, v146, v7, s48
    v_and_b32 v146, 0x7fffff, v146
    v_add3_u32 v3, s49, v5, 6
    v_mul_u32_u24 v4, 205, v3
    v_lshrrev_b32 v4, 10, v4
    v_mul_u32_u24 v7, 5, v4
    v_sub_u32 v3, v3, v7
    v_mul_u32_u24 v147, 81920, v4
    v_lshrrev_b32 v7, 1, v3
    v_lshl_add_u32 v147, v7, 9, v147
    v_and_b32 v7, 1, v3
    v_lshl_add_u32 v147, v7, 3, v147
    v_lshrrev_b32 v7, 2, v3
    v_mad_u32_u24 v7, v7, v191, v190
    v_add3_u32 v147, v147, v7, s48
    v_and_b32 v147, 0x7fffff, v147
    s_add_u32 s49, s35, 3
    s_and_b32 s49, s49, 3
    s_lshl_b32 s49, s49, 3
    s_add_u32 s49, s49, s46
    v_add3_u32 v3, s49, v5, 0
    v_mul_u32_u24 v4, 205, v3
    v_lshrrev_b32 v4, 10, v4
    v_mul_u32_u24 v7, 5, v4
    v_sub_u32 v3, v3, v7
    v_mul_u32_u24 v148, 81920, v4
    v_lshrrev_b32 v7, 1, v3
    v_lshl_add_u32 v148, v7, 9, v148
    v_and_b32 v7, 1, v3
    v_lshl_add_u32 v148, v7, 3, v148
    v_lshrrev_b32 v7, 2, v3
    v_mad_u32_u24 v7, v7, v191, v190
    v_add3_u32 v148, v148, v7, s48
    v_and_b32 v148, 0x7fffff, v148
    v_add3_u32 v3, s49, v5, 2
    v_mul_u32_u24 v4, 205, v3
    v_lshrrev_b32 v4, 10, v4
    v_mul_u32_u24 v7, 5, v4
    v_sub_u32 v3, v3, v7
    v_mul_u32_u24 v149, 81920, v4
    v_lshrrev_b32 v7, 1, v3
    v_lshl_add_u32 v149, v7, 9, v149
    v_and_b32 v7, 1, v3
    v_lshl_add_u32 v149, v7, 3, v149
    v_lshrrev_b32 v7, 2, v3
    v_mad_u32_u24 v7, v7, v191, v190
    v_add3_u32 v149, v149, v7, s48
    v_and_b32 v149, 0x7fffff, v149
    v_add3_u32 v3, s49, v5, 4
    v_mul_u32_u24 v4, 205, v3
    v_lshrrev_b32 v4, 10, v4
    v_mul_u32_u24 v7, 5, v4
    v_sub_u32 v3, v3, v7
    v_mul_u32_u24 v150, 81920, v4
    v_lshrrev_b32 v7, 1, v3
    v_lshl_add_u32 v150, v7, 9, v150
    v_and_b32 v7, 1, v3
    v_lshl_add_u32 v150, v7, 3, v150
    v_lshrrev_b32 v7, 2, v3
    v_mad_u32_u24 v7, v7, v191, v190
    v_add3_u32 v150, v150, v7, s48
    v_and_b32 v150, 0x7fffff, v150
    v_add3_u32 v3, s49, v5, 6
    v_mul_u32_u24 v4, 205, v3
    v_lshrrev_b32 v4, 10, v4
    v_mul_u32_u24 v7, 5, v4
    v_sub_u32 v3, v3, v7
    v_mul_u32_u24 v151, 81920, v4
    v_lshrrev_b32 v7, 1, v3
    v_lshl_add_u32 v151, v7, 9, v151
    v_and_b32 v7, 1, v3
    v_lshl_add_u32 v151, v7, 3, v151
    v_lshrrev_b32 v7, 2, v3
    v_mad_u32_u24 v7, v7, v191, v190
    v_add3_u32 v151, v151, v7, s48
    v_and_b32 v151, 0x7fffff, v151
    s_mov_b32 s51, 0x3ea52b5c
    s_branch L_qkv0_kernel_join_5
L_qkv0_kernel_isk_4:
    s_add_u32 s16, s28, 0x400000
    s_addc_u32 s17, s29, 0
    s_mov_b32 s18, 0x500000
    s_mov_b32 s19, 0x00020000
    v_lshrrev_b32 v5, 5, v1
    v_and_b32 v6, 31, v1
    s_lshl_b32 s46, s47, 5
    s_mul_i32 s48, s42, 2560
    v_lshlrev_b32 v190, 4, v6
    v_lshrrev_b32 v191, 4, v6
    v_mul_u32_u24 v191, 2304, v191
    s_and_b32 s49, s42, 1
    s_mul_i32 s49, s49, 2552
    s_sub_u32 s49, 0x800000, s49
    v_add_u32 v191, s49, v191
    s_add_u32 s49, s35, 0
    s_and_b32 s49, s49, 3
    s_lshl_b32 s49, s49, 3
    s_add_u32 s49, s49, s46
    v_add3_u32 v3, s49, v5, 0
    v_mul_u32_u24 v4, 205, v3
    v_lshrrev_b32 v4, 10, v4
    v_mul_u32_u24 v7, 5, v4
    v_sub_u32 v3, v3, v7
    v_mul_u32_u24 v136, 163840, v4
    v_lshrrev_b32 v7, 1, v3
    v_lshl_add_u32 v136, v7, 9, v136
    v_and_b32 v7, 1, v3
    v_lshl_add_u32 v136, v7, 3, v136
    v_lshrrev_b32 v7, 2, v3
    v_mad_u32_u24 v7, v7, v191, v190
    v_add3_u32 v136, v136, v7, s48
    v_and_b32 v136, 0x7fffff, v136
    v_add3_u32 v3, s49, v5, 2
    v_mul_u32_u24 v4, 205, v3
    v_lshrrev_b32 v4, 10, v4
    v_mul_u32_u24 v7, 5, v4
    v_sub_u32 v3, v3, v7
    v_mul_u32_u24 v137, 163840, v4
    v_lshrrev_b32 v7, 1, v3
    v_lshl_add_u32 v137, v7, 9, v137
    v_and_b32 v7, 1, v3
    v_lshl_add_u32 v137, v7, 3, v137
    v_lshrrev_b32 v7, 2, v3
    v_mad_u32_u24 v7, v7, v191, v190
    v_add3_u32 v137, v137, v7, s48
    v_and_b32 v137, 0x7fffff, v137
    v_add3_u32 v3, s49, v5, 4
    v_mul_u32_u24 v4, 205, v3
    v_lshrrev_b32 v4, 10, v4
    v_mul_u32_u24 v7, 5, v4
    v_sub_u32 v3, v3, v7
    v_mul_u32_u24 v138, 163840, v4
    v_lshrrev_b32 v7, 1, v3
    v_lshl_add_u32 v138, v7, 9, v138
    v_and_b32 v7, 1, v3
    v_lshl_add_u32 v138, v7, 3, v138
    v_lshrrev_b32 v7, 2, v3
    v_mad_u32_u24 v7, v7, v191, v190
    v_add3_u32 v138, v138, v7, s48
    v_and_b32 v138, 0x7fffff, v138
    v_add3_u32 v3, s49, v5, 6
    v_mul_u32_u24 v4, 205, v3
    v_lshrrev_b32 v4, 10, v4
    v_mul_u32_u24 v7, 5, v4
    v_sub_u32 v3, v3, v7
    v_mul_u32_u24 v139, 163840, v4
    v_lshrrev_b32 v7, 1, v3
    v_lshl_add_u32 v139, v7, 9, v139
    v_and_b32 v7, 1, v3
    v_lshl_add_u32 v139, v7, 3, v139
    v_lshrrev_b32 v7, 2, v3
    v_mad_u32_u24 v7, v7, v191, v190
    v_add3_u32 v139, v139, v7, s48
    v_and_b32 v139, 0x7fffff, v139
    s_add_u32 s49, s35, 1
    s_and_b32 s49, s49, 3
    s_lshl_b32 s49, s49, 3
    s_add_u32 s49, s49, s46
    v_add3_u32 v3, s49, v5, 0
    v_mul_u32_u24 v4, 205, v3
    v_lshrrev_b32 v4, 10, v4
    v_mul_u32_u24 v7, 5, v4
    v_sub_u32 v3, v3, v7
    v_mul_u32_u24 v140, 163840, v4
    v_lshrrev_b32 v7, 1, v3
    v_lshl_add_u32 v140, v7, 9, v140
    v_and_b32 v7, 1, v3
    v_lshl_add_u32 v140, v7, 3, v140
    v_lshrrev_b32 v7, 2, v3
    v_mad_u32_u24 v7, v7, v191, v190
    v_add3_u32 v140, v140, v7, s48
    v_and_b32 v140, 0x7fffff, v140
    v_add3_u32 v3, s49, v5, 2
    v_mul_u32_u24 v4, 205, v3
    v_lshrrev_b32 v4, 10, v4
    v_mul_u32_u24 v7, 5, v4
    v_sub_u32 v3, v3, v7
    v_mul_u32_u24 v141, 163840, v4
    v_lshrrev_b32 v7, 1, v3
    v_lshl_add_u32 v141, v7, 9, v141
    v_and_b32 v7, 1, v3
    v_lshl_add_u32 v141, v7, 3, v141
    v_lshrrev_b32 v7, 2, v3
    v_mad_u32_u24 v7, v7, v191, v190
    v_add3_u32 v141, v141, v7, s48
    v_and_b32 v141, 0x7fffff, v141
    v_add3_u32 v3, s49, v5, 4
    v_mul_u32_u24 v4, 205, v3
    v_lshrrev_b32 v4, 10, v4
    v_mul_u32_u24 v7, 5, v4
    v_sub_u32 v3, v3, v7
    v_mul_u32_u24 v142, 163840, v4
    v_lshrrev_b32 v7, 1, v3
    v_lshl_add_u32 v142, v7, 9, v142
    v_and_b32 v7, 1, v3
    v_lshl_add_u32 v142, v7, 3, v142
    v_lshrrev_b32 v7, 2, v3
    v_mad_u32_u24 v7, v7, v191, v190
    v_add3_u32 v142, v142, v7, s48
    v_and_b32 v142, 0x7fffff, v142
    v_add3_u32 v3, s49, v5, 6
    v_mul_u32_u24 v4, 205, v3
    v_lshrrev_b32 v4, 10, v4
    v_mul_u32_u24 v7, 5, v4
    v_sub_u32 v3, v3, v7
    v_mul_u32_u24 v143, 163840, v4
    v_lshrrev_b32 v7, 1, v3
    v_lshl_add_u32 v143, v7, 9, v143
    v_and_b32 v7, 1, v3
    v_lshl_add_u32 v143, v7, 3, v143
    v_lshrrev_b32 v7, 2, v3
    v_mad_u32_u24 v7, v7, v191, v190
    v_add3_u32 v143, v143, v7, s48
    v_and_b32 v143, 0x7fffff, v143
    s_add_u32 s49, s35, 2
    s_and_b32 s49, s49, 3
    s_lshl_b32 s49, s49, 3
    s_add_u32 s49, s49, s46
    v_add3_u32 v3, s49, v5, 0
    v_mul_u32_u24 v4, 205, v3
    v_lshrrev_b32 v4, 10, v4
    v_mul_u32_u24 v7, 5, v4
    v_sub_u32 v3, v3, v7
    v_mul_u32_u24 v144, 163840, v4
    v_lshrrev_b32 v7, 1, v3
    v_lshl_add_u32 v144, v7, 9, v144
    v_and_b32 v7, 1, v3
    v_lshl_add_u32 v144, v7, 3, v144
    v_lshrrev_b32 v7, 2, v3
    v_mad_u32_u24 v7, v7, v191, v190
    v_add3_u32 v144, v144, v7, s48
    v_and_b32 v144, 0x7fffff, v144
    v_add3_u32 v3, s49, v5, 2
    v_mul_u32_u24 v4, 205, v3
    v_lshrrev_b32 v4, 10, v4
    v_mul_u32_u24 v7, 5, v4
    v_sub_u32 v3, v3, v7
    v_mul_u32_u24 v145, 163840, v4
    v_lshrrev_b32 v7, 1, v3
    v_lshl_add_u32 v145, v7, 9, v145
    v_and_b32 v7, 1, v3
    v_lshl_add_u32 v145, v7, 3, v145
    v_lshrrev_b32 v7, 2, v3
    v_mad_u32_u24 v7, v7, v191, v190
    v_add3_u32 v145, v145, v7, s48
    v_and_b32 v145, 0x7fffff, v145
    v_add3_u32 v3, s49, v5, 4
    v_mul_u32_u24 v4, 205, v3
    v_lshrrev_b32 v4, 10, v4
    v_mul_u32_u24 v7, 5, v4
    v_sub_u32 v3, v3, v7
    v_mul_u32_u24 v146, 163840, v4
    v_lshrrev_b32 v7, 1, v3
    v_lshl_add_u32 v146, v7, 9, v146
    v_and_b32 v7, 1, v3
    v_lshl_add_u32 v146, v7, 3, v146
    v_lshrrev_b32 v7, 2, v3
    v_mad_u32_u24 v7, v7, v191, v190
    v_add3_u32 v146, v146, v7, s48
    v_and_b32 v146, 0x7fffff, v146
    v_add3_u32 v3, s49, v5, 6
    v_mul_u32_u24 v4, 205, v3
    v_lshrrev_b32 v4, 10, v4
    v_mul_u32_u24 v7, 5, v4
    v_sub_u32 v3, v3, v7
    v_mul_u32_u24 v147, 163840, v4
    v_lshrrev_b32 v7, 1, v3
    v_lshl_add_u32 v147, v7, 9, v147
    v_and_b32 v7, 1, v3
    v_lshl_add_u32 v147, v7, 3, v147
    v_lshrrev_b32 v7, 2, v3
    v_mad_u32_u24 v7, v7, v191, v190
    v_add3_u32 v147, v147, v7, s48
    v_and_b32 v147, 0x7fffff, v147
    s_add_u32 s49, s35, 3
    s_and_b32 s49, s49, 3
    s_lshl_b32 s49, s49, 3
    s_add_u32 s49, s49, s46
    v_add3_u32 v3, s49, v5, 0
    v_mul_u32_u24 v4, 205, v3
    v_lshrrev_b32 v4, 10, v4
    v_mul_u32_u24 v7, 5, v4
    v_sub_u32 v3, v3, v7
    v_mul_u32_u24 v148, 163840, v4
    v_lshrrev_b32 v7, 1, v3
    v_lshl_add_u32 v148, v7, 9, v148
    v_and_b32 v7, 1, v3
    v_lshl_add_u32 v148, v7, 3, v148
    v_lshrrev_b32 v7, 2, v3
    v_mad_u32_u24 v7, v7, v191, v190
    v_add3_u32 v148, v148, v7, s48
    v_and_b32 v148, 0x7fffff, v148
    v_add3_u32 v3, s49, v5, 2
    v_mul_u32_u24 v4, 205, v3
    v_lshrrev_b32 v4, 10, v4
    v_mul_u32_u24 v7, 5, v4
    v_sub_u32 v3, v3, v7
    v_mul_u32_u24 v149, 163840, v4
    v_lshrrev_b32 v7, 1, v3
    v_lshl_add_u32 v149, v7, 9, v149
    v_and_b32 v7, 1, v3
    v_lshl_add_u32 v149, v7, 3, v149
    v_lshrrev_b32 v7, 2, v3
    v_mad_u32_u24 v7, v7, v191, v190
    v_add3_u32 v149, v149, v7, s48
    v_and_b32 v149, 0x7fffff, v149
    v_add3_u32 v3, s49, v5, 4
    v_mul_u32_u24 v4, 205, v3
    v_lshrrev_b32 v4, 10, v4
    v_mul_u32_u24 v7, 5, v4
    v_sub_u32 v3, v3, v7
    v_mul_u32_u24 v150, 163840, v4
    v_lshrrev_b32 v7, 1, v3
    v_lshl_add_u32 v150, v7, 9, v150
    v_and_b32 v7, 1, v3
    v_lshl_add_u32 v150, v7, 3, v150
    v_lshrrev_b32 v7, 2, v3
    v_mad_u32_u24 v7, v7, v191, v190
    v_add3_u32 v150, v150, v7, s48
    v_and_b32 v150, 0x7fffff, v150
    v_add3_u32 v3, s49, v5, 6
    v_mul_u32_u24 v4, 205, v3
    v_lshrrev_b32 v4, 10, v4
    v_mul_u32_u24 v7, 5, v4
    v_sub_u32 v3, v3, v7
    v_mul_u32_u24 v151, 163840, v4
    v_lshrrev_b32 v7, 1, v3
    v_lshl_add_u32 v151, v7, 9, v151
    v_and_b32 v7, 1, v3
    v_lshl_add_u32 v151, v7, 3, v151
    v_lshrrev_b32 v7, 2, v3
    v_mad_u32_u24 v7, v7, v191, v190
    v_add3_u32 v151, v151, v7, s48
    v_and_b32 v151, 0x7fffff, v151
    s_mov_b32 s51, 1.0
L_qkv0_kernel_join_5:
    s_mov_b32 s44, 0
    s_mov_b32 s50, 10
    s_mov_b32 s60, 32768
    s_barrier
    ds_read_b128 v[32:35], v22
    ds_read_b64_tr_b16 v[40:41], v18 offset:0
    ds_read_b64_tr_b16 v[42:43], v18 offset:1024
    ds_read_b64_tr_b16 v[44:45], v19 offset:0
    ds_read_b64_tr_b16 v[46:47], v19 offset:1024
    ds_read_b64_tr_b16 v[48:49], v20 offset:0
    ds_read_b64_tr_b16 v[50:51], v20 offset:1024
    ds_read_b64_tr_b16 v[52:53], v21 offset:0
    ds_read_b64_tr_b16 v[54:55], v21 offset:1024
L_qkv0_kernel_loop_6:
    s_waitcnt lgkmcnt(6)
    v_mfma_f32_32x32x16_bf16 v[72:87], v[40:43], v[32:35], v[72:87]
    ds_read_b128 v[36:39], v23
    ds_read_b64_tr_b16 v[56:57], v18 offset:4096
    s_waitcnt lgkmcnt(6)
    v_mfma_f32_32x32x16_bf16 v[88:103], v[44:47], v[32:35], v[88:103]
    ds_read_b64_tr_b16 v[58:59], v18 offset:5120
    ds_read_b64_tr_b16 v[60:61], v19 offset:4096
    s_waitcnt lgkmcnt(6)
    v_mfma_f32_32x32x16_bf16 v[104:119], v[48:51], v[32:35], v[104:119]
    ds_read_b64_tr_b16 v[62:63], v19 offset:5120
    ds_read_b64_tr_b16 v[64:65], v20 offset:4096
    s_waitcnt lgkmcnt(6)
    v_mfma_f32_32x32x16_bf16 v[120:135], v[52:55], v[32:35], v[120:135]
    ds_read_b64_tr_b16 v[66:67], v20 offset:5120
    ds_read_b64_tr_b16 v[68:69], v21 offset:4096
    v_mfma_f32_32x32x16_bf16 v[192:207], v[40:43], v[208:211], v[192:207]
    ds_read_b64_tr_b16 v[70:71], v21 offset:5120
    s_waitcnt lgkmcnt(6)
    v_mfma_f32_32x32x16_bf16 v[72:87], v[56:59], v[36:39], v[72:87]
    ds_read_b128 v[32:35], v24
    ds_read_b64_tr_b16 v[40:41], v18 offset:8192
    s_waitcnt lgkmcnt(6)
    v_mfma_f32_32x32x16_bf16 v[88:103], v[60:63], v[36:39], v[88:103]
    ds_read_b64_tr_b16 v[42:43], v18 offset:9216
    ds_read_b64_tr_b16 v[44:45], v19 offset:8192
    s_waitcnt lgkmcnt(6)
    v_mfma_f32_32x32x16_bf16 v[104:119], v[64:67], v[36:39], v[104:119]
    ds_read_b64_tr_b16 v[46:47], v19 offset:9216
    ds_read_b64_tr_b16 v[48:49], v20 offset:8192
    s_waitcnt lgkmcnt(6)
    v_mfma_f32_32x32x16_bf16 v[120:135], v[68:71], v[36:39], v[120:135]
    ds_read_b64_tr_b16 v[50:51], v20 offset:9216
    ds_read_b64_tr_b16 v[52:53], v21 offset:8192
    v_mfma_f32_32x32x16_bf16 v[192:207], v[56:59], v[208:211], v[192:207]
    ds_read_b64_tr_b16 v[54:55], v21 offset:9216
    s_waitcnt lgkmcnt(6)
    v_mfma_f32_32x32x16_bf16 v[72:87], v[40:43], v[32:35], v[72:87]
    s_barrier
    s_add_u32 s44, s44, 32768
    s_cmp_ge_u32 s44, 131072
    s_cselect_b32 s45, 0xfffe8000, s60
    s_cselect_b32 s44, 0, s44
    ds_read_b128 v[36:39], v25
    ds_read_b64_tr_b16 v[56:57], v18 offset:12288
    ds_read_b64_tr_b16 v[58:59], v18 offset:13312
    s_waitcnt lgkmcnt(7)
    v_mfma_f32_32x32x16_bf16 v[88:103], v[44:47], v[32:35], v[88:103]
    ds_read_b64_tr_b16 v[60:61], v19 offset:12288
    ds_read_b64_tr_b16 v[62:63], v19 offset:13312
    ds_read_b64_tr_b16 v[64:65], v20 offset:12288
    ds_read_b64_tr_b16 v[66:67], v20 offset:13312
    s_waitcnt lgkmcnt(9)
    v_mfma_f32_32x32x16_bf16 v[104:119], v[48:51], v[32:35], v[104:119]
    ds_read_b64_tr_b16 v[68:69], v21 offset:12288
    ds_read_b64_tr_b16 v[70:71], v21 offset:13312
    v_add_u32 v22, s45, v22
    s_waitcnt lgkmcnt(9)
    v_mfma_f32_32x32x16_bf16 v[120:135], v[52:55], v[32:35], v[120:135]
    v_add_u32 v23, s45, v23
    v_add_u32 v24, s45, v24
    v_add_u32 v25, s45, v25
    v_add_u32 v18, s45, v18
    v_mfma_f32_32x32x16_bf16 v[192:207], v[40:43], v[208:211], v[192:207]
    v_add_u32 v19, s45, v19
    v_add_u32 v20, s45, v20
    v_add_u32 v21, s45, v21
    s_waitcnt lgkmcnt(6)
    v_mfma_f32_32x32x16_bf16 v[72:87], v[56:59], v[36:39], v[72:87]
    ds_read_b128 v[32:35], v22
    ds_read_b64_tr_b16 v[40:41], v18 offset:0
    s_waitcnt lgkmcnt(6)
    v_mfma_f32_32x32x16_bf16 v[88:103], v[60:63], v[36:39], v[88:103]
    ds_read_b64_tr_b16 v[42:43], v18 offset:1024
    ds_read_b64_tr_b16 v[44:45], v19 offset:0
    s_waitcnt lgkmcnt(6)
    v_mfma_f32_32x32x16_bf16 v[104:119], v[64:67], v[36:39], v[104:119]
    ds_read_b64_tr_b16 v[46:47], v19 offset:1024
    ds_read_b64_tr_b16 v[48:49], v20 offset:0
    s_waitcnt lgkmcnt(6)
    v_mfma_f32_32x32x16_bf16 v[120:135], v[68:71], v[36:39], v[120:135]
    ds_read_b64_tr_b16 v[50:51], v20 offset:1024
    ds_read_b64_tr_b16 v[52:53], v21 offset:0
    v_mfma_f32_32x32x16_bf16 v[192:207], v[56:59], v[208:211], v[192:207]
    ds_read_b64_tr_b16 v[54:55], v21 offset:1024
    s_sub_u32 s50, s50, 1
    s_cmp_lg_u32 s50, 0
    s_cbranch_scc1 L_qkv0_kernel_loop_6
    s_waitcnt  lgkmcnt(0)
    s_nop 7
    v_lshrrev_b32 v4, 5, v1
    v_lshlrev_b32 v4, 4, v4
    s_lshl_b32 s46, s35, 7
    v_add_u32 v3, s46, v4
    v_add_u32 v5, 98304, v3
    v_add_u32 v4, 98304, v4
    s_mov_b32 exec_lo, 1
    s_mov_b32 exec_hi, 1
    ds_write_b128 v5, v[192:195] offset:0
    ds_write_b128 v5, v[196:199] offset:32
    ds_write_b128 v5, v[200:203] offset:64
    ds_write_b128 v5, v[204:207] offset:96
    s_cmp_lg_u32 s32, 0
    s_cbranch_scc1 L_qkv0_kernel_nocs_7
    s_lshl_b32 s46, s33, 9
    buffer_store_dwordx4 v[192:195], v3, s[52:55], s46 offen offset:0 sc1
    buffer_store_dwordx4 v[196:199], v3, s[52:55], s46 offen offset:32 sc1
    buffer_store_dwordx4 v[200:203], v3, s[52:55], s46 offen offset:64 sc1
    buffer_store_dwordx4 v[204:207], v3, s[52:55], s46 offen offset:96 sc1
L_qkv0_kernel_nocs_7:
    s_mov_b64 exec, -1
    s_waitcnt lgkmcnt(0)
    s_barrier
    v_lshlrev_b32 v5, 3, v1
    s_lshl_b32 s46, s35, 9
    s_add_u32 s46, s46, 100352
    v_add_u32 v5, s46, v5
    ds_read_b64 v[30:31], v5
    v_add_f32 v26, v26, v27
    v_add_f32 v28, v28, v29
    v_mov_b32 v6, v4
    s_waitcnt lgkmcnt(0)
    v_add_f32 v26, v26, v30
    v_add_f32 v28, v28, v31
    v_mov_b32 v3, v26
    v_mov_b32 v4, v28
    s_nop 1
    v_permlane32_swap_b32 v26, v3
    v_permlane32_swap_b32 v28, v4
    s_nop 1
    v_add_f32 v26, v26, v3
    v_add_f32 v28, v28, v4
    v_mul_f32 v26, 0x3acccccd, v26
    v_mul_f32 v28, 0x3acccccd, v28
    v_fma_f32 v28, -v26, v26, v28
    v_max_f32 v28, 0, v28
    v_add_f32 v28, 0x3727c5ac, v28
    v_rsq_f32 v30, v28
    s_nop 0
    v_mul_f32 v31, v30, v26
    v_sub_f32 v31, 0, v31
    v_mov_b32 v4, v6
    v_mul_f32 v30, s51, v30
    v_mul_f32 v31, s51, v31
    s_add_u32 s49, s35, 0
    s_and_b32 s49, s49, 3
    s_lshl_b32 s49, s49, 7
    v_add_u32 v3, s49, v4
    ds_read_b128 v[152:155], v3 offset:0
    ds_read_b128 v[156:159], v3 offset:32
    ds_read_b128 v[160:163], v3 offset:64
    ds_read_b128 v[164:167], v3 offset:96
    s_waitcnt lgkmcnt(0)
    v_pk_mul_f32 v[152:153], v[30:31], v[152:153] op_sel:[1,0] op_sel_hi:[1,1]
    v_pk_fma_f32 v[72:73], v[30:31], v[72:73], v[152:153] op_sel_hi:[0,1,1]
    v_pk_mul_f32 v[154:155], v[30:31], v[154:155] op_sel:[1,0] op_sel_hi:[1,1]
    v_pk_fma_f32 v[74:75], v[30:31], v[74:75], v[154:155] op_sel_hi:[0,1,1]
    v_cvt_pk_bf16_f32 v72, v72, v73
    v_cvt_pk_bf16_f32 v73, v74, v75
    buffer_store_dwordx2 v[72:73], v136, s[16:19], 0 offen
    v_pk_mul_f32 v[156:157], v[30:31], v[156:157] op_sel:[1,0] op_sel_hi:[1,1]
    v_pk_fma_f32 v[76:77], v[30:31], v[76:77], v[156:157] op_sel_hi:[0,1,1]
    v_pk_mul_f32 v[158:159], v[30:31], v[158:159] op_sel:[1,0] op_sel_hi:[1,1]
    v_pk_fma_f32 v[78:79], v[30:31], v[78:79], v[158:159] op_sel_hi:[0,1,1]
    v_cvt_pk_bf16_f32 v76, v76, v77
    v_cvt_pk_bf16_f32 v77, v78, v79
    buffer_store_dwordx2 v[76:77], v137, s[16:19], 0 offen
    v_pk_mul_f32 v[160:161], v[30:31], v[160:161] op_sel:[1,0] op_sel_hi:[1,1]
    v_pk_fma_f32 v[80:81], v[30:31], v[80:81], v[160:161] op_sel_hi:[0,1,1]
    v_pk_mul_f32 v[162:163], v[30:31], v[162:163] op_sel:[1,0] op_sel_hi:[1,1]
    v_pk_fma_f32 v[82:83], v[30:31], v[82:83], v[162:163] op_sel_hi:[0,1,1]
    v_cvt_pk_bf16_f32 v80, v80, v81
    v_cvt_pk_bf16_f32 v81, v82, v83
    buffer_store_dwordx2 v[80:81], v138, s[16:19], 0 offen
    v_pk_mul_f32 v[164:165], v[30:31], v[164:165] op_sel:[1,0] op_sel_hi:[1,1]
    v_pk_fma_f32 v[84:85], v[30:31], v[84:85], v[164:165] op_sel_hi:[0,1,1]
    v_pk_mul_f32 v[166:167], v[30:31], v[166:167] op_sel:[1,0] op_sel_hi:[1,1]
    v_pk_fma_f32 v[86:87], v[30:31], v[86:87], v[166:167] op_sel_hi:[0,1,1]
    v_cvt_pk_bf16_f32 v84, v84, v85
    v_cvt_pk_bf16_f32 v85, v86, v87
    buffer_store_dwordx2 v[84:85], v139, s[16:19], 0 offen
    s_add_u32 s49, s35, 1
    s_and_b32 s49, s49, 3
    s_lshl_b32 s49, s49, 7
    v_add_u32 v3, s49, v4
    ds_read_b128 v[168:171], v3 offset:0
    ds_read_b128 v[172:175], v3 offset:32
    ds_read_b128 v[176:179], v3 offset:64
    ds_read_b128 v[180:183], v3 offset:96
    s_waitcnt lgkmcnt(0)
    v_pk_mul_f32 v[168:169], v[30:31], v[168:169] op_sel:[1,0] op_sel_hi:[1,1]
    v_pk_fma_f32 v[88:89], v[30:31], v[88:89], v[168:169] op_sel_hi:[0,1,1]
    v_pk_mul_f32 v[170:171], v[30:31], v[170:171] op_sel:[1,0] op_sel_hi:[1,1]
    v_pk_fma_f32 v[90:91], v[30:31], v[90:91], v[170:171] op_sel_hi:[0,1,1]
    v_cvt_pk_bf16_f32 v88, v88, v89
    v_cvt_pk_bf16_f32 v89, v90, v91
    buffer_store_dwordx2 v[88:89], v140, s[16:19], 0 offen
    v_pk_mul_f32 v[172:173], v[30:31], v[172:173] op_sel:[1,0] op_sel_hi:[1,1]
    v_pk_fma_f32 v[92:93], v[30:31], v[92:93], v[172:173] op_sel_hi:[0,1,1]
    v_pk_mul_f32 v[174:175], v[30:31], v[174:175] op_sel:[1,0] op_sel_hi:[1,1]
    v_pk_fma_f32 v[94:95], v[30:31], v[94:95], v[174:175] op_sel_hi:[0,1,1]
    v_cvt_pk_bf16_f32 v92, v92, v93
    v_cvt_pk_bf16_f32 v93, v94, v95
    buffer_store_dwordx2 v[92:93], v141, s[16:19], 0 offen
    v_pk_mul_f32 v[176:177], v[30:31], v[176:177] op_sel:[1,0] op_sel_hi:[1,1]
    v_pk_fma_f32 v[96:97], v[30:31], v[96:97], v[176:177] op_sel_hi:[0,1,1]
    v_pk_mul_f32 v[178:179], v[30:31], v[178:179] op_sel:[1,0] op_sel_hi:[1,1]
    v_pk_fma_f32 v[98:99], v[30:31], v[98:99], v[178:179] op_sel_hi:[0,1,1]
    v_cvt_pk_bf16_f32 v96, v96, v97
    v_cvt_pk_bf16_f32 v97, v98, v99
    buffer_store_dwordx2 v[96:97], v142, s[16:19], 0 offen
    v_pk_mul_f32 v[180:181], v[30:31], v[180:181] op_sel:[1,0] op_sel_hi:[1,1]
    v_pk_fma_f32 v[100:101], v[30:31], v[100:101], v[180:181] op_sel_hi:[0,1,1]
    v_pk_mul_f32 v[182:183], v[30:31], v[182:183] op_sel:[1,0] op_sel_hi:[1,1]
    v_pk_fma_f32 v[102:103], v[30:31], v[102:103], v[182:183] op_sel_hi:[0,1,1]
    v_cvt_pk_bf16_f32 v100, v100, v101
    v_cvt_pk_bf16_f32 v101, v102, v103
    buffer_store_dwordx2 v[100:101], v143, s[16:19], 0 offen
    s_add_u32 s49, s35, 2
    s_and_b32 s49, s49, 3
    s_lshl_b32 s49, s49, 7
    v_add_u32 v3, s49, v4
    ds_read_b128 v[152:155], v3 offset:0
    ds_read_b128 v[156:159], v3 offset:32
    ds_read_b128 v[160:163], v3 offset:64
    ds_read_b128 v[164:167], v3 offset:96
    s_waitcnt lgkmcnt(0)
    v_pk_mul_f32 v[152:153], v[30:31], v[152:153] op_sel:[1,0] op_sel_hi:[1,1]
    v_pk_fma_f32 v[104:105], v[30:31], v[104:105], v[152:153] op_sel_hi:[0,1,1]
    v_pk_mul_f32 v[154:155], v[30:31], v[154:155] op_sel:[1,0] op_sel_hi:[1,1]
    v_pk_fma_f32 v[106:107], v[30:31], v[106:107], v[154:155] op_sel_hi:[0,1,1]
    v_cvt_pk_bf16_f32 v104, v104, v105
    v_cvt_pk_bf16_f32 v105, v106, v107
    buffer_store_dwordx2 v[104:105], v144, s[16:19], 0 offen
    v_pk_mul_f32 v[156:157], v[30:31], v[156:157] op_sel:[1,0] op_sel_hi:[1,1]
    v_pk_fma_f32 v[108:109], v[30:31], v[108:109], v[156:157] op_sel_hi:[0,1,1]
    v_pk_mul_f32 v[158:159], v[30:31], v[158:159] op_sel:[1,0] op_sel_hi:[1,1]
    v_pk_fma_f32 v[110:111], v[30:31], v[110:111], v[158:159] op_sel_hi:[0,1,1]
    v_cvt_pk_bf16_f32 v108, v108, v109
    v_cvt_pk_bf16_f32 v109, v110, v111
    buffer_store_dwordx2 v[108:109], v145, s[16:19], 0 offen
    v_pk_mul_f32 v[160:161], v[30:31], v[160:161] op_sel:[1,0] op_sel_hi:[1,1]
    v_pk_fma_f32 v[112:113], v[30:31], v[112:113], v[160:161] op_sel_hi:[0,1,1]
    v_pk_mul_f32 v[162:163], v[30:31], v[162:163] op_sel:[1,0] op_sel_hi:[1,1]
    v_pk_fma_f32 v[114:115], v[30:31], v[114:115], v[162:163] op_sel_hi:[0,1,1]
    v_cvt_pk_bf16_f32 v112, v112, v113
    v_cvt_pk_bf16_f32 v113, v114, v115
    buffer_store_dwordx2 v[112:113], v146, s[16:19], 0 offen
    v_pk_mul_f32 v[164:165], v[30:31], v[164:165] op_sel:[1,0] op_sel_hi:[1,1]
    v_pk_fma_f32 v[116:117], v[30:31], v[116:117], v[164:165] op_sel_hi:[0,1,1]
    v_pk_mul_f32 v[166:167], v[30:31], v[166:167] op_sel:[1,0] op_sel_hi:[1,1]
    v_pk_fma_f32 v[118:119], v[30:31], v[118:119], v[166:167] op_sel_hi:[0,1,1]
    v_cvt_pk_bf16_f32 v116, v116, v117
    v_cvt_pk_bf16_f32 v117, v118, v119
    buffer_store_dwordx2 v[116:117], v147, s[16:19], 0 offen
    s_add_u32 s49, s35, 3
    s_and_b32 s49, s49, 3
    s_lshl_b32 s49, s49, 7
    v_add_u32 v3, s49, v4
    ds_read_b128 v[168:171], v3 offset:0
    ds_read_b128 v[172:175], v3 offset:32
    ds_read_b128 v[176:179], v3 offset:64
    ds_read_b128 v[180:183], v3 offset:96
    s_waitcnt lgkmcnt(0)
    v_pk_mul_f32 v[168:169], v[30:31], v[168:169] op_sel:[1,0] op_sel_hi:[1,1]
    v_pk_fma_f32 v[120:121], v[30:31], v[120:121], v[168:169] op_sel_hi:[0,1,1]
    v_pk_mul_f32 v[170:171], v[30:31], v[170:171] op_sel:[1,0] op_sel_hi:[1,1]
    v_pk_fma_f32 v[122:123], v[30:31], v[122:123], v[170:171] op_sel_hi:[0,1,1]
    v_cvt_pk_bf16_f32 v120, v120, v121
    v_cvt_pk_bf16_f32 v121, v122, v123
    buffer_store_dwordx2 v[120:121], v148, s[16:19], 0 offen
    v_pk_mul_f32 v[172:173], v[30:31], v[172:173] op_sel:[1,0] op_sel_hi:[1,1]
    v_pk_fma_f32 v[124:125], v[30:31], v[124:125], v[172:173] op_sel_hi:[0,1,1]
    v_pk_mul_f32 v[174:175], v[30:31], v[174:175] op_sel:[1,0] op_sel_hi:[1,1]
    v_pk_fma_f32 v[126:127], v[30:31], v[126:127], v[174:175] op_sel_hi:[0,1,1]
    v_cvt_pk_bf16_f32 v124, v124, v125
    v_cvt_pk_bf16_f32 v125, v126, v127
    buffer_store_dwordx2 v[124:125], v149, s[16:19], 0 offen
    v_pk_mul_f32 v[176:177], v[30:31], v[176:177] op_sel:[1,0] op_sel_hi:[1,1]
    v_pk_fma_f32 v[128:129], v[30:31], v[128:129], v[176:177] op_sel_hi:[0,1,1]
    v_pk_mul_f32 v[178:179], v[30:31], v[178:179] op_sel:[1,0] op_sel_hi:[1,1]
    v_pk_fma_f32 v[130:131], v[30:31], v[130:131], v[178:179] op_sel_hi:[0,1,1]
    v_cvt_pk_bf16_f32 v128, v128, v129
    v_cvt_pk_bf16_f32 v129, v130, v131
    buffer_store_dwordx2 v[128:129], v150, s[16:19], 0 offen
    v_pk_mul_f32 v[180:181], v[30:31], v[180:181] op_sel:[1,0] op_sel_hi:[1,1]
    v_pk_fma_f32 v[132:133], v[30:31], v[132:133], v[180:181] op_sel_hi:[0,1,1]
    v_pk_mul_f32 v[182:183], v[30:31], v[182:183] op_sel:[1,0] op_sel_hi:[1,1]
    v_pk_fma_f32 v[134:135], v[30:31], v[134:135], v[182:183] op_sel_hi:[0,1,1]
    v_cvt_pk_bf16_f32 v132, v132, v133
    v_cvt_pk_bf16_f32 v133, v134, v135
    buffer_store_dwordx2 v[132:133], v151, s[16:19], 0 offen
    s_endpgm
L_qkv0_kernel_v:
    s_sub_u32 s47, s33, 10
    s_add_u32 s16, s28, 0x400000
    s_addc_u32 s17, s29, 0
    s_mov_b32 s18, 0x500000
    s_mov_b32 s19, 0x00020000
    v_lshrrev_b32 v5, 5, v1
    v_and_b32 v6, 31, v1
    s_lshl_b32 s46, s47, 7
    s_mul_i32 s48, s42, 2560
    s_add_u32 s48, s48, 1280
    v_mul_u32_u24 v5, 320, v5
    s_add_u32 s49, s35, 0
    s_and_b32 s49, s49, 3
    s_lshl_b32 s49, s49, 5
    s_add_u32 s49, s49, s46
    v_add_u32 v3, s49, v6
    v_mul_u32_u24 v4, 3277, v3
    v_lshrrev_b32 v4, 16, v4
    v_mul_u32_u24 v7, 20, v4
    v_sub_u32 v3, v3, v7
    v_mul_u32_u24 v136, 163840, v4
    v_lshl_add_u32 v136, v3, 4, v136
    v_add3_u32 v136, v136, v5, s48
    s_add_u32 s49, s35, 1
    s_and_b32 s49, s49, 3
    s_lshl_b32 s49, s49, 5
    s_add_u32 s49, s49, s46
    v_add_u32 v3, s49, v6
    v_mul_u32_u24 v4, 3277, v3
    v_lshrrev_b32 v4, 16, v4
    v_mul_u32_u24 v7, 20, v4
    v_sub_u32 v3, v3, v7
    v_mul_u32_u24 v137, 163840, v4
    v_lshl_add_u32 v137, v3, 4, v137
    v_add3_u32 v137, v137, v5, s48
    s_add_u32 s49, s35, 2
    s_and_b32 s49, s49, 3
    s_lshl_b32 s49, s49, 5
    s_add_u32 s49, s49, s46
    v_add_u32 v3, s49, v6
    v_mul_u32_u24 v4, 3277, v3
    v_lshrrev_b32 v4, 16, v4
    v_mul_u32_u24 v7, 20, v4
    v_sub_u32 v3, v3, v7
    v_mul_u32_u24 v138, 163840, v4
    v_lshl_add_u32 v138, v3, 4, v138
    v_add3_u32 v138, v138, v5, s48
    s_add_u32 s49, s35, 3
    s_and_b32 s49, s49, 3
    s_lshl_b32 s49, s49, 5
    s_add_u32 s49, s49, s46
    v_add_u32 v3, s49, v6
    v_mul_u32_u24 v4, 3277, v3
    v_lshrrev_b32 v4, 16, v4
    v_mul_u32_u24 v7, 20, v4
    v_sub_u32 v3, v3, v7
    v_mul_u32_u24 v139, 163840, v4
    v_lshl_add_u32 v139, v3, 4, v139
    v_add3_u32 v139, v139, v5, s48
    s_mov_b32 s44, 0
    s_mov_b32 s50, 10
    s_mov_b32 s60, 32768
    s_barrier
    ds_read_b128 v[32:35], v22
    ds_read_b64_tr_b16 v[40:41], v18 offset:0
    ds_read_b64_tr_b16 v[42:43], v18 offset:1024
    ds_read_b64_tr_b16 v[44:45], v19 offset:0
    ds_read_b64_tr_b16 v[46:47], v19 offset:1024
    ds_read_b64_tr_b16 v[48:49], v20 offset:0
    ds_read_b64_tr_b16 v[50:51], v20 offset:1024
    ds_read_b64_tr_b16 v[52:53], v21 offset:0
    ds_read_b64_tr_b16 v[54:55], v21 offset:1024
L_qkv0_kernel_loop_8:
    s_waitcnt lgkmcnt(6)
    v_mfma_f32_32x32x16_bf16 v[72:87], v[32:35], v[40:43], v[72:87]
    ds_read_b128 v[36:39], v23
    ds_read_b64_tr_b16 v[56:57], v18 offset:4096
    s_waitcnt lgkmcnt(6)
    v_mfma_f32_32x32x16_bf16 v[88:103], v[32:35], v[44:47], v[88:103]
    ds_read_b64_tr_b16 v[58:59], v18 offset:5120
    ds_read_b64_tr_b16 v[60:61], v19 offset:4096
    s_waitcnt lgkmcnt(6)
    v_mfma_f32_32x32x16_bf16 v[104:119], v[32:35], v[48:51], v[104:119]
    ds_read_b64_tr_b16 v[62:63], v19 offset:5120
    ds_read_b64_tr_b16 v[64:65], v20 offset:4096
    s_waitcnt lgkmcnt(6)
    v_mfma_f32_32x32x16_bf16 v[120:135], v[32:35], v[52:55], v[120:135]
    ds_read_b64_tr_b16 v[66:67], v20 offset:5120
    ds_read_b64_tr_b16 v[68:69], v21 offset:4096
    v_mfma_f32_32x32x16_bf16 v[192:207], v[40:43], v[208:211], v[192:207]
    ds_read_b64_tr_b16 v[70:71], v21 offset:5120
    s_waitcnt lgkmcnt(6)
    v_mfma_f32_32x32x16_bf16 v[72:87], v[36:39], v[56:59], v[72:87]
    ds_read_b128 v[32:35], v24
    ds_read_b64_tr_b16 v[40:41], v18 offset:8192
    s_waitcnt lgkmcnt(6)
    v_mfma_f32_32x32x16_bf16 v[88:103], v[36:39], v[60:63], v[88:103]
    ds_read_b64_tr_b16 v[42:43], v18 offset:9216
    ds_read_b64_tr_b16 v[44:45], v19 offset:8192
    s_waitcnt lgkmcnt(6)
    v_mfma_f32_32x32x16_bf16 v[104:119], v[36:39], v[64:67], v[104:119]
    ds_read_b64_tr_b16 v[46:47], v19 offset:9216
    ds_read_b64_tr_b16 v[48:49], v20 offset:8192
    s_waitcnt lgkmcnt(6)
    v_mfma_f32_32x32x16_bf16 v[120:135], v[36:39], v[68:71], v[120:135]
    ds_read_b64_tr_b16 v[50:51], v20 offset:9216
    ds_read_b64_tr_b16 v[52:53], v21 offset:8192
    v_mfma_f32_32x32x16_bf16 v[192:207], v[56:59], v[208:211], v[192:207]
    ds_read_b64_tr_b16 v[54:55], v21 offset:9216
    s_waitcnt lgkmcnt(6)
    v_mfma_f32_32x32x16_bf16 v[72:87], v[32:35], v[40:43], v[72:87]
    s_barrier
    s_add_u32 s44, s44, 32768
    s_cmp_ge_u32 s44, 131072
    s_cselect_b32 s45, 0xfffe8000, s60
    s_cselect_b32 s44, 0, s44
    ds_read_b128 v[36:39], v25
    ds_read_b64_tr_b16 v[56:57], v18 offset:12288
    ds_read_b64_tr_b16 v[58:59], v18 offset:13312
    s_waitcnt lgkmcnt(7)
    v_mfma_f32_32x32x16_bf16 v[88:103], v[32:35], v[44:47], v[88:103]
    ds_read_b64_tr_b16 v[60:61], v19 offset:12288
    ds_read_b64_tr_b16 v[62:63], v19 offset:13312
    ds_read_b64_tr_b16 v[64:65], v20 offset:12288
    ds_read_b64_tr_b16 v[66:67], v20 offset:13312
    s_waitcnt lgkmcnt(9)
    v_mfma_f32_32x32x16_bf16 v[104:119], v[32:35], v[48:51], v[104:119]
    ds_read_b64_tr_b16 v[68:69], v21 offset:12288
    ds_read_b64_tr_b16 v[70:71], v21 offset:13312
    v_add_u32 v22, s45, v22
    s_waitcnt lgkmcnt(9)
    v_mfma_f32_32x32x16_bf16 v[120:135], v[32:35], v[52:55], v[120:135]
    v_add_u32 v23, s45, v23
    v_add_u32 v24, s45, v24
    v_add_u32 v25, s45, v25
    v_add_u32 v18, s45, v18
    v_mfma_f32_32x32x16_bf16 v[192:207], v[40:43], v[208:211], v[192:207]
    v_add_u32 v19, s45, v19
    v_add_u32 v20, s45, v20
    v_add_u32 v21, s45, v21
    s_waitcnt lgkmcnt(6)
    v_mfma_f32_32x32x16_bf16 v[72:87], v[36:39], v[56:59], v[72:87]
    ds_read_b128 v[32:35], v22
    ds_read_b64_tr_b16 v[40:41], v18 offset:0
    s_waitcnt lgkmcnt(6)
    v_mfma_f32_32x32x16_bf16 v[88:103], v[36:39], v[60:63], v[88:103]
    ds_read_b64_tr_b16 v[42:43], v18 offset:1024
    ds_read_b64_tr_b16 v[44:45], v19 offset:0
    s_waitcnt lgkmcnt(6)
    v_mfma_f32_32x32x16_bf16 v[104:119], v[36:39], v[64:67], v[104:119]
    ds_read_b64_tr_b16 v[46:47], v19 offset:1024
    ds_read_b64_tr_b16 v[48:49], v20 offset:0
    s_waitcnt lgkmcnt(6)
    v_mfma_f32_32x32x16_bf16 v[120:135], v[36:39], v[68:71], v[120:135]
    ds_read_b64_tr_b16 v[50:51], v20 offset:1024
    ds_read_b64_tr_b16 v[52:53], v21 offset:0
    v_mfma_f32_32x32x16_bf16 v[192:207], v[56:59], v[208:211], v[192:207]
    ds_read_b64_tr_b16 v[54:55], v21 offset:1024
    s_sub_u32 s50, s50, 1
    s_cmp_lg_u32 s50, 0
    s_cbranch_scc1 L_qkv0_kernel_loop_8
    s_waitcnt  lgkmcnt(0)
    s_nop 7
    v_lshrrev_b32 v4, 5, v1
    v_lshlrev_b32 v4, 4, v4
    s_lshl_b32 s46, s35, 7
    v_add_u32 v3, s46, v4
    v_add_u32 v5, 98304, v3
    v_add_u32 v4, 98304, v4
    s_mov_b32 exec_lo, 1
    s_mov_b32 exec_hi, 1
    ds_write_b128 v5, v[192:195] offset:0
    ds_write_b128 v5, v[196:199] offset:32
    ds_write_b128 v5, v[200:203] offset:64
    ds_write_b128 v5, v[204:207] offset:96
    s_cmp_lg_u32 s32, 0
    s_cbranch_scc1 L_qkv0_kernel_nocs_9
    s_lshl_b32 s46, s33, 9
    buffer_store_dwordx4 v[192:195], v3, s[52:55], s46 offen offset:0 sc1
    buffer_store_dwordx4 v[196:199], v3, s[52:55], s46 offen offset:32 sc1
    buffer_store_dwordx4 v[200:203], v3, s[52:55], s46 offen offset:64 sc1
    buffer_store_dwordx4 v[204:207], v3, s[52:55], s46 offen offset:96 sc1
L_qkv0_kernel_nocs_9:
    s_mov_b64 exec, -1
    s_waitcnt lgkmcnt(0)
    s_barrier
    v_lshlrev_b32 v5, 3, v1
    s_lshl_b32 s46, s35, 9
    s_add_u32 s46, s46, 100352
    v_add_u32 v5, s46, v5
    ds_read_b64 v[30:31], v5
    v_add_f32 v26, v26, v27
    v_add_f32 v28, v28, v29
    v_mov_b32 v6, v4
    s_waitcnt lgkmcnt(0)
    v_add_f32 v26, v26, v30
    v_add_f32 v28, v28, v31
    v_mov_b32 v3, v26
    v_mov_b32 v4, v28
    s_nop 1
    v_permlane32_swap_b32 v26, v3
    v_permlane32_swap_b32 v28, v4
    s_nop 1
    v_add_f32 v26, v26, v3
    v_add_f32 v28, v28, v4
    v_mul_f32 v26, 0x3acccccd, v26
    v_mul_f32 v28, 0x3acccccd, v28
    v_fma_f32 v28, -v26, v26, v28
    v_max_f32 v28, 0, v28
    v_add_f32 v28, 0x3727c5ac, v28
    v_rsq_f32 v30, v28
    s_nop 0
    v_mul_f32 v31, v30, v26
    v_sub_f32 v31, 0, v31
    v_mov_b32 v4, v6
    s_lshl_b32 s46, s35, 8
    s_add_u32 s46, s46, 1024
    v_add_u32 v3, s46, v4
    v_and_b32 v4, 31, v1
    v_lshlrev_b32 v4, 2, v4
    v_add_u32 v4, 98304, v4
    v_add_u32 v5, s46, v4
    ds_write_b32 v5, v30
    ds_write_b32 v5, v31 offset:128
    s_waitcnt lgkmcnt(0)
    ds_read_b128 v[152:155], v3 offset:0
    ds_read_b128 v[168:171], v3 offset:128
    ds_read_b128 v[156:159], v3 offset:32
    ds_read_b128 v[172:175], v3 offset:160
    ds_read_b128 v[160:163], v3 offset:64
    ds_read_b128 v[176:179], v3 offset:192
    ds_read_b128 v[164:167], v3 offset:96
    ds_read_b128 v[180:183], v3 offset:224
    s_add_u32 s49, s35, 0
    s_and_b32 s49, s49, 3
    s_lshl_b32 s49, s49, 7
    v_add_u32 v5, s49, v4
    ds_read_b32 v184, v5
    s_add_u32 s49, s35, 1
    s_and_b32 s49, s49, 3
    s_lshl_b32 s49, s49, 7
    v_add_u32 v5, s49, v4
    ds_read_b32 v186, v5
    s_add_u32 s49, s35, 2
    s_and_b32 s49, s49, 3
    s_lshl_b32 s49, s49, 7
    v_add_u32 v5, s49, v4
    ds_read_b32 v188, v5
    s_add_u32 s49, s35, 3
    s_and_b32 s49, s49, 3
    s_lshl_b32 s49, s49, 7
    v_add_u32 v5, s49, v4
    ds_read_b32 v190, v5
    s_waitcnt lgkmcnt(0)
    v_pk_mul_f32 v[72:73], v[152:153], v[72:73]
    v_pk_fma_f32 v[72:73], v[184:185], v[168:169], v[72:73] op_sel_hi:[0,1,1]
    v_pk_mul_f32 v[74:75], v[154:155], v[74:75]
    v_pk_fma_f32 v[74:75], v[184:185], v[170:171], v[74:75] op_sel_hi:[0,1,1]
    v_pk_mul_f32 v[76:77], v[156:157], v[76:77]
    v_pk_fma_f32 v[76:77], v[184:185], v[172:173], v[76:77] op_sel_hi:[0,1,1]
    v_pk_mul_f32 v[78:79], v[158:159], v[78:79]
    v_pk_fma_f32 v[78:79], v[184:185], v[174:175], v[78:79] op_sel_hi:[0,1,1]
    v_cvt_pk_bf16_f32 v72, v72, v73
    v_cvt_pk_bf16_f32 v73, v74, v75
    v_cvt_pk_bf16_f32 v74, v76, v77
    v_cvt_pk_bf16_f32 v75, v78, v79
    buffer_store_dwordx4 v[72:75], v136, s[16:19], 0 offen offset:0 sc1
    v_pk_mul_f32 v[80:81], v[160:161], v[80:81]
    v_pk_fma_f32 v[80:81], v[184:185], v[176:177], v[80:81] op_sel_hi:[0,1,1]
    v_pk_mul_f32 v[82:83], v[162:163], v[82:83]
    v_pk_fma_f32 v[82:83], v[184:185], v[178:179], v[82:83] op_sel_hi:[0,1,1]
    v_pk_mul_f32 v[84:85], v[164:165], v[84:85]
    v_pk_fma_f32 v[84:85], v[184:185], v[180:181], v[84:85] op_sel_hi:[0,1,1]
    v_pk_mul_f32 v[86:87], v[166:167], v[86:87]
    v_pk_fma_f32 v[86:87], v[184:185], v[182:183], v[86:87] op_sel_hi:[0,1,1]
    v_cvt_pk_bf16_f32 v80, v80, v81
    v_cvt_pk_bf16_f32 v81, v82, v83
    v_cvt_pk_bf16_f32 v82, v84, v85
    v_cvt_pk_bf16_f32 v83, v86, v87
    buffer_store_dwordx4 v[80:83], v136, s[16:19], 0 offen offset:640 sc1
    v_pk_mul_f32 v[88:89], v[152:153], v[88:89]
    v_pk_fma_f32 v[88:89], v[186:187], v[168:169], v[88:89] op_sel_hi:[0,1,1]
    v_pk_mul_f32 v[90:91], v[154:155], v[90:91]
    v_pk_fma_f32 v[90:91], v[186:187], v[170:171], v[90:91] op_sel_hi:[0,1,1]
    v_pk_mul_f32 v[92:93], v[156:157], v[92:93]
    v_pk_fma_f32 v[92:93], v[186:187], v[172:173], v[92:93] op_sel_hi:[0,1,1]
    v_pk_mul_f32 v[94:95], v[158:159], v[94:95]
    v_pk_fma_f32 v[94:95], v[186:187], v[174:175], v[94:95] op_sel_hi:[0,1,1]
    v_cvt_pk_bf16_f32 v88, v88, v89
    v_cvt_pk_bf16_f32 v89, v90, v91
    v_cvt_pk_bf16_f32 v90, v92, v93
    v_cvt_pk_bf16_f32 v91, v94, v95
    buffer_store_dwordx4 v[88:91], v137, s[16:19], 0 offen offset:0 sc1
    v_pk_mul_f32 v[96:97], v[160:161], v[96:97]
    v_pk_fma_f32 v[96:97], v[186:187], v[176:177], v[96:97] op_sel_hi:[0,1,1]
    v_pk_mul_f32 v[98:99], v[162:163], v[98:99]
    v_pk_fma_f32 v[98:99], v[186:187], v[178:179], v[98:99] op_sel_hi:[0,1,1]
    v_pk_mul_f32 v[100:101], v[164:165], v[100:101]
    v_pk_fma_f32 v[100:101], v[186:187], v[180:181], v[100:101] op_sel_hi:[0,1,1]
    v_pk_mul_f32 v[102:103], v[166:167], v[102:103]
    v_pk_fma_f32 v[102:103], v[186:187], v[182:183], v[102:103] op_sel_hi:[0,1,1]
    v_cvt_pk_bf16_f32 v96, v96, v97
    v_cvt_pk_bf16_f32 v97, v98, v99
    v_cvt_pk_bf16_f32 v98, v100, v101
    v_cvt_pk_bf16_f32 v99, v102, v103
    buffer_store_dwordx4 v[96:99], v137, s[16:19], 0 offen offset:640 sc1
    v_pk_mul_f32 v[104:105], v[152:153], v[104:105]
    v_pk_fma_f32 v[104:105], v[188:189], v[168:169], v[104:105] op_sel_hi:[0,1,1]
    v_pk_mul_f32 v[106:107], v[154:155], v[106:107]
    v_pk_fma_f32 v[106:107], v[188:189], v[170:171], v[106:107] op_sel_hi:[0,1,1]
    v_pk_mul_f32 v[108:109], v[156:157], v[108:109]
    v_pk_fma_f32 v[108:109], v[188:189], v[172:173], v[108:109] op_sel_hi:[0,1,1]
    v_pk_mul_f32 v[110:111], v[158:159], v[110:111]
    v_pk_fma_f32 v[110:111], v[188:189], v[174:175], v[110:111] op_sel_hi:[0,1,1]
    v_cvt_pk_bf16_f32 v104, v104, v105
    v_cvt_pk_bf16_f32 v105, v106, v107
    v_cvt_pk_bf16_f32 v106, v108, v109
    v_cvt_pk_bf16_f32 v107, v110, v111
    buffer_store_dwordx4 v[104:107], v138, s[16:19], 0 offen offset:0 sc1
    v_pk_mul_f32 v[112:113], v[160:161], v[112:113]
    v_pk_fma_f32 v[112:113], v[188:189], v[176:177], v[112:113] op_sel_hi:[0,1,1]
    v_pk_mul_f32 v[114:115], v[162:163], v[114:115]
    v_pk_fma_f32 v[114:115], v[188:189], v[178:179], v[114:115] op_sel_hi:[0,1,1]
    v_pk_mul_f32 v[116:117], v[164:165], v[116:117]
    v_pk_fma_f32 v[116:117], v[188:189], v[180:181], v[116:117] op_sel_hi:[0,1,1]
    v_pk_mul_f32 v[118:119], v[166:167], v[118:119]
    v_pk_fma_f32 v[118:119], v[188:189], v[182:183], v[118:119] op_sel_hi:[0,1,1]
    v_cvt_pk_bf16_f32 v112, v112, v113
    v_cvt_pk_bf16_f32 v113, v114, v115
    v_cvt_pk_bf16_f32 v114, v116, v117
    v_cvt_pk_bf16_f32 v115, v118, v119
    buffer_store_dwordx4 v[112:115], v138, s[16:19], 0 offen offset:640 sc1
    v_pk_mul_f32 v[120:121], v[152:153], v[120:121]
    v_pk_fma_f32 v[120:121], v[190:191], v[168:169], v[120:121] op_sel_hi:[0,1,1]
    v_pk_mul_f32 v[122:123], v[154:155], v[122:123]
    v_pk_fma_f32 v[122:123], v[190:191], v[170:171], v[122:123] op_sel_hi:[0,1,1]
    v_pk_mul_f32 v[124:125], v[156:157], v[124:125]
    v_pk_fma_f32 v[124:125], v[190:191], v[172:173], v[124:125] op_sel_hi:[0,1,1]
    v_pk_mul_f32 v[126:127], v[158:159], v[126:127]
    v_pk_fma_f32 v[126:127], v[190:191], v[174:175], v[126:127] op_sel_hi:[0,1,1]
    v_cvt_pk_bf16_f32 v120, v120, v121
    v_cvt_pk_bf16_f32 v121, v122, v123
    v_cvt_pk_bf16_f32 v122, v124, v125
    v_cvt_pk_bf16_f32 v123, v126, v127
    buffer_store_dwordx4 v[120:123], v139, s[16:19], 0 offen offset:0 sc1
    v_pk_mul_f32 v[128:129], v[160:161], v[128:129]
    v_pk_fma_f32 v[128:129], v[190:191], v[176:177], v[128:129] op_sel_hi:[0,1,1]
    v_pk_mul_f32 v[130:131], v[162:163], v[130:131]
    v_pk_fma_f32 v[130:131], v[190:191], v[178:179], v[130:131] op_sel_hi:[0,1,1]
    v_pk_mul_f32 v[132:133], v[164:165], v[132:133]
    v_pk_fma_f32 v[132:133], v[190:191], v[180:181], v[132:133] op_sel_hi:[0,1,1]
    v_pk_mul_f32 v[134:135], v[166:167], v[134:135]
    v_pk_fma_f32 v[134:135], v[190:191], v[182:183], v[134:135] op_sel_hi:[0,1,1]
    v_cvt_pk_bf16_f32 v128, v128, v129
    v_cvt_pk_bf16_f32 v129, v130, v131
    v_cvt_pk_bf16_f32 v130, v132, v133
    v_cvt_pk_bf16_f32 v131, v134, v135
    buffer_store_dwordx4 v[128:131], v139, s[16:19], 0 offen offset:640 sc1
    s_endpgm
L_qkv0_kernel_spare:
    v_mul_u32_u24 v3, 0xab, v1
    v_lshrrev_b32 v3, 12, v3
    v_mul_u32_u24 v4, 24, v3
    v_sub_u32 v4, v1, v4
    v_mul_u32_u24 v5, 3072, v3
    v_lshl_add_u32 v5, v4, 4, v5
    s_waitcnt lgkmcnt(0)
    s_cmp_ge_u32 s32, 8
    s_cselect_b32 s8, s26, s24
    s_cselect_b32 s9, s27, s25
    s_mov_b32 s10, 0x1e0000
    s_mov_b32 s11, 0x00020000
    s_and_b32 s33, s32, 7
    s_mul_i32 s36, s33, 384
    s_mul_i32 s37, s64, 245760
    s_add_u32 s36, s36, s37
    s_mov_b32 exec_lo, -1
    s_mov_b32 exec_hi, 0xffff
    s_add_u32 s52, s28, 0x2080000
    s_addc_u32 s53, s29, 0
    s_mov_b32 s54, 0x5000
    s_mov_b32 s55, 0x00020000
    s_add_u32 s56, s28, 0x3000000
    s_addc_u32 s57, s29, 0
    s_mov_b32 s58, 0x10000
    s_mov_b32 s59, 0x00020000
    s_cmp_lg_u32 s32, 0
    s_cbranch_scc1 L_qkv0_kernel_nz_10
    s_mov_b64 exec, -1
    v_lshlrev_b32 v6, 7, v1
    v_mov_b32 v8, 0
    v_mov_b32 v9, 0
    v_mov_b32 v10, 0
    v_mov_b32 v11, 0
    s_lshl_b32 s37, s64, 13
    buffer_store_dwordx4 v[8:11], v6, s[56:59], s37 offen sc1
    buffer_store_dwordx4 v[8:11], v6, s[56:59], s37 offen offset:16 sc1
    buffer_store_dwordx4 v[8:11], v6, s[56:59], s37 offen offset:32 sc1
    buffer_store_dwordx4 v[8:11], v6, s[56:59], s37 offen offset:48 sc1
    s_nop 1
    s_mov_b32 exec_hi, 0xffff
L_qkv0_kernel_nz_10:
    s_endpgm
    v_mov_b32 v8, 0
    v_mov_b32 v9, 0
    v_mov_b32 v10, 0
    v_mov_b32 v11, 0
    v_mov_b32 v12, 0
    v_mov_b32 v13, 0
    v_mov_b32 v14, 0
    v_mov_b32 v15, 0
    buffer_load_dwordx4 v[16:19], v5, s[8:11], s36 offen
    s_add_u32 s36, s36, 6144
    buffer_load_dwordx4 v[20:23], v5, s[8:11], s36 offen
    s_add_u32 s36, s36, 6144
    buffer_load_dwordx4 v[24:27], v5, s[8:11], s36 offen
    s_add_u32 s36, s36, 6144
    buffer_load_dwordx4 v[28:31], v5, s[8:11], s36 offen
    s_add_u32 s36, s36, 6144
    buffer_load_dwordx4 v[32:35], v5, s[8:11], s36 offen
    s_add_u32 s36, s36, 6144
    buffer_load_dwordx4 v[36:39], v5, s[8:11], s36 offen
    s_add_u32 s36, s36, 6144
    buffer_load_dwordx4 v[40:43], v5, s[8:11], s36 offen
    s_add_u32 s36, s36, 6144
    buffer_load_dwordx4 v[44:47], v5, s[8:11], s36 offen
    s_add_u32 s36, s36, 6144
    s_mov_b32 s50, 5
L_qkv0_kernel_sp_11:
    s_cmp_eq_u32 s50, 1
    s_cselect_b32 s36, 0x7f000000, s36
    s_waitcnt vmcnt(7)
    v_lshlrev_b32 v100, 16, v16
    v_and_b32 v101, 0xffff0000, v16
    v_lshlrev_b32 v102, 16, v17
    v_and_b32 v103, 0xffff0000, v17
    v_lshlrev_b32 v104, 16, v18
    v_and_b32 v105, 0xffff0000, v18
    v_lshlrev_b32 v106, 16, v19
    v_and_b32 v107, 0xffff0000, v19
    buffer_load_dwordx4 v[16:19], v5, s[8:11], s36 offen
    s_add_u32 s36, s36, 6144
    v_pk_add_f32 v[8:9], v[8:9], v[100:101]
    v_pk_add_f32 v[10:11], v[10:11], v[102:103]
    v_pk_add_f32 v[12:13], v[12:13], v[104:105]
    v_pk_add_f32 v[14:15], v[14:15], v[106:107]
    s_waitcnt vmcnt(7)
    v_lshlrev_b32 v100, 16, v20
    v_and_b32 v101, 0xffff0000, v20
    v_lshlrev_b32 v102, 16, v21
    v_and_b32 v103, 0xffff0000, v21
    v_lshlrev_b32 v104, 16, v22
    v_and_b32 v105, 0xffff0000, v22
    v_lshlrev_b32 v106, 16, v23
    v_and_b32 v107, 0xffff0000, v23
    buffer_load_dwordx4 v[20:23], v5, s[8:11], s36 offen
    s_add_u32 s36, s36, 6144
    v_pk_add_f32 v[8:9], v[8:9], v[100:101]
    v_pk_add_f32 v[10:11], v[10:11], v[102:103]
    v_pk_add_f32 v[12:13], v[12:13], v[104:105]
    v_pk_add_f32 v[14:15], v[14:15], v[106:107]
    s_waitcnt vmcnt(7)
    v_lshlrev_b32 v100, 16, v24
    v_and_b32 v101, 0xffff0000, v24
    v_lshlrev_b32 v102, 16, v25
    v_and_b32 v103, 0xffff0000, v25
    v_lshlrev_b32 v104, 16, v26
    v_and_b32 v105, 0xffff0000, v26
    v_lshlrev_b32 v106, 16, v27
    v_and_b32 v107, 0xffff0000, v27
    buffer_load_dwordx4 v[24:27], v5, s[8:11], s36 offen
    s_add_u32 s36, s36, 6144
    v_pk_add_f32 v[8:9], v[8:9], v[100:101]
    v_pk_add_f32 v[10:11], v[10:11], v[102:103]
    v_pk_add_f32 v[12:13], v[12:13], v[104:105]
    v_pk_add_f32 v[14:15], v[14:15], v[106:107]
    s_waitcnt vmcnt(7)
    v_lshlrev_b32 v100, 16, v28
    v_and_b32 v101, 0xffff0000, v28
    v_lshlrev_b32 v102, 16, v29
    v_and_b32 v103, 0xffff0000, v29
    v_lshlrev_b32 v104, 16, v30
    v_and_b32 v105, 0xffff0000, v30
    v_lshlrev_b32 v106, 16, v31
    v_and_b32 v107, 0xffff0000, v31
    buffer_load_dwordx4 v[28:31], v5, s[8:11], s36 offen
    s_add_u32 s36, s36, 6144
    v_pk_add_f32 v[8:9], v[8:9], v[100:101]
    v_pk_add_f32 v[10:11], v[10:11], v[102:103]
    v_pk_add_f32 v[12:13], v[12:13], v[104:105]
    v_pk_add_f32 v[14:15], v[14:15], v[106:107]
    s_waitcnt vmcnt(7)
    v_lshlrev_b32 v100, 16, v32
    v_and_b32 v101, 0xffff0000, v32
    v_lshlrev_b32 v102, 16, v33
    v_and_b32 v103, 0xffff0000, v33
    v_lshlrev_b32 v104, 16, v34
    v_and_b32 v105, 0xffff0000, v34
    v_lshlrev_b32 v106, 16, v35
    v_and_b32 v107, 0xffff0000, v35
    buffer_load_dwordx4 v[32:35], v5, s[8:11], s36 offen
    s_add_u32 s36, s36, 6144
    v_pk_add_f32 v[8:9], v[8:9], v[100:101]
    v_pk_add_f32 v[10:11], v[10:11], v[102:103]
    v_pk_add_f32 v[12:13], v[12:13], v[104:105]
    v_pk_add_f32 v[14:15], v[14:15], v[106:107]
    s_waitcnt vmcnt(7)
    v_lshlrev_b32 v100, 16, v36
    v_and_b32 v101, 0xffff0000, v36
    v_lshlrev_b32 v102, 16, v37
    v_and_b32 v103, 0xffff0000, v37
    v_lshlrev_b32 v104, 16, v38
    v_and_b32 v105, 0xffff0000, v38
    v_lshlrev_b32 v106, 16, v39
    v_and_b32 v107, 0xffff0000, v39
    buffer_load_dwordx4 v[36:39], v5, s[8:11], s36 offen
    s_add_u32 s36, s36, 6144
    v_pk_add_f32 v[8:9], v[8:9], v[100:101]
    v_pk_add_f32 v[10:11], v[10:11], v[102:103]
    v_pk_add_f32 v[12:13], v[12:13], v[104:105]
    v_pk_add_f32 v[14:15], v[14:15], v[106:107]
    s_waitcnt vmcnt(7)
    v_lshlrev_b32 v100, 16, v40
    v_and_b32 v101, 0xffff0000, v40
    v_lshlrev_b32 v102, 16, v41
    v_and_b32 v103, 0xffff0000, v41
    v_lshlrev_b32 v104, 16, v42
    v_and_b32 v105, 0xffff0000, v42
    v_lshlrev_b32 v106, 16, v43
    v_and_b32 v107, 0xffff0000, v43
    buffer_load_dwordx4 v[40:43], v5, s[8:11], s36 offen
    s_add_u32 s36, s36, 6144
    v_pk_add_f32 v[8:9], v[8:9], v[100:101]
    v_pk_add_f32 v[10:11], v[10:11], v[102:103]
    v_pk_add_f32 v[12:13], v[12:13], v[104:105]
    v_pk_add_f32 v[14:15], v[14:15], v[106:107]
    s_waitcnt vmcnt(7)
    v_lshlrev_b32 v100, 16, v44
    v_and_b32 v101, 0xffff0000, v44
    v_lshlrev_b32 v102, 16, v45
    v_and_b32 v103, 0xffff0000, v45
    v_lshlrev_b32 v104, 16, v46
    v_and_b32 v105, 0xffff0000, v46
    v_lshlrev_b32 v106, 16, v47
    v_and_b32 v107, 0xffff0000, v47
    buffer_load_dwordx4 v[44:47], v5, s[8:11], s36 offen
    s_add_u32 s36, s36, 6144
    v_pk_add_f32 v[8:9], v[8:9], v[100:101]
    v_pk_add_f32 v[10:11], v[10:11], v[102:103]
    v_pk_add_f32 v[12:13], v[12:13], v[104:105]
    v_pk_add_f32 v[14:15], v[14:15], v[106:107]
    s_sub_u32 s50, s50, 1
    s_cmp_lg_u32 s50, 0
    s_cbranch_scc1 L_qkv0_kernel_sp_11
    s_lshl_b32 s37, s64, 1
    v_add_u32 v3, s37, v3
    v_mul_u32_u24 v3, 768, v3
    v_lshl_add_u32 v3, v4, 5, v3
    ds_write_b128 v3, v[8:11]
    ds_write_b128 v3, v[12:15] offset:16
    s_mov_b64 exec, -1
    v_lshlrev_b32 v3, 2, v0
    s_waitcnt vmcnt(0) lgkmcnt(0)
    s_barrier
    ds_read_b32 v16, v3 offset:0
    ds_read_b32 v17, v3 offset:768
    ds_read_b32 v18, v3 offset:1536
    ds_read_b32 v19, v3 offset:2304
    ds_read_b32 v20, v3 offset:3072
    ds_read_b32 v21, v3 offset:3840
    ds_read_b32 v22, v3 offset:4608
    ds_read_b32 v23, v3 offset:5376
    ds_read_b32 v24, v3 offset:6144
    ds_read_b32 v25, v3 offset:6912
    ds_read_b32 v26, v3 offset:7680
    ds_read_b32 v27, v3 offset:8448
    ds_read_b32 v28, v3 offset:9216
    ds_read_b32 v29, v3 offset:9984
    ds_read_b32 v30, v3 offset:10752
    ds_read_b32 v31, v3 offset:11520
    s_waitcnt lgkmcnt(0)
    v_add_f32 v16, v16, v17
    v_add_f32 v16, v16, v18
    v_add_f32 v16, v16, v19
    v_add_f32 v16, v16, v20
    v_add_f32 v16, v16, v21
    v_add_f32 v16, v16, v22
    v_add_f32 v16, v16, v23
    v_add_f32 v16, v16, v24
    v_add_f32 v16, v16, v25
    v_add_f32 v16, v16, v26
    v_add_f32 v16, v16, v27
    v_add_f32 v16, v16, v28
    v_add_f32 v16, v16, v29
    v_add_f32 v16, v16, v30
    v_add_f32 v16, v16, v31
    v_cmp_le_u32 vcc, 96, v0
    v_mov_b32 v4, 0
    v_mov_b32 v5, 384
    s_nop 1
    v_cndmask_b32 v4, v4, v5, vcc
    v_add_u32 v3, v3, v4
    s_mul_i32 s36, s33, 1536
    s_add_u32 s36, s36, 8192
    s_cmp_ge_u32 s32, 8
    s_cselect_b32 s37, 384, 0
    s_add_u32 s36, s36, s37
    v_cmp_gt_u32 vcc, 192, v0
    s_and_saveexec_b64 s[40:41], vcc
    s_cbranch_execz L_qkv0_kernel_sp2
    buffer_store_dword v16, v3, s[52:55], s36 offen
    s_endpgm
L_qkv0_kernel_sp2:
    s_cmp_lt_u32 s64, 4
    s_cbranch_scc1 L_qkv0_kernel_end
    s_and_b32 s35, s64, 3
    s_endpgm
L_qkv0_kernel_end:
    s_endpgm
.section .rodata,"a"
.p2align 6
.amdhsa_kernel qkv0_kernel
  .amdhsa_next_free_vgpr 212
  .amdhsa_next_free_sgpr 100
  .amdhsa_accum_offset 212
  .amdhsa_group_segment_fixed_size 0
  .amdhsa_kernarg_size 80
  .amdhsa_user_sgpr_count 2
  .amdhsa_user_sgpr_kernarg_segment_ptr 1
  .amdhsa_system_sgpr_workgroup_id_x 1
.end_amdhsa_kernel
.text
.globl attn0_kernel
.p2align 8
.type attn0_kernel,@function
attn0_kernel:
    s_cmp_ge_u32 s2, 256
    s_cbranch_scc1 L_attn0_kernel_end
    s_load_dwordx2 s[28:29], s[0:1], 72
    s_load_dwordx2 s[20:21], s[0:1], 16
    s_load_dwordx4 s[24:27], s[0:1], 32
    s_load_dwordx2 s[22:23], s[0:1], 48
    v_lshrrev_b32 v2, 6, v0
    v_and_b32 v1, 63, v0
    s_and_b32 s50, s2, 7
    s_lshr_b32 s51, s2, 3
    v_readfirstlane_b32 s49, v2
    s_lshl_b32 s30, s50, 2
    s_and_b32 s32, s51, 3
    s_add_u32 s30, s30, s32
    s_lshr_b32 s31, s51, 2
    v_lshlrev_b32 v123, 4, v1
    v_lshlrev_b32 v4, 3, v1
    s_and_b32 s35, s49, 7
    s_lshr_b32 s49, s49, 3
    s_lshl_b32 s33, s31, 3
    s_add_u32 s33, s33, s35
    s_lshl_b32 s34, s30, 6
    s_add_u32 s34, s34, s33
    s_mul_i32 s34, s34, 1280
    s_mul_i32 s47, s49, 81920
    s_lshl_b32 s37, s35, 10
    s_add_u32 s37, s37, s47
    s_mul_i32 s36, s30, 163840
    s_add_u32 s36, s36, s37
    v_mov_b32 v12, 0
    v_mov_b32 v13, 0
    s_waitcnt lgkmcnt(0)
    s_add_u32 s8, s28, 0x400000
    s_addc_u32 s9, s29, 0
    s_mov_b32 s10, 0x500000
    s_mov_b32 s11, 0x00020000
    s_mov_b32 s4, s28
    s_mov_b32 s5, s29
    s_mov_b32 s6, 0x280000
    s_mov_b32 s7, 0x00020000
    s_mov_b32 m0, s37
    s_add_u32 s37, s37, 8192
    buffer_load_dwordx4 v123, s[8:11], s36 offen lds
    s_add_u32 s36, s36, 8192
    buffer_load_dwordx4 v[8:11], v123, s[4:7], s34 offen
    s_mov_b32 exec_hi, 0
    buffer_load_dwordx2 v[12:13], v4, s[4:7], s34 offen offset:1024
    s_mov_b64 exec, -1
    s_mov_b32 m0, s37
    s_add_u32 s37, s37, 8192
    buffer_load_dwordx4 v123, s[8:11], s36 offen lds
    s_add_u32 s36, s36, 8192
    s_lshr_b32 s37, s35, 1
    s_mul_i32 s37, s37, 81920
    s_and_b32 s36, s35, 1
    s_lshl_b32 s36, s36, 10
    s_add_u32 s37, s37, s36
    s_add_u32 s37, s37, 16384
    s_mul_i32 s36, s30, 163840
    s_add_u32 s36, s36, s37
    s_lshl_b32 s48, s49, 3
    s_add_u32 s48, s48, s35
    s_lshr_b32 s48, s48, 2
    s_add_u32 s12, s28, 0xa00000
    s_addc_u32 s13, s29, 0
    s_mov_b32 s14, 0x280000
    s_mov_b32 s15, 0x00020000
    v_add_u32 v5, s47, v123
    v_and_b32 v2, 31, v1
    v_lshrrev_b32 v6, 4, v2
    v_mul_u32_u24 v6, 2304, v6
    v_lshl_add_u32 v6, v2, 4, v6
    v_add_u32 v6, 1024, v6
    v_add_u32 v6, s47, v6
    v_lshrrev_b32 v4, 5, v1
    v_mul_u32_u24 v4, 320, v4
    v_lshl_add_u32 v7, v2, 4, v4
    v_add_u32 v7, 1280, v7
    v_add_u32 v7, s47, v7
    s_mov_b32 s40, 0x000fffff
    s_mov_b32 s41, 0x000fffff
    v_mov_b32 v104, 0
    v_mov_b32 v105, 0
    v_mov_b32 v106, 0
    v_mov_b32 v107, 0
    v_mov_b32 v108, 0
    v_mov_b32 v109, 0
    v_mov_b32 v110, 0
    v_mov_b32 v111, 0
    v_mov_b32 v112, 0
    v_mov_b32 v113, 0
    v_mov_b32 v114, 0
    v_mov_b32 v115, 0
    v_mov_b32 v116, 0
    v_mov_b32 v117, 0
    v_mov_b32 v118, 0
    v_mov_b32 v119, 0
    s_mov_b32 exec_lo, 0x00100000
    s_mov_b32 exec_hi, 0x00100000
    v_mov_b32 v104, 0x3f803f80
    v_mov_b32 v105, 0x3f803f80
    v_mov_b32 v106, 0x3f803f80
    v_mov_b32 v107, 0x3f803f80
    v_mov_b32 v108, 0x3f803f80
    v_mov_b32 v109, 0x3f803f80
    v_mov_b32 v110, 0x3f803f80
    v_mov_b32 v111, 0x3f803f80
    v_mov_b32 v112, 0x3f803f80
    v_mov_b32 v113, 0x3f803f80
    v_mov_b32 v114, 0x3f803f80
    v_mov_b32 v115, 0x3f803f80
    v_mov_b32 v116, 0x3f803f80
    v_mov_b32 v117, 0x3f803f80
    v_mov_b32 v118, 0x3f803f80
    v_mov_b32 v119, 0x3f803f80
    s_mov_b64 exec, -1
    v_mov_b32 v72, 0
    v_mov_b32 v73, 0
    v_mov_b32 v74, 0
    v_mov_b32 v75, 0
    v_mov_b32 v76, 0
    v_mov_b32 v77, 0
    v_mov_b32 v78, 0
    v_mov_b32 v79, 0
    v_mov_b32 v80, 0
    v_mov_b32 v81, 0
    v_mov_b32 v82, 0
    v_mov_b32 v83, 0
    v_mov_b32 v84, 0
    v_mov_b32 v85, 0
    v_mov_b32 v86, 0
    v_mov_b32 v87, 0
    v_mov_b32 v68, 0
    v_mov_b32 v69, 0
    v_mov_b32 v70, 0
    v_mov_b32 v71, 0
    s_mov_b32 s44, 0
    s_mov_b32 s45, 0
    s_waitcnt vmcnt(0)
    s_barrier
    s_cmp_lg_u32 s48, 0
    s_cbranch_scc1 L_attn0_kernel_nd_1
    s_mov_b32 m0, s37
    s_add_u32 s37, s37, 2048
    buffer_load_dwordx4 v123, s[8:11], s36 offen lds
    s_add_u32 s36, s36, 2048
    s_mov_b32 m0, s37
    s_add_u32 s37, s37, 2048
    buffer_load_dwordx4 v123, s[8:11], s36 offen lds
    s_add_u32 s36, s36, 2048
    s_mov_b32 m0, s37
    s_add_u32 s37, s37, 2048
    buffer_load_dwordx4 v123, s[8:11], s36 offen lds
    s_add_u32 s36, s36, 2048
    s_mov_b32 m0, s37
    s_add_u32 s37, s37, 2048
    buffer_load_dwordx4 v123, s[8:11], s36 offen lds
    s_add_u32 s36, s36, 2048
    s_mov_b32 m0, s37
    s_add_u32 s37, s37, 2048
    buffer_load_dwordx4 v123, s[8:11], s36 offen lds
    s_add_u32 s36, s36, 2048
    s_mov_b32 m0, s37
    s_add_u32 s37, s37, 2048
    buffer_load_dwordx4 v123, s[8:11], s36 offen lds
    s_add_u32 s36, s36, 2048
    s_mov_b32 m0, s37
    s_add_u32 s37, s37, 2048
    buffer_load_dwordx4 v123, s[8:11], s36 offen lds
    s_add_u32 s36, s36, 2048
    s_mov_b32 m0, s37
    s_add_u32 s37, s37, 2048
    buffer_load_dwordx4 v123, s[8:11], s36 offen lds
    s_add_u32 s36, s36, 2048
    s_mov_b32 m0, s37
    s_add_u32 s37, s37, 2048
    buffer_load_dwordx4 v123, s[8:11], s36 offen lds
    s_add_u32 s36, s36, 2048
    s_mov_b32 m0, s37
    s_add_u32 s37, s37, 2048
    buffer_load_dwordx4 v123, s[8:11], s36 offen lds
    s_add_u32 s36, s36, 2048
    s_mov_b32 m0, s37
    s_add_u32 s37, s37, 2048
    buffer_load_dwordx4 v123, s[8:11], s36 offen lds
    s_add_u32 s36, s36, 2048
    s_mov_b32 m0, s37
    s_add_u32 s37, s37, 2048
    buffer_load_dwordx4 v123, s[8:11], s36 offen lds
    s_add_u32 s36, s36, 2048
L_attn0_kernel_nd_1:
    ds_read_b128 v[88:91], v5 offset:0
    ds_read_b128 v[96:99], v6 offset:0
    ds_read_b128 v[92:95], v5 offset:2560
    s_mov_b64 exec, s[40:41]
    ds_read_b128 v[104:107], v7 offset:0
    ds_read_b128 v[108:111], v7 offset:640
    s_mov_b64 exec, -1
    s_waitcnt lgkmcnt(3)
    v_mfma_f32_32x32x16_bf16 v[32:47], v[88:91], v[8:11], 0
    v_mfma_f32_32x32x8_bf16 v[32:47], v[96:97], v[12:13], v[32:47]
    s_nop 15
    v_max3_f32 v4, v32, v33, v34
    v_max3_f32 v4, v4, v35, v36
    v_max3_f32 v4, v4, v37, v38
    v_max3_f32 v4, v4, v39, v40
    v_max3_f32 v4, v4, v41, v42
    v_max3_f32 v4, v4, v43, v44
    v_max3_f32 v4, v4, v45, v46
    v_max_f32 v4, v4, v47
    v_mov_b32 v3, v4
    s_nop 1
    v_permlane32_swap_b32 v4, v3
    s_nop 1
    v_max_f32 v4, v4, v3
    v_sub_f32 v16, 0, v4
    v_mov_b32 v17, v16
    v_mov_b32 v18, v16
    v_mov_b32 v19, v16
    v_mov_b32 v20, v16
    v_mov_b32 v21, v16
    v_mov_b32 v22, v16
    v_mov_b32 v23, v16
    v_mov_b32 v24, v16
    v_mov_b32 v25, v16
    v_mov_b32 v26, v16
    v_mov_b32 v27, v16
    v_mov_b32 v28, v16
    v_mov_b32 v29, v16
    v_mov_b32 v30, v16
    v_mov_b32 v31, v16
    s_nop 1
    v_mfma_f32_32x32x16_bf16 v[32:47], v[88:91], v[8:11], v[16:31]
    v_mfma_f32_32x32x8_bf16 v[32:47], v[96:97], v[12:13], v[32:47]
L_attn0_kernel_main_2:
    s_nop 11
L_attn0_kernel_loop_3:
    s_add_u32 s46, s45, s44
    s_waitcnt lgkmcnt(0)
    v_mfma_f32_32x32x16_bf16 v[48:63], v[92:95], v[8:11], v[16:31]
    ds_read_b128 v[88:91], v5 offset:5120
    v_exp_f32 v32, v32
    v_exp_f32 v33, v33
    v_exp_f32 v34, v34
    v_exp_f32 v35, v35
    v_exp_f32 v36, v36
    v_mfma_f32_32x32x16_bf16 v[72:87], v[116:119], v[68:71], v[72:87]
    s_mov_b64 exec, s[40:41]
    ds_read_b128 v[112:115], v7 offset:2560
    ds_read_b128 v[116:119], v7 offset:3200
    s_mov_b64 exec, -1
    v_exp_f32 v37, v37
    v_exp_f32 v38, v38
    v_exp_f32 v39, v39
    v_cvt_pk_bf16_f32 v64, v32, v33
    v_cvt_pk_bf16_f32 v65, v34, v35
    v_cvt_pk_bf16_f32 v66, v36, v37
    v_cvt_pk_bf16_f32 v67, v38, v39
    v_mfma_f32_32x32x8_bf16 v[48:63], v[98:99], v[12:13], v[48:63]
    ds_read_b128 v[96:99], v6 offset:5120
    v_exp_f32 v40, v40
    v_exp_f32 v41, v41
    v_exp_f32 v42, v42
    v_exp_f32 v43, v43
    v_exp_f32 v44, v44
    v_mfma_f32_32x32x16_bf16 v[72:87], v[104:107], v[64:67], v[72:87]
    v_exp_f32 v45, v45
    v_exp_f32 v46, v46
    v_exp_f32 v47, v47
    v_cvt_pk_bf16_f32 v68, v40, v41
    v_cvt_pk_bf16_f32 v69, v42, v43
    v_cvt_pk_bf16_f32 v70, v44, v45
    v_cvt_pk_bf16_f32 v71, v46, v47
    s_waitcnt lgkmcnt(0)
    v_mfma_f32_32x32x16_bf16 v[32:47], v[88:91], v[8:11], v[16:31]
    ds_read_b128 v[92:95], v5 offset:7680
    v_exp_f32 v48, v48
    v_exp_f32 v49, v49
    v_exp_f32 v50, v50
    v_exp_f32 v51, v51
    v_exp_f32 v52, v52
    v_mfma_f32_32x32x16_bf16 v[72:87], v[108:111], v[68:71], v[72:87]
    s_mov_b64 exec, s[40:41]
    ds_read_b128 v[104:107], v7 offset:5120
    ds_read_b128 v[108:111], v7 offset:5760
    s_mov_b64 exec, -1
    v_exp_f32 v53, v53
    v_exp_f32 v54, v54
    v_exp_f32 v55, v55
    v_cvt_pk_bf16_f32 v64, v48, v49
    v_cvt_pk_bf16_f32 v65, v50, v51
    v_cvt_pk_bf16_f32 v66, v52, v53
    v_cvt_pk_bf16_f32 v67, v54, v55
    v_mfma_f32_32x32x8_bf16 v[32:47], v[96:97], v[12:13], v[32:47]
    v_exp_f32 v56, v56
    v_exp_f32 v57, v57
    v_exp_f32 v58, v58
    v_exp_f32 v59, v59
    v_exp_f32 v60, v60
    v_mfma_f32_32x32x16_bf16 v[72:87], v[112:115], v[64:67], v[72:87]
    v_exp_f32 v61, v61
    v_exp_f32 v62, v62
    v_exp_f32 v63, v63
    v_cvt_pk_bf16_f32 v68, v56, v57
    v_cvt_pk_bf16_f32 v69, v58, v59
    v_cvt_pk_bf16_f32 v70, v60, v61
    v_cvt_pk_bf16_f32 v71, v62, v63
    s_waitcnt lgkmcnt(0)
    v_mfma_f32_32x32x16_bf16 v[48:63], v[92:95], v[8:11], v[16:31]
    ds_read_b128 v[88:91], v5 offset:10240
    v_exp_f32 v32, v32
    v_exp_f32 v33, v33
    v_exp_f32 v34, v34
    v_exp_f32 v35, v35
    v_exp_f32 v36, v36
    v_mfma_f32_32x32x16_bf16 v[72:87], v[116:119], v[68:71], v[72:87]
    s_mov_b64 exec, s[40:41]
    ds_read_b128 v[112:115], v7 offset:7680
    ds_read_b128 v[116:119], v7 offset:8320
    s_mov_b64 exec, -1
    v_exp_f32 v37, v37
    v_exp_f32 v38, v38
    v_exp_f32 v39, v39
    v_cvt_pk_bf16_f32 v64, v32, v33
    v_cvt_pk_bf16_f32 v65, v34, v35
    v_cvt_pk_bf16_f32 v66, v36, v37
    v_cvt_pk_bf16_f32 v67, v38, v39
    v_mfma_f32_32x32x8_bf16 v[48:63], v[98:99], v[12:13], v[48:63]
    ds_read_b128 v[96:99], v6 offset:10240
    v_exp_f32 v40, v40
    v_exp_f32 v41, v41
    v_exp_f32 v42, v42
    v_exp_f32 v43, v43
    v_exp_f32 v44, v44
    v_mfma_f32_32x32x16_bf16 v[72:87], v[104:107], v[64:67], v[72:87]
    v_exp_f32 v45, v45
    v_exp_f32 v46, v46
    v_exp_f32 v47, v47
    v_cvt_pk_bf16_f32 v68, v40, v41
    v_cvt_pk_bf16_f32 v69, v42, v43
    v_cvt_pk_bf16_f32 v70, v44, v45
    v_cvt_pk_bf16_f32 v71, v46, v47
    s_waitcnt lgkmcnt(0)
    v_mfma_f32_32x32x16_bf16 v[32:47], v[88:91], v[8:11], v[16:31]
    ds_read_b128 v[92:95], v5 offset:12800
    v_exp_f32 v48, v48
    v_exp_f32 v49, v49
    v_exp_f32 v50, v50
    v_exp_f32 v51, v51
    v_exp_f32 v52, v52
    v_mfma_f32_32x32x16_bf16 v[72:87], v[108:111], v[68:71], v[72:87]
    s_mov_b64 exec, s[40:41]
    ds_read_b128 v[104:107], v7 offset:10240
    ds_read_b128 v[108:111], v7 offset:10880
    s_mov_b64 exec, -1
    v_exp_f32 v53, v53
    v_exp_f32 v54, v54
    v_exp_f32 v55, v55
    v_cvt_pk_bf16_f32 v64, v48, v49
    v_cvt_pk_bf16_f32 v65, v50, v51
    v_cvt_pk_bf16_f32 v66, v52, v53
    v_cvt_pk_bf16_f32 v67, v54, v55
    v_mfma_f32_32x32x8_bf16 v[32:47], v[96:97], v[12:13], v[32:47]
    v_exp_f32 v56, v56
    v_exp_f32 v57, v57
    v_exp_f32 v58, v58
    v_exp_f32 v59, v59
    v_exp_f32 v60, v60
    v_mfma_f32_32x32x16_bf16 v[72:87], v[112:115], v[64:67], v[72:87]
    v_exp_f32 v61, v61
    v_exp_f32 v62, v62
    v_exp_f32 v63, v63
    v_cvt_pk_bf16_f32 v68, v56, v57
    v_cvt_pk_bf16_f32 v69, v58, v59
    v_cvt_pk_bf16_f32 v70, v60, v61
    v_cvt_pk_bf16_f32 v71, v62, v63
    s_cmp_eq_u32 s46, 0
    s_cbranch_scc1 L_attn0_kernel_s2
L_attn0_kernel_s2r:
    s_waitcnt lgkmcnt(0)
    v_mfma_f32_32x32x16_bf16 v[48:63], v[92:95], v[8:11], v[16:31]
    ds_read_b128 v[88:91], v5 offset:15360
    v_exp_f32 v32, v32
    v_exp_f32 v33, v33
    v_exp_f32 v34, v34
    v_exp_f32 v35, v35
    v_exp_f32 v36, v36
    v_mfma_f32_32x32x16_bf16 v[72:87], v[116:119], v[68:71], v[72:87]
    s_mov_b64 exec, s[40:41]
    ds_read_b128 v[112:115], v7 offset:12800
    ds_read_b128 v[116:119], v7 offset:13440
    s_mov_b64 exec, -1
    v_exp_f32 v37, v37
    v_exp_f32 v38, v38
    v_exp_f32 v39, v39
    v_cvt_pk_bf16_f32 v64, v32, v33
    v_cvt_pk_bf16_f32 v65, v34, v35
    v_cvt_pk_bf16_f32 v66, v36, v37
    v_cvt_pk_bf16_f32 v67, v38, v39
    v_mfma_f32_32x32x8_bf16 v[48:63], v[98:99], v[12:13], v[48:63]
    ds_read_b128 v[96:99], v6 offset:15360
    v_exp_f32 v40, v40
    v_exp_f32 v41, v41
    v_exp_f32 v42, v42
    v_exp_f32 v43, v43
    v_exp_f32 v44, v44
    v_mfma_f32_32x32x16_bf16 v[72:87], v[104:107], v[64:67], v[72:87]
    v_exp_f32 v45, v45
    v_exp_f32 v46, v46
    v_exp_f32 v47, v47
    v_cvt_pk_bf16_f32 v68, v40, v41
    v_cvt_pk_bf16_f32 v69, v42, v43
    v_cvt_pk_bf16_f32 v70, v44, v45
    v_cvt_pk_bf16_f32 v71, v46, v47
    s_waitcnt lgkmcnt(0)
    v_mfma_f32_32x32x16_bf16 v[32:47], v[88:91], v[8:11], v[16:31]
    ds_read_b128 v[92:95], v5 offset:17920
    v_exp_f32 v48, v48
    v_exp_f32 v49, v49
    v_exp_f32 v50, v50
    v_exp_f32 v51, v51
    v_exp_f32 v52, v52
    v_mfma_f32_32x32x16_bf16 v[72:87], v[108:111], v[68:71], v[72:87]
    s_mov_b64 exec, s[40:41]
    ds_read_b128 v[104:107], v7 offset:15360
    ds_read_b128 v[108:111], v7 offset:16000
    s_mov_b64 exec, -1
    v_exp_f32 v53, v53
    v_exp_f32 v54, v54
    v_exp_f32 v55, v55
    v_cvt_pk_bf16_f32 v64, v48, v49
    v_cvt_pk_bf16_f32 v65, v50, v51
    v_cvt_pk_bf16_f32 v66, v52, v53
    v_cvt_pk_bf16_f32 v67, v54, v55
    v_mfma_f32_32x32x8_bf16 v[32:47], v[96:97], v[12:13], v[32:47]
    v_exp_f32 v56, v56
    v_exp_f32 v57, v57
    v_exp_f32 v58, v58
    v_exp_f32 v59, v59
    v_exp_f32 v60, v60
    v_mfma_f32_32x32x16_bf16 v[72:87], v[112:115], v[64:67], v[72:87]
    v_exp_f32 v61, v61
    v_exp_f32 v62, v62
    v_exp_f32 v63, v63
    v_cvt_pk_bf16_f32 v68, v56, v57
    v_cvt_pk_bf16_f32 v69, v58, v59
    v_cvt_pk_bf16_f32 v70, v60, v61
    v_cvt_pk_bf16_f32 v71, v62, v63
    s_waitcnt lgkmcnt(0)
    v_mfma_f32_32x32x16_bf16 v[48:63], v[92:95], v[8:11], v[16:31]
    ds_read_b128 v[88:91], v5 offset:20480
    v_exp_f32 v32, v32
    v_exp_f32 v33, v33
    v_exp_f32 v34, v34
    v_exp_f32 v35, v35
    v_exp_f32 v36, v36
    v_mfma_f32_32x32x16_bf16 v[72:87], v[116:119], v[68:71], v[72:87]
    s_mov_b64 exec, s[40:41]
    ds_read_b128 v[112:115], v7 offset:17920
    ds_read_b128 v[116:119], v7 offset:18560
    s_mov_b64 exec, -1
    v_exp_f32 v37, v37
    v_exp_f32 v38, v38
    v_exp_f32 v39, v39
    v_cvt_pk_bf16_f32 v64, v32, v33
    v_cvt_pk_bf16_f32 v65, v34, v35
    v_cvt_pk_bf16_f32 v66, v36, v37
    v_cvt_pk_bf16_f32 v67, v38, v39
    v_mfma_f32_32x32x8_bf16 v[48:63], v[98:99], v[12:13], v[48:63]
    ds_read_b128 v[96:99], v6 offset:20480
    v_exp_f32 v40, v40
    v_exp_f32 v41, v41
    v_exp_f32 v42, v42
    v_exp_f32 v43, v43
    v_exp_f32 v44, v44
    v_mfma_f32_32x32x16_bf16 v[72:87], v[104:107], v[64:67], v[72:87]
    v_exp_f32 v45, v45
    v_exp_f32 v46, v46
    v_exp_f32 v47, v47
    v_cvt_pk_bf16_f32 v68, v40, v41
    v_cvt_pk_bf16_f32 v69, v42, v43
    v_cvt_pk_bf16_f32 v70, v44, v45
    v_cvt_pk_bf16_f32 v71, v46, v47
    s_waitcnt lgkmcnt(0)
    v_mfma_f32_32x32x16_bf16 v[32:47], v[88:91], v[8:11], v[16:31]
    ds_read_b128 v[92:95], v5 offset:23040
    v_exp_f32 v48, v48
    v_exp_f32 v49, v49
    v_exp_f32 v50, v50
    v_exp_f32 v51, v51
    v_exp_f32 v52, v52
    v_mfma_f32_32x32x16_bf16 v[72:87], v[108:111], v[68:71], v[72:87]
    s_mov_b64 exec, s[40:41]
    ds_read_b128 v[104:107], v7 offset:20480
    ds_read_b128 v[108:111], v7 offset:21120
    s_mov_b64 exec, -1
    v_exp_f32 v53, v53
    v_exp_f32 v54, v54
    v_exp_f32 v55, v55
    v_cvt_pk_bf16_f32 v64, v48, v49
    v_cvt_pk_bf16_f32 v65, v50, v51
    v_cvt_pk_bf16_f32 v66, v52, v53
    v_cvt_pk_bf16_f32 v67, v54, v55
    v_mfma_f32_32x32x8_bf16 v[32:47], v[96:97], v[12:13], v[32:47]
    v_exp_f32 v56, v56
    v_exp_f32 v57, v57
    v_exp_f32 v58, v58
    v_exp_f32 v59, v59
    v_exp_f32 v60, v60
    v_mfma_f32_32x32x16_bf16 v[72:87], v[112:115], v[64:67], v[72:87]
    v_exp_f32 v61, v61
    v_exp_f32 v62, v62
    v_exp_f32 v63, v63
    v_cvt_pk_bf16_f32 v68, v56, v57
    v_cvt_pk_bf16_f32 v69, v58, v59
    v_cvt_pk_bf16_f32 v70, v60, v61
    v_cvt_pk_bf16_f32 v71, v62, v63
    s_waitcnt lgkmcnt(0)
    v_mfma_f32_32x32x16_bf16 v[48:63], v[92:95], v[8:11], v[16:31]
    ds_read_b128 v[88:91], v5 offset:25600
    v_exp_f32 v32, v32
    v_exp_f32 v33, v33
    v_exp_f32 v34, v34
    v_exp_f32 v35, v35
    v_exp_f32 v36, v36
    v_mfma_f32_32x32x16_bf16 v[72:87], v[116:119], v[68:71], v[72:87]
    s_mov_b64 exec, s[40:41]
    ds_read_b128 v[112:115], v7 offset:23040
    ds_read_b128 v[116:119], v7 offset:23680
    s_mov_b64 exec, -1
    v_exp_f32 v37, v37
    v_exp_f32 v38, v38
    v_exp_f32 v39, v39
    v_cvt_pk_bf16_f32 v64, v32, v33
    v_cvt_pk_bf16_f32 v65, v34, v35
    v_cvt_pk_bf16_f32 v66, v36, v37
    v_cvt_pk_bf16_f32 v67, v38, v39
    v_mfma_f32_32x32x8_bf16 v[48:63], v[98:99], v[12:13], v[48:63]
    ds_read_b128 v[96:99], v6 offset:25600
    v_exp_f32 v40, v40
    v_exp_f32 v41, v41
    v_exp_f32 v42, v42
    v_exp_f32 v43, v43
    v_exp_f32 v44, v44
    v_mfma_f32_32x32x16_bf16 v[72:87], v[104:107], v[64:67], v[72:87]
    v_exp_f32 v45, v45
    v_exp_f32 v46, v46
    v_exp_f32 v47, v47
    v_cvt_pk_bf16_f32 v68, v40, v41
    v_cvt_pk_bf16_f32 v69, v42, v43
    v_cvt_pk_bf16_f32 v70, v44, v45
    v_cvt_pk_bf16_f32 v71, v46, v47
    s_waitcnt lgkmcnt(0)
    v_mfma_f32_32x32x16_bf16 v[32:47], v[88:91], v[8:11], v[16:31]
    ds_read_b128 v[92:95], v5 offset:28160
    v_exp_f32 v48, v48
    v_exp_f32 v49, v49
    v_exp_f32 v50, v50
    v_exp_f32 v51, v51
    v_exp_f32 v52, v52
    v_mfma_f32_32x32x16_bf16 v[72:87], v[108:111], v[68:71], v[72:87]
    s_mov_b64 exec, s[40:41]
    ds_read_b128 v[104:107], v7 offset:25600
    ds_read_b128 v[108:111], v7 offset:26240
    s_mov_b64 exec, -1
    v_exp_f32 v53, v53
    v_exp_f32 v54, v54
    v_exp_f32 v55, v55
    v_cvt_pk_bf16_f32 v64, v48, v49
    v_cvt_pk_bf16_f32 v65, v50, v51
    v_cvt_pk_bf16_f32 v66, v52, v53
    v_cvt_pk_bf16_f32 v67, v54, v55
    v_mfma_f32_32x32x8_bf16 v[32:47], v[96:97], v[12:13], v[32:47]
    v_exp_f32 v56, v56
    v_exp_f32 v57, v57
    v_exp_f32 v58, v58
    v_exp_f32 v59, v59
    v_exp_f32 v60, v60
    v_mfma_f32_32x32x16_bf16 v[72:87], v[112:115], v[64:67], v[72:87]
    v_exp_f32 v61, v61
    v_exp_f32 v62, v62
    v_exp_f32 v63, v63
    v_cvt_pk_bf16_f32 v68, v56, v57
    v_cvt_pk_bf16_f32 v69, v58, v59
    v_cvt_pk_bf16_f32 v70, v60, v61
    v_cvt_pk_bf16_f32 v71, v62, v63
    s_waitcnt lgkmcnt(0)
    v_mfma_f32_32x32x16_bf16 v[48:63], v[92:95], v[8:11], v[16:31]
    ds_read_b128 v[88:91], v5 offset:30720
    v_exp_f32 v32, v32
    v_exp_f32 v33, v33
    v_exp_f32 v34, v34
    v_exp_f32 v35, v35
    v_exp_f32 v36, v36
    v_mfma_f32_32x32x16_bf16 v[72:87], v[116:119], v[68:71], v[72:87]
    s_mov_b64 exec, s[40:41]
    ds_read_b128 v[112:115], v7 offset:28160
    ds_read_b128 v[116:119], v7 offset:28800
    s_mov_b64 exec, -1
    v_exp_f32 v37, v37
    v_exp_f32 v38, v38
    v_exp_f32 v39, v39
    v_cvt_pk_bf16_f32 v64, v32, v33
    v_cvt_pk_bf16_f32 v65, v34, v35
    v_cvt_pk_bf16_f32 v66, v36, v37
    v_cvt_pk_bf16_f32 v67, v38, v39
    v_mfma_f32_32x32x8_bf16 v[48:63], v[98:99], v[12:13], v[48:63]
    ds_read_b128 v[96:99], v6 offset:30720
    v_exp_f32 v40, v40
    v_exp_f32 v41, v41
    v_exp_f32 v42, v42
    v_exp_f32 v43, v43
    v_exp_f32 v44, v44
    v_mfma_f32_32x32x16_bf16 v[72:87], v[104:107], v[64:67], v[72:87]
    v_exp_f32 v45, v45
    v_exp_f32 v46, v46
    v_exp_f32 v47, v47
    v_cvt_pk_bf16_f32 v68, v40, v41
    v_cvt_pk_bf16_f32 v69, v42, v43
    v_cvt_pk_bf16_f32 v70, v44, v45
    v_cvt_pk_bf16_f32 v71, v46, v47
    s_waitcnt lgkmcnt(0)
    v_mfma_f32_32x32x16_bf16 v[32:47], v[88:91], v[8:11], v[16:31]
    ds_read_b128 v[92:95], v5 offset:33280
    v_exp_f32 v48, v48
    v_exp_f32 v49, v49
    v_exp_f32 v50, v50
    v_exp_f32 v51, v51
    v_exp_f32 v52, v52
    v_mfma_f32_32x32x16_bf16 v[72:87], v[108:111], v[68:71], v[72:87]
    s_mov_b64 exec, s[40:41]
    ds_read_b128 v[104:107], v7 offset:30720
    ds_read_b128 v[108:111], v7 offset:31360
    s_mov_b64 exec, -1
    v_exp_f32 v53, v53
    v_exp_f32 v54, v54
    v_exp_f32 v55, v55
    v_cvt_pk_bf16_f32 v64, v48, v49
    v_cvt_pk_bf16_f32 v65, v50, v51
    v_cvt_pk_bf16_f32 v66, v52, v53
    v_cvt_pk_bf16_f32 v67, v54, v55
    v_mfma_f32_32x32x8_bf16 v[32:47], v[96:97], v[12:13], v[32:47]
    v_exp_f32 v56, v56
    v_exp_f32 v57, v57
    v_exp_f32 v58, v58
    v_exp_f32 v59, v59
    v_exp_f32 v60, v60
    v_mfma_f32_32x32x16_bf16 v[72:87], v[112:115], v[64:67], v[72:87]
    v_exp_f32 v61, v61
    v_exp_f32 v62, v62
    v_exp_f32 v63, v63
    v_cvt_pk_bf16_f32 v68, v56, v57
    v_cvt_pk_bf16_f32 v69, v58, v59
    v_cvt_pk_bf16_f32 v70, v60, v61
    v_cvt_pk_bf16_f32 v71, v62, v63
    s_cmp_eq_u32 s46, 0
    s_cbranch_scc1 L_attn0_kernel_s3
L_attn0_kernel_s3r:
    s_waitcnt lgkmcnt(0)
    v_mfma_f32_32x32x16_bf16 v[48:63], v[92:95], v[8:11], v[16:31]
    ds_read_b128 v[88:91], v5 offset:35840
    v_exp_f32 v32, v32
    v_exp_f32 v33, v33
    v_exp_f32 v34, v34
    v_exp_f32 v35, v35
    v_exp_f32 v36, v36
    v_mfma_f32_32x32x16_bf16 v[72:87], v[116:119], v[68:71], v[72:87]
    s_mov_b64 exec, s[40:41]
    ds_read_b128 v[112:115], v7 offset:33280
    ds_read_b128 v[116:119], v7 offset:33920
    s_mov_b64 exec, -1
    v_exp_f32 v37, v37
    v_exp_f32 v38, v38
    v_exp_f32 v39, v39
    v_cvt_pk_bf16_f32 v64, v32, v33
    v_cvt_pk_bf16_f32 v65, v34, v35
    v_cvt_pk_bf16_f32 v66, v36, v37
    v_cvt_pk_bf16_f32 v67, v38, v39
    v_mfma_f32_32x32x8_bf16 v[48:63], v[98:99], v[12:13], v[48:63]
    ds_read_b128 v[96:99], v6 offset:35840
    v_exp_f32 v40, v40
    v_exp_f32 v41, v41
    v_exp_f32 v42, v42
    v_exp_f32 v43, v43
    v_exp_f32 v44, v44
    v_mfma_f32_32x32x16_bf16 v[72:87], v[104:107], v[64:67], v[72:87]
    v_exp_f32 v45, v45
    v_exp_f32 v46, v46
    v_exp_f32 v47, v47
    v_cvt_pk_bf16_f32 v68, v40, v41
    v_cvt_pk_bf16_f32 v69, v42, v43
    v_cvt_pk_bf16_f32 v70, v44, v45
    v_cvt_pk_bf16_f32 v71, v46, v47
    s_waitcnt lgkmcnt(0)
    v_mfma_f32_32x32x16_bf16 v[32:47], v[88:91], v[8:11], v[16:31]
    ds_read_b128 v[92:95], v5 offset:38400
    v_exp_f32 v48, v48
    v_exp_f32 v49, v49
    v_exp_f32 v50, v50
    v_exp_f32 v51, v51
    v_exp_f32 v52, v52
    v_mfma_f32_32x32x16_bf16 v[72:87], v[108:111], v[68:71], v[72:87]
    s_mov_b64 exec, s[40:41]
    ds_read_b128 v[104:107], v7 offset:35840
    ds_read_b128 v[108:111], v7 offset:36480
    s_mov_b64 exec, -1
    v_exp_f32 v53, v53
    v_exp_f32 v54, v54
    v_exp_f32 v55, v55
    v_cvt_pk_bf16_f32 v64, v48, v49
    v_cvt_pk_bf16_f32 v65, v50, v51
    v_cvt_pk_bf16_f32 v66, v52, v53
    v_cvt_pk_bf16_f32 v67, v54, v55
    v_mfma_f32_32x32x8_bf16 v[32:47], v[96:97], v[12:13], v[32:47]
    v_exp_f32 v56, v56
    v_exp_f32 v57, v57
    v_exp_f32 v58, v58
    v_exp_f32 v59, v59
    v_exp_f32 v60, v60
    v_mfma_f32_32x32x16_bf16 v[72:87], v[112:115], v[64:67], v[72:87]
    v_exp_f32 v61, v61
    v_exp_f32 v62, v62
    v_exp_f32 v63, v63
    v_cvt_pk_bf16_f32 v68, v56, v57
    v_cvt_pk_bf16_f32 v69, v58, v59
    v_cvt_pk_bf16_f32 v70, v60, v61
    v_cvt_pk_bf16_f32 v71, v62, v63
    s_waitcnt lgkmcnt(0)
    v_mfma_f32_32x32x16_bf16 v[48:63], v[92:95], v[8:11], v[16:31]
    ds_read_b128 v[88:91], v5 offset:40960
    v_exp_f32 v32, v32
    v_exp_f32 v33, v33
    v_exp_f32 v34, v34
    v_exp_f32 v35, v35
    v_exp_f32 v36, v36
    v_mfma_f32_32x32x16_bf16 v[72:87], v[116:119], v[68:71], v[72:87]
    s_mov_b64 exec, s[40:41]
    ds_read_b128 v[112:115], v7 offset:38400
    ds_read_b128 v[116:119], v7 offset:39040
    s_mov_b64 exec, -1
    v_exp_f32 v37, v37
    v_exp_f32 v38, v38
    v_exp_f32 v39, v39
    v_cvt_pk_bf16_f32 v64, v32, v33
    v_cvt_pk_bf16_f32 v65, v34, v35
    v_cvt_pk_bf16_f32 v66, v36, v37
    v_cvt_pk_bf16_f32 v67, v38, v39
    v_mfma_f32_32x32x8_bf16 v[48:63], v[98:99], v[12:13], v[48:63]
    ds_read_b128 v[96:99], v6 offset:40960
    v_exp_f32 v40, v40
    v_exp_f32 v41, v41
    v_exp_f32 v42, v42
    v_exp_f32 v43, v43
    v_exp_f32 v44, v44
    v_mfma_f32_32x32x16_bf16 v[72:87], v[104:107], v[64:67], v[72:87]
    v_exp_f32 v45, v45
    v_exp_f32 v46, v46
    v_exp_f32 v47, v47
    v_cvt_pk_bf16_f32 v68, v40, v41
    v_cvt_pk_bf16_f32 v69, v42, v43
    v_cvt_pk_bf16_f32 v70, v44, v45
    v_cvt_pk_bf16_f32 v71, v46, v47
    s_waitcnt lgkmcnt(0)
    v_mfma_f32_32x32x16_bf16 v[32:47], v[88:91], v[8:11], v[16:31]
    ds_read_b128 v[92:95], v5 offset:43520
    v_exp_f32 v48, v48
    v_exp_f32 v49, v49
    v_exp_f32 v50, v50
    v_exp_f32 v51, v51
    v_exp_f32 v52, v52
    v_mfma_f32_32x32x16_bf16 v[72:87], v[108:111], v[68:71], v[72:87]
    s_mov_b64 exec, s[40:41]
    ds_read_b128 v[104:107], v7 offset:40960
    ds_read_b128 v[108:111], v7 offset:41600
    s_mov_b64 exec, -1
    v_exp_f32 v53, v53
    v_exp_f32 v54, v54
    v_exp_f32 v55, v55
    v_cvt_pk_bf16_f32 v64, v48, v49
    v_cvt_pk_bf16_f32 v65, v50, v51
    v_cvt_pk_bf16_f32 v66, v52, v53
    v_cvt_pk_bf16_f32 v67, v54, v55
    v_mfma_f32_32x32x8_bf16 v[32:47], v[96:97], v[12:13], v[32:47]
    v_exp_f32 v56, v56
    v_exp_f32 v57, v57
    v_exp_f32 v58, v58
    v_exp_f32 v59, v59
    v_exp_f32 v60, v60
    v_mfma_f32_32x32x16_bf16 v[72:87], v[112:115], v[64:67], v[72:87]
    v_exp_f32 v61, v61
    v_exp_f32 v62, v62
    v_exp_f32 v63, v63
    v_cvt_pk_bf16_f32 v68, v56, v57
    v_cvt_pk_bf16_f32 v69, v58, v59
    v_cvt_pk_bf16_f32 v70, v60, v61
    v_cvt_pk_bf16_f32 v71, v62, v63
    v_add_u32 v5, 40960, v5
    v_add_u32 v6, 40960, v6
    v_add_u32 v7, 40960, v7
    s_add_u32 s45, s45, 1
    s_cmp_lt_u32 s45, 2
    s_cbranch_scc1 L_attn0_kernel_loop_3
    v_mfma_f32_32x32x16_bf16 v[72:87], v[116:119], v[68:71], v[72:87]
    s_waitcnt lgkmcnt(0)
    v_subrev_u32 v5, 81920, v5
    v_subrev_u32 v6, 81920, v6
    v_subrev_u32 v7, 81920, v7
    s_nop 15
    s_mov_b32 s46, 0x4e800000
    v_cmp_gt_f32 vcc, s46, v80
    s_nop 1
    s_cmp_eq_u32 vcc_hi, -1
    s_cbranch_scc1 L_attn0_kernel_fin
    s_cmp_lg_u32 s44, 0
    s_cbranch_scc1 L_attn0_kernel_fin
    s_mov_b32 s44, 1
    v_mov_b32 v4, 0xff800000
    s_mov_b32 s45, 0
L_attn0_kernel_fb_4:
    ds_read_b128 v[88:91], v5 offset:0
    ds_read_b128 v[96:99], v6 offset:0
    ds_read_b128 v[92:95], v5 offset:2560
    s_waitcnt lgkmcnt(0)
    v_mfma_f32_32x32x16_bf16 v[32:47], v[88:91], v[8:11], 0
    v_mfma_f32_32x32x8_bf16 v[32:47], v[96:97], v[12:13], v[32:47]
    v_mfma_f32_32x32x16_bf16 v[48:63], v[92:95], v[8:11], 0
    v_mfma_f32_32x32x8_bf16 v[48:63], v[98:99], v[12:13], v[48:63]
    s_nop 15
    v_max3_f32 v4, v4, v32, v33
    v_max3_f32 v4, v4, v34, v35
    v_max3_f32 v4, v4, v36, v37
    v_max3_f32 v4, v4, v38, v39
    v_max3_f32 v4, v4, v40, v41
    v_max3_f32 v4, v4, v42, v43
    v_max3_f32 v4, v4, v44, v45
    v_max3_f32 v4, v4, v46, v47
    v_max3_f32 v4, v4, v48, v49
    v_max3_f32 v4, v4, v50, v51
    v_max3_f32 v4, v4, v52, v53
    v_max3_f32 v4, v4, v54, v55
    v_max3_f32 v4, v4, v56, v57
    v_max3_f32 v4, v4, v58, v59
    v_max3_f32 v4, v4, v60, v61
    v_max3_f32 v4, v4, v62, v63
    v_add_u32 v5, 5120, v5
    v_add_u32 v6, 5120, v6
    s_add_u32 s45, s45, 1
    s_cmp_lt_u32 s45, 16
    s_cbranch_scc1 L_attn0_kernel_fb_4
    v_subrev_u32 v5, 81920, v5
    v_subrev_u32 v6, 81920, v6
    v_mov_b32 v3, v4
    s_nop 1
    v_permlane32_swap_b32 v4, v3
    s_nop 1
    v_max_f32 v4, v4, v3
    v_sub_f32 v16, 0, v4
    v_mov_b32 v17, v16
    v_mov_b32 v18, v16
    v_mov_b32 v19, v16
    v_mov_b32 v20, v16
    v_mov_b32 v21, v16
    v_mov_b32 v22, v16
    v_mov_b32 v23, v16
    v_mov_b32 v24, v16
    v_mov_b32 v25, v16
    v_mov_b32 v26, v16
    v_mov_b32 v27, v16
    v_mov_b32 v28, v16
    v_mov_b32 v29, v16
    v_mov_b32 v30, v16
    v_mov_b32 v31, v16
    v_mov_b32 v72, 0
    v_mov_b32 v73, 0
    v_mov_b32 v74, 0
    v_mov_b32 v75, 0
    v_mov_b32 v76, 0
    v_mov_b32 v77, 0
    v_mov_b32 v78, 0
    v_mov_b32 v79, 0
    v_mov_b32 v80, 0
    v_mov_b32 v81, 0
    v_mov_b32 v82, 0
    v_mov_b32 v83, 0
    v_mov_b32 v84, 0
    v_mov_b32 v85, 0
    v_mov_b32 v86, 0
    v_mov_b32 v87, 0
    v_mov_b32 v68, 0
    v_mov_b32 v69, 0
    v_mov_b32 v70, 0
    v_mov_b32 v71, 0
    s_mov_b32 s45, 0
    ds_read_b128 v[88:91], v5 offset:0
    ds_read_b128 v[96:99], v6 offset:0
    ds_read_b128 v[92:95], v5 offset:2560
    s_mov_b64 exec, s[40:41]
    ds_read_b128 v[104:107], v7 offset:0
    ds_read_b128 v[108:111], v7 offset:640
    s_mov_b64 exec, -1
    s_waitcnt lgkmcnt(3)
    v_mfma_f32_32x32x16_bf16 v[32:47], v[88:91], v[8:11], v[16:31]
    v_mfma_f32_32x32x8_bf16 v[32:47], v[96:97], v[12:13], v[32:47]
    s_branch L_attn0_kernel_main_2
L_attn0_kernel_s2:
    s_waitcnt vmcnt(0)
    s_barrier
    s_cmp_lg_u32 s48, 0
    s_cbranch_scc1 L_attn0_kernel_s2r
    s_mov_b32 m0, s37
    s_add_u32 s37, s37, 2048
    buffer_load_dwordx4 v123, s[8:11], s36 offen lds
    s_add_u32 s36, s36, 2048
    s_mov_b32 m0, s37
    s_add_u32 s37, s37, 2048
    buffer_load_dwordx4 v123, s[8:11], s36 offen lds
    s_add_u32 s36, s36, 2048
    s_mov_b32 m0, s37
    s_add_u32 s37, s37, 2048
    buffer_load_dwordx4 v123, s[8:11], s36 offen lds
    s_add_u32 s36, s36, 2048
    s_mov_b32 m0, s37
    s_add_u32 s37, s37, 2048
    buffer_load_dwordx4 v123, s[8:11], s36 offen lds
    s_add_u32 s36, s36, 2048
    s_mov_b32 m0, s37
    s_add_u32 s37, s37, 2048
    buffer_load_dwordx4 v123, s[8:11], s36 offen lds
    s_add_u32 s36, s36, 2048
    s_mov_b32 m0, s37
    s_add_u32 s37, s37, 2048
    buffer_load_dwordx4 v123, s[8:11], s36 offen lds
    s_add_u32 s36, s36, 2048
    s_mov_b32 m0, s37
    s_add_u32 s37, s37, 2048
    buffer_load_dwordx4 v123, s[8:11], s36 offen lds
    s_add_u32 s36, s36, 2048
    s_mov_b32 m0, s37
    s_add_u32 s37, s37, 2048
    buffer_load_dwordx4 v123, s[8:11], s36 offen lds
    s_add_u32 s36, s36, 2048
    s_mov_b32 m0, s37
    s_add_u32 s37, s37, 2048
    buffer_load_dwordx4 v123, s[8:11], s36 offen lds
    s_add_u32 s36, s36, 2048
    s_mov_b32 m0, s37
    s_add_u32 s37, s37, 2048
    buffer_load_dwordx4 v123, s[8:11], s36 offen lds
    s_add_u32 s36, s36, 2048
    s_mov_b32 m0, s37
    s_add_u32 s37, s37, 2048
    buffer_load_dwordx4 v123, s[8:11], s36 offen lds
    s_add_u32 s36, s36, 2048
    s_mov_b32 m0, s37
    s_add_u32 s37, s37, 2048
    buffer_load_dwordx4 v123, s[8:11], s36 offen lds
    s_add_u32 s36, s36, 2048
    s_mov_b32 m0, s37
    s_add_u32 s37, s37, 2048
    buffer_load_dwordx4 v123, s[8:11], s36 offen lds
    s_add_u32 s36, s36, 2048
    s_mov_b32 m0, s37
    s_add_u32 s37, s37, 2048
    buffer_load_dwordx4 v123, s[8:11], s36 offen lds
    s_add_u32 s36, s36, 2048
    s_mov_b32 m0, s37
    s_add_u32 s37, s37, 2048
    buffer_load_dwordx4 v123, s[8:11], s36 offen lds
    s_add_u32 s36, s36, 2048
    s_mov_b32 m0, s37
    s_add_u32 s37, s37, 2048
    buffer_load_dwordx4 v123, s[8:11], s36 offen lds
    s_add_u32 s36, s36, 2048
    s_mov_b32 m0, s37
    s_add_u32 s37, s37, 2048
    buffer_load_dwordx4 v123, s[8:11], s36 offen lds
    s_add_u32 s36, s36, 2048
    s_mov_b32 m0, s37
    s_add_u32 s37, s37, 2048
    buffer_load_dwordx4 v123, s[8:11], s36 offen lds
    s_add_u32 s36, s36, 2048
    s_mov_b32 m0, s37
    s_add_u32 s37, s37, 2048
    buffer_load_dwordx4 v123, s[8:11], s36 offen lds
    s_add_u32 s36, s36, 2048
    s_mov_b32 m0, s37
    s_add_u32 s37, s37, 2048
    buffer_load_dwordx4 v123, s[8:11], s36 offen lds
    s_add_u32 s36, s36, 2048
    s_branch L_attn0_kernel_s2r
L_attn0_kernel_s3:
    s_waitcnt vmcnt(0)
    s_barrier
    s_branch L_attn0_kernel_s3r
L_attn0_kernel_fin:
    s_lshl_b32 s46, s35, 12
    v_add_u32 v5, s46, v123
    v_lshrrev_b32 v6, 2, v123
    v_add_u32 v6, s46, v6
    s_cmp_eq_u32 s49, 0
    s_cbranch_scc1 L_attn0_kernel_h0
    s_barrier
    ds_write_b128 v5, v[72:75]
    ds_write_b128 v5, v[76:79] offset:1024
    ds_write_b128 v5, v[80:83] offset:2048
    ds_write_b32 v6, v16 offset:3072
    s_waitcnt lgkmcnt(0)
    s_barrier
    s_endpgm
L_attn0_kernel_h0:
    s_lshl_b32 s52, s2, 3
    s_add_u32 s52, s52, s35
    s_add_u32 s53, s52, 0
    s_mul_i32 s54, s53, 0xaaab
    s_lshr_b32 s54, s54, 20
    s_mul_i32 s55, s54, 24
    s_sub_u32 s55, s53, s55
    s_cmp_ge_u32 s55, 12
    s_cselect_b32 s56, s26, s24
    s_cselect_b32 s57, s27, s25
    s_cselect_b32 s47, 12, 0
    s_mov_b32 s58, 0x1e0000
    s_mov_b32 s59, 0x00020000
    s_sub_u32 s55, s55, s47
    s_lshl_b32 s55, s55, 6
    v_add_u32 v3, s55, v1
    v_mul_u32_u24 v4, 0x1556, v3
    v_lshrrev_b32 v4, 16, v4
    v_mul_u32_u24 v48, 2880, v4
    v_lshl_add_u32 v48, v3, 4, v48
    s_mul_i32 s47, s54, 0xcd
    s_lshr_b32 s47, s47, 11
    s_mul_i32 s55, s47, 10
    s_sub_u32 s55, s54, s55
    s_mul_i32 s55, s55, 196608
    s_mul_i32 s47, s47, 192
    s_add_u32 s76, s55, s47
    s_cmp_ge_u32 s53, 3840
    s_cselect_b32 s76, 0x7f000000, s76
    buffer_load_dwordx4 v[32:35], v48, s[56:59], s76 offen
    s_add_u32 s53, s52, 2048
    s_mul_i32 s54, s53, 0xaaab
    s_lshr_b32 s54, s54, 20
    s_mul_i32 s55, s54, 24
    s_sub_u32 s55, s53, s55
    s_cmp_ge_u32 s55, 12
    s_cselect_b32 s60, s26, s24
    s_cselect_b32 s61, s27, s25
    s_cselect_b32 s47, 12, 0
    s_mov_b32 s62, 0x1e0000
    s_mov_b32 s63, 0x00020000
    s_sub_u32 s55, s55, s47
    s_lshl_b32 s55, s55, 6
    v_add_u32 v3, s55, v1
    v_mul_u32_u24 v4, 0x1556, v3
    v_lshrrev_b32 v4, 16, v4
    v_mul_u32_u24 v49, 2880, v4
    v_lshl_add_u32 v49, v3, 4, v49
    s_mul_i32 s47, s54, 0xcd
    s_lshr_b32 s47, s47, 11
    s_mul_i32 s55, s47, 10
    s_sub_u32 s55, s54, s55
    s_mul_i32 s55, s55, 196608
    s_mul_i32 s47, s47, 192
    s_add_u32 s77, s55, s47
    s_cmp_ge_u32 s53, 3840
    s_cselect_b32 s77, 0x7f000000, s77
    buffer_load_dwordx4 v[36:39], v49, s[60:63], s77 offen
    s_mov_b32 s53, s52
    s_mov_b32 s64, s22
    s_mov_b32 s65, s23
    s_mov_b32 s66, 0x1e0000
    s_mov_b32 s67, 0x00020000
    s_mul_i32 s54, s53, 0xcccd
    s_lshr_b32 s54, s54, 20
    s_mul_i32 s55, s54, 20
    s_sub_u32 s55, s53, s55
    s_lshl_b32 s55, s55, 6
    v_add_u32 v3, s55, v1
    v_mul_u32_u24 v4, 0x199a, v3
    v_lshrrev_b32 v4, 16, v4
    v_mul_u32_u24 v50, 1120, v4
    v_lshl_add_u32 v50, v3, 4, v50
    s_mul_i32 s47, s54, 171
    s_lshr_b32 s47, s47, 11
    s_mul_i32 s55, s47, 12
    s_sub_u32 s55, s54, s55
    s_mul_i32 s55, s55, 163840
    s_mul_i32 s47, s47, 160
    s_add_u32 s78, s55, s47
    s_cmp_ge_u32 s53, 1920
    s_cselect_b32 s78, 0x7f000000, s78
    buffer_load_dwordx4 v[40:43], v50, s[64:67], s78 offen
    s_sub_u32 s53, 2047, s52
    s_mov_b32 s68, s20
    s_mov_b32 s69, s21
    s_mov_b32 s70, 0xc8000
    s_mov_b32 s71, 0x00020000
    s_mul_i32 s54, s53, 0xcccd
    s_lshr_b32 s54, s54, 20
    s_mul_i32 s55, s54, 20
    s_sub_u32 s55, s53, s55
    s_lshl_b32 s55, s55, 6
    v_add_u32 v3, s55, v1
    v_mul_u32_u24 v4, 0x199a, v3
    v_lshrrev_b32 v4, 16, v4
    v_mul_u32_u24 v51, 1120, v4
    v_lshl_add_u32 v51, v3, 4, v51
    s_mul_i32 s47, s54, 205
    s_lshr_b32 s47, s47, 10
    s_mul_i32 s55, s47, 5
    s_sub_u32 s55, s54, s55
    s_mul_i32 s55, s55, 163840
    s_mul_i32 s47, s47, 160
    s_add_u32 s79, s55, s47
    s_cmp_ge_u32 s53, 800
    s_cselect_b32 s79, 0x7f000000, s79
    buffer_load_dwordx4 v[44:47], v51, s[68:71], s79 offen
    s_lshl_b32 s81, s53, 10
    s_lshl_b32 s80, s52, 10
    s_add_u32 s82, s80, 0x200000
    s_add_u32 s84, s28, 0x2400000
    s_addc_u32 s85, s29, 0
    s_mov_b32 s86, 0x3c0000
    s_mov_b32 s87, 0x00020000
    s_add_u32 s88, s28, 0x2900000
    s_addc_u32 s89, s29, 0
    s_mov_b32 s90, 0x1e0000
    s_mov_b32 s91, 0x00020000
    s_add_u32 s16, s28, 0x2800000
    s_addc_u32 s17, s29, 0
    s_mov_b32 s18, 0xc8000
    s_mov_b32 s19, 0x00020000
    s_lshl_b32 s53, s35, 5
    s_add_u32 s53, s53, s51
    s_cmp_ge_u32 s53, 48
    s_cbranch_scc1 L_attn0_kernel_ncs_5a
    s_mul_i32 s54, s50, 48
    s_add_u32 s53, s53, s54
    s_cmp_ge_u32 s53, 192
    s_cselect_b32 s56, s26, s24
    s_cselect_b32 s57, s27, s25
    s_cselect_b32 s54, 192, 0
    s_cselect_b32 s47, 384, 0
    s_mov_b32 s58, 0x1e0000
    s_mov_b32 s59, 0x00020000
    s_sub_u32 s53, s53, s54
    s_lshl_b32 s55, s53, 4
    v_mul_u32_u24 v3, 3072, v1
    buffer_load_dwordx4 v[88:91], v3, s[56:59], s55 offen
    s_add_u32 s55, s55, 196608
    buffer_load_dwordx4 v[92:95], v3, s[56:59], s55 offen
    s_add_u32 s55, s55, 196608
    buffer_load_dwordx4 v[96:99], v3, s[56:59], s55 offen
    s_add_u32 s55, s55, 196608
    buffer_load_dwordx4 v[100:103], v3, s[56:59], s55 offen
    s_add_u32 s55, s55, 196608
    buffer_load_dwordx4 v[104:107], v3, s[56:59], s55 offen
    s_add_u32 s55, s55, 196608
    buffer_load_dwordx4 v[108:111], v3, s[56:59], s55 offen
    s_add_u32 s55, s55, 196608
    buffer_load_dwordx4 v[112:115], v3, s[56:59], s55 offen
    s_add_u32 s55, s55, 196608
    buffer_load_dwordx4 v[116:119], v3, s[56:59], s55 offen
    s_add_u32 s55, s55, 196608
    buffer_load_dwordx4 v[64:67], v3, s[56:59], s55 offen
    s_add_u32 s55, s55, 196608
    buffer_load_dwordx4 v[68:71], v3, s[56:59], s55 offen
    s_add_u32 s55, s55, 196608
    s_mov_b32 s83, 1
    s_branch L_attn0_kernel_ncs_5b
L_attn0_kernel_ncs_5a:
    s_mov_b32 s83, 0
L_attn0_kernel_ncs_5b:
    s_waitcnt vmcnt(0)
    buffer_store_dwordx4 v[32:35], v123, s[84:87], s80 offen sc1
    buffer_store_dwordx4 v[36:39], v123, s[84:87], s82 offen sc1
    buffer_store_dwordx4 v[40:43], v123, s[88:91], s80 offen sc1
    buffer_store_dwordx4 v[44:47], v123, s[16:19], s81 offen sc1
    s_cmp_eq_u32 s83, 0
    s_cbranch_scc1 L_attn0_kernel_ncs_5
    v_mov_b32 v52, 0
    v_mov_b32 v53, 0
    v_mov_b32 v54, 0
    v_mov_b32 v55, 0
    v_mov_b32 v56, 0
    v_mov_b32 v57, 0
    v_mov_b32 v58, 0
    v_mov_b32 v59, 0
    v_lshlrev_b32 v60, 16, v88
    v_and_b32 v61, 0xffff0000, v88
    v_pk_add_f32 v[52:53], v[52:53], v[60:61]
    v_lshlrev_b32 v60, 16, v89
    v_and_b32 v61, 0xffff0000, v89
    v_pk_add_f32 v[54:55], v[54:55], v[60:61]
    v_lshlrev_b32 v60, 16, v90
    v_and_b32 v61, 0xffff0000, v90
    v_pk_add_f32 v[56:57], v[56:57], v[60:61]
    v_lshlrev_b32 v60, 16, v91
    v_and_b32 v61, 0xffff0000, v91
    v_pk_add_f32 v[58:59], v[58:59], v[60:61]
    v_lshlrev_b32 v60, 16, v92
    v_and_b32 v61, 0xffff0000, v92
    v_pk_add_f32 v[52:53], v[52:53], v[60:61]
    v_lshlrev_b32 v60, 16, v93
    v_and_b32 v61, 0xffff0000, v93
    v_pk_add_f32 v[54:55], v[54:55], v[60:61]
    v_lshlrev_b32 v60, 16, v94
    v_and_b32 v61, 0xffff0000, v94
    v_pk_add_f32 v[56:57], v[56:57], v[60:61]
    v_lshlrev_b32 v60, 16, v95
    v_and_b32 v61, 0xffff0000, v95
    v_pk_add_f32 v[58:59], v[58:59], v[60:61]
    v_lshlrev_b32 v60, 16, v96
    v_and_b32 v61, 0xffff0000, v96
    v_pk_add_f32 v[52:53], v[52:53], v[60:61]
    v_lshlrev_b32 v60, 16, v97
    v_and_b32 v61, 0xffff0000, v97
    v_pk_add_f32 v[54:55], v[54:55], v[60:61]
    v_lshlrev_b32 v60, 16, v98
    v_and_b32 v61, 0xffff0000, v98
    v_pk_add_f32 v[56:57], v[56:57], v[60:61]
    v_lshlrev_b32 v60, 16, v99
    v_and_b32 v61, 0xffff0000, v99
    v_pk_add_f32 v[58:59], v[58:59], v[60:61]
    v_lshlrev_b32 v60, 16, v100
    v_and_b32 v61, 0xffff0000, v100
    v_pk_add_f32 v[52:53], v[52:53], v[60:61]
    v_lshlrev_b32 v60, 16, v101
    v_and_b32 v61, 0xffff0000, v101
    v_pk_add_f32 v[54:55], v[54:55], v[60:61]
    v_lshlrev_b32 v60, 16, v102
    v_and_b32 v61, 0xffff0000, v102
    v_pk_add_f32 v[56:57], v[56:57], v[60:61]
    v_lshlrev_b32 v60, 16, v103
    v_and_b32 v61, 0xffff0000, v103
    v_pk_add_f32 v[58:59], v[58:59], v[60:61]
    v_lshlrev_b32 v60, 16, v104
    v_and_b32 v61, 0xffff0000, v104
    v_pk_add_f32 v[52:53], v[52:53], v[60:61]
    v_lshlrev_b32 v60, 16, v105
    v_and_b32 v61, 0xffff0000, v105
    v_pk_add_f32 v[54:55], v[54:55], v[60:61]
    v_lshlrev_b32 v60, 16, v106
    v_and_b32 v61, 0xffff0000, v106
    v_pk_add_f32 v[56:57], v[56:57], v[60:61]
    v_lshlrev_b32 v60, 16, v107
    v_and_b32 v61, 0xffff0000, v107
    v_pk_add_f32 v[58:59], v[58:59], v[60:61]
    v_lshlrev_b32 v60, 16, v108
    v_and_b32 v61, 0xffff0000, v108
    v_pk_add_f32 v[52:53], v[52:53], v[60:61]
    v_lshlrev_b32 v60, 16, v109
    v_and_b32 v61, 0xffff0000, v109
    v_pk_add_f32 v[54:55], v[54:55], v[60:61]
    v_lshlrev_b32 v60, 16, v110
    v_and_b32 v61, 0xffff0000, v110
    v_pk_add_f32 v[56:57], v[56:57], v[60:61]
    v_lshlrev_b32 v60, 16, v111
    v_and_b32 v61, 0xffff0000, v111
    v_pk_add_f32 v[58:59], v[58:59], v[60:61]
    v_lshlrev_b32 v60, 16, v112
    v_and_b32 v61, 0xffff0000, v112
    v_pk_add_f32 v[52:53], v[52:53], v[60:61]
    v_lshlrev_b32 v60, 16, v113
    v_and_b32 v61, 0xffff0000, v113
    v_pk_add_f32 v[54:55], v[54:55], v[60:61]
    v_lshlrev_b32 v60, 16, v114
    v_and_b32 v61, 0xffff0000, v114
    v_pk_add_f32 v[56:57], v[56:57], v[60:61]
    v_lshlrev_b32 v60, 16, v115
    v_and_b32 v61, 0xffff0000, v115
    v_pk_add_f32 v[58:59], v[58:59], v[60:61]
    v_lshlrev_b32 v60, 16, v116
    v_and_b32 v61, 0xffff0000, v116
    v_pk_add_f32 v[52:53], v[52:53], v[60:61]
    v_lshlrev_b32 v60, 16, v117
    v_and_b32 v61, 0xffff0000, v117
    v_pk_add_f32 v[54:55], v[54:55], v[60:61]
    v_lshlrev_b32 v60, 16, v118
    v_and_b32 v61, 0xffff0000, v118
    v_pk_add_f32 v[56:57], v[56:57], v[60:61]
    v_lshlrev_b32 v60, 16, v119
    v_and_b32 v61, 0xffff0000, v119
    v_pk_add_f32 v[58:59], v[58:59], v[60:61]
    v_lshlrev_b32 v60, 16, v64
    v_and_b32 v61, 0xffff0000, v64
    v_pk_add_f32 v[52:53], v[52:53], v[60:61]
    v_lshlrev_b32 v60, 16, v65
    v_and_b32 v61, 0xffff0000, v65
    v_pk_add_f32 v[54:55], v[54:55], v[60:61]
    v_lshlrev_b32 v60, 16, v66
    v_and_b32 v61, 0xffff0000, v66
    v_pk_add_f32 v[56:57], v[56:57], v[60:61]
    v_lshlrev_b32 v60, 16, v67
    v_and_b32 v61, 0xffff0000, v67
    v_pk_add_f32 v[58:59], v[58:59], v[60:61]
    v_lshlrev_b32 v60, 16, v68
    v_and_b32 v61, 0xffff0000, v68
    v_pk_add_f32 v[52:53], v[52:53], v[60:61]
    v_lshlrev_b32 v60, 16, v69
    v_and_b32 v61, 0xffff0000, v69
    v_pk_add_f32 v[54:55], v[54:55], v[60:61]
    v_lshlrev_b32 v60, 16, v70
    v_and_b32 v61, 0xffff0000, v70
    v_pk_add_f32 v[56:57], v[56:57], v[60:61]
    v_lshlrev_b32 v60, 16, v71
    v_and_b32 v61, 0xffff0000, v71
    v_pk_add_f32 v[58:59], v[58:59], v[60:61]
    s_nop 1
    v_add_f32_dpp v52, v52, v52 row_shr:1 row_mask:0xf bank_mask:0xf bound_ctrl:0
    v_add_f32_dpp v53, v53, v53 row_shr:1 row_mask:0xf bank_mask:0xf bound_ctrl:0
    v_add_f32_dpp v54, v54, v54 row_shr:1 row_mask:0xf bank_mask:0xf bound_ctrl:0
    v_add_f32_dpp v55, v55, v55 row_shr:1 row_mask:0xf bank_mask:0xf bound_ctrl:0
    v_add_f32_dpp v56, v56, v56 row_shr:1 row_mask:0xf bank_mask:0xf bound_ctrl:0
    v_add_f32_dpp v57, v57, v57 row_shr:1 row_mask:0xf bank_mask:0xf bound_ctrl:0
    v_add_f32_dpp v58, v58, v58 row_shr:1 row_mask:0xf bank_mask:0xf bound_ctrl:0
    v_add_f32_dpp v59, v59, v59 row_shr:1 row_mask:0xf bank_mask:0xf bound_ctrl:0
    s_nop 1
    v_add_f32_dpp v52, v52, v52 row_shr:2 row_mask:0xf bank_mask:0xf bound_ctrl:0
    v_add_f32_dpp v53, v53, v53 row_shr:2 row_mask:0xf bank_mask:0xf bound_ctrl:0
    v_add_f32_dpp v54, v54, v54 row_shr:2 row_mask:0xf bank_mask:0xf bound_ctrl:0
    v_add_f32_dpp v55, v55, v55 row_shr:2 row_mask:0xf bank_mask:0xf bound_ctrl:0
    v_add_f32_dpp v56, v56, v56 row_shr:2 row_mask:0xf bank_mask:0xf bound_ctrl:0
    v_add_f32_dpp v57, v57, v57 row_shr:2 row_mask:0xf bank_mask:0xf bound_ctrl:0
    v_add_f32_dpp v58, v58, v58 row_shr:2 row_mask:0xf bank_mask:0xf bound_ctrl:0
    v_add_f32_dpp v59, v59, v59 row_shr:2 row_mask:0xf bank_mask:0xf bound_ctrl:0
    s_nop 1
    v_add_f32_dpp v52, v52, v52 row_shr:4 row_mask:0xf bank_mask:0xf bound_ctrl:0
    v_add_f32_dpp v53, v53, v53 row_shr:4 row_mask:0xf bank_mask:0xf bound_ctrl:0
    v_add_f32_dpp v54, v54, v54 row_shr:4 row_mask:0xf bank_mask:0xf bound_ctrl:0
    v_add_f32_dpp v55, v55, v55 row_shr:4 row_mask:0xf bank_mask:0xf bound_ctrl:0
    v_add_f32_dpp v56, v56, v56 row_shr:4 row_mask:0xf bank_mask:0xf bound_ctrl:0
    v_add_f32_dpp v57, v57, v57 row_shr:4 row_mask:0xf bank_mask:0xf bound_ctrl:0
    v_add_f32_dpp v58, v58, v58 row_shr:4 row_mask:0xf bank_mask:0xf bound_ctrl:0
    v_add_f32_dpp v59, v59, v59 row_shr:4 row_mask:0xf bank_mask:0xf bound_ctrl:0
    s_nop 1
    v_add_f32_dpp v52, v52, v52 row_shr:8 row_mask:0xf bank_mask:0xf bound_ctrl:0
    v_add_f32_dpp v53, v53, v53 row_shr:8 row_mask:0xf bank_mask:0xf bound_ctrl:0
    v_add_f32_dpp v54, v54, v54 row_shr:8 row_mask:0xf bank_mask:0xf bound_ctrl:0
    v_add_f32_dpp v55, v55, v55 row_shr:8 row_mask:0xf bank_mask:0xf bound_ctrl:0
    v_add_f32_dpp v56, v56, v56 row_shr:8 row_mask:0xf bank_mask:0xf bound_ctrl:0
    v_add_f32_dpp v57, v57, v57 row_shr:8 row_mask:0xf bank_mask:0xf bound_ctrl:0
    v_add_f32_dpp v58, v58, v58 row_shr:8 row_mask:0xf bank_mask:0xf bound_ctrl:0
    v_add_f32_dpp v59, v59, v59 row_shr:8 row_mask:0xf bank_mask:0xf bound_ctrl:0
    v_mov_b32 v88, v52
    v_mov_b32 v89, v53
    v_mov_b32 v90, v54
    v_mov_b32 v91, v55
    v_mov_b32 v92, v56
    v_mov_b32 v93, v57
    v_mov_b32 v94, v58
    v_mov_b32 v95, v59
    s_nop 1
    v_permlane16_swap_b32 v52, v88
    v_permlane16_swap_b32 v53, v89
    v_permlane16_swap_b32 v54, v90
    v_permlane16_swap_b32 v55, v91
    v_permlane16_swap_b32 v56, v92
    v_permlane16_swap_b32 v57, v93
    v_permlane16_swap_b32 v58, v94
    v_permlane16_swap_b32 v59, v95
    s_nop 1
    v_add_f32 v52, v52, v88
    v_add_f32 v53, v53, v89
    v_add_f32 v54, v54, v90
    v_add_f32 v55, v55, v91
    v_add_f32 v56, v56, v92
    v_add_f32 v57, v57, v93
    v_add_f32 v58, v58, v94
    v_add_f32 v59, v59, v95
    v_mov_b32 v88, v52
    v_mov_b32 v89, v53
    v_mov_b32 v90, v54
    v_mov_b32 v91, v55
    v_mov_b32 v92, v56
    v_mov_b32 v93, v57
    v_mov_b32 v94, v58
    v_mov_b32 v95, v59
    s_nop 1
    v_permlane32_swap_b32 v52, v88
    v_permlane32_swap_b32 v53, v89
    v_permlane32_swap_b32 v54, v90
    v_permlane32_swap_b32 v55, v91
    v_permlane32_swap_b32 v56, v92
    v_permlane32_swap_b32 v57, v93
    v_permlane32_swap_b32 v58, v94
    v_permlane32_swap_b32 v59, v95
    s_nop 1
    v_add_f32 v52, v52, v88
    v_add_f32 v53, v53, v89
    v_add_f32 v54, v54, v90
    v_add_f32 v55, v55, v91
    v_add_f32 v56, v56, v92
    v_add_f32 v57, v57, v93
    v_add_f32 v58, v58, v94
    v_add_f32 v59, v59, v95
    s_add_u32 s56, s28, 0x2080000
    s_addc_u32 s57, s29, 0
    s_mov_b32 s58, 0x5000
    s_mov_b32 s59, 0x00020000
    s_mul_i32 s54, s53, 0xab
    s_lshr_b32 s54, s54, 11
    s_mul_i32 s55, s54, 384
    s_lshl_b32 s53, s53, 5
    s_add_u32 s55, s55, s53
    s_add_u32 s55, s55, s47
    s_add_u32 s55, s55, 8192
    v_mov_b32 v3, 0
    s_mov_b64 exec, 0x8000
    buffer_store_dwordx4 v[52:55], v3, s[56:59], s55 offen sc1
    buffer_store_dwordx4 v[56:59], v3, s[56:59], s55 offen offset:16 sc1
    s_mov_b64 exec, -1
L_attn0_kernel_ncs_5:
    s_mul_i32 s42, s30, 5
    s_add_u32 s42, s42, 0
    v_lshrrev_b32 v4, 5, v1
    v_add_u32 v4, s42, v4
    v_lshrrev_b32 v120, 3, v4
    v_lshlrev_b32 v120, 11, v120
    v_and_b32 v3, 3, v4
    v_lshl_add_u32 v120, v3, 9, v120
    v_and_b32 v3, 4, v4
    v_lshl_add_u32 v120, v3, 1, v120
    v_lshl_add_u32 v120, v2, 4, v120
    s_mul_i32 s42, s30, 5
    s_add_u32 s42, s42, 2
    v_lshrrev_b32 v4, 5, v1
    v_add_u32 v4, s42, v4
    v_lshrrev_b32 v121, 3, v4
    v_lshlrev_b32 v121, 11, v121
    v_and_b32 v3, 3, v4
    v_lshl_add_u32 v121, v3, 9, v121
    v_and_b32 v3, 4, v4
    v_lshl_add_u32 v121, v3, 1, v121
    v_lshl_add_u32 v121, v2, 4, v121
    s_mul_i32 s42, s30, 5
    s_add_u32 s42, s42, 4
    v_lshrrev_b32 v4, 5, v1
    v_add_u32 v4, s42, v4
    v_lshrrev_b32 v122, 3, v4
    v_lshlrev_b32 v122, 11, v122
    v_and_b32 v3, 3, v4
    v_lshl_add_u32 v122, v3, 9, v122
    v_and_b32 v3, 4, v4
    v_lshl_add_u32 v122, v3, 1, v122
    v_lshl_add_u32 v122, v2, 4, v122
    s_mul_i32 s43, s33, 40960
    s_barrier
    s_barrier
    ds_read_b32 v104, v6 offset:3072
    ds_read_b128 v[88:91], v5
    ds_read_b128 v[92:95], v5 offset:1024
    ds_read_b128 v[96:99], v5 offset:2048
    s_waitcnt lgkmcnt(3)
    v_min_f32 v3, v16, v104
    v_sub_f32 v4, v3, v16
    v_sub_f32 v3, v3, v104
    v_exp_f32 v4, v4
    v_exp_f32 v3, v3
    s_waitcnt lgkmcnt(0)
    v_mul_f32 v72, v72, v4
    v_mul_f32 v73, v73, v4
    v_mul_f32 v74, v74, v4
    v_mul_f32 v75, v75, v4
    v_mul_f32 v76, v76, v4
    v_mul_f32 v77, v77, v4
    v_mul_f32 v78, v78, v4
    v_mul_f32 v79, v79, v4
    v_mul_f32 v80, v80, v4
    v_mul_f32 v81, v81, v4
    v_mul_f32 v82, v82, v4
    v_mul_f32 v83, v83, v4
    v_fmac_f32 v72, v88, v3
    v_fmac_f32 v73, v89, v3
    v_fmac_f32 v74, v90, v3
    v_fmac_f32 v75, v91, v3
    v_fmac_f32 v76, v92, v3
    v_fmac_f32 v77, v93, v3
    v_fmac_f32 v78, v94, v3
    v_fmac_f32 v79, v95, v3
    v_fmac_f32 v80, v96, v3
    v_fmac_f32 v81, v97, v3
    v_fmac_f32 v82, v98, v3
    v_fmac_f32 v83, v99, v3
    v_mov_b32 v3, v80
    v_mov_b32 v4, v80
    s_nop 1
    v_permlane32_swap_b32 v3, v4
    s_nop 1
    v_rcp_f32 v4, v4
    s_nop 0
    v_mul_f32 v72, v72, v4
    v_mul_f32 v73, v73, v4
    v_mul_f32 v74, v74, v4
    v_mul_f32 v75, v75, v4
    v_mul_f32 v76, v76, v4
    v_mul_f32 v77, v77, v4
    v_mul_f32 v78, v78, v4
    v_mul_f32 v79, v79, v4
    v_mul_f32 v80, v80, v4
    v_mul_f32 v81, v81, v4
    v_mul_f32 v82, v82, v4
    v_mul_f32 v83, v83, v4
    v_cvt_pk_bf16_f32 v64, v72, v73
    v_cvt_pk_bf16_f32 v65, v74, v75
    v_cvt_pk_bf16_f32 v66, v76, v77
    v_cvt_pk_bf16_f32 v67, v78, v79
    v_cvt_pk_bf16_f32 v68, v80, v81
    v_cvt_pk_bf16_f32 v69, v82, v83
    buffer_store_dwordx2 v[64:65], v120, s[12:15], s43 offen
    buffer_store_dwordx2 v[66:67], v121, s[12:15], s43 offen
    s_mov_b32 exec_hi, 0
    buffer_store_dwordx2 v[68:69], v122, s[12:15], s43 offen
    s_endpgm
L_attn0_kernel_end:
    s_endpgm
.section .rodata,"a"
.p2align 6
.amdhsa_kernel attn0_kernel
  .amdhsa_next_free_vgpr 124
  .amdhsa_next_free_sgpr 100
  .amdhsa_accum_offset 124
  .amdhsa_group_segment_fixed_size 0
  .amdhsa_kernarg_size 80
  .amdhsa_user_sgpr_count 2
  .amdhsa_user_sgpr_kernarg_segment_ptr 1
  .amdhsa_system_sgpr_workgroup_id_x 1
.end_amdhsa_kernel
.text
.globl attn1_kernel
.p2align 8
.type attn1_kernel,@function
attn1_kernel:
    s_cmp_ge_u32 s2, 256
    s_cbranch_scc1 L_attn1_kernel_end
    s_load_dwordx2 s[28:29], s[0:1], 72
    s_load_dwordx2 s[20:21], s[0:1], 16
    s_load_dwordx4 s[24:27], s[0:1], 32
    s_load_dwordx2 s[22:23], s[0:1], 48
    v_lshrrev_b32 v2, 6, v0
    v_and_b32 v1, 63, v0
    s_and_b32 s50, s2, 7
    s_lshr_b32 s51, s2, 3
    v_readfirstlane_b32 s49, v2
    s_lshl_b32 s30, s50, 2
    s_and_b32 s32, s51, 3
    s_add_u32 s30, s30, s32
    s_lshr_b32 s31, s51, 2
    v_lshlrev_b32 v123, 4, v1
    v_lshlrev_b32 v4, 3, v1
    s_and_b32 s35, s49, 7
    s_lshr_b32 s49, s49, 3
    s_lshl_b32 s33, s31, 3
    s_add_u32 s33, s33, s35
    s_lshl_b32 s34, s30, 6
    s_add_u32 s34, s34, s33
    s_mul_i32 s34, s34, 1280
    s_mul_i32 s47, s49, 81920
    s_lshl_b32 s37, s35, 10
    s_add_u32 s37, s37, s47
    s_mul_i32 s36, s30, 163840
    s_add_u32 s36, s36, s37
    v_mov_b32 v12, 0
    v_mov_b32 v13, 0
    s_waitcnt lgkmcnt(0)
    s_add_u32 s8, s28, 0x400000
    s_addc_u32 s9, s29, 0
    s_mov_b32 s10, 0x500000
    s_mov_b32 s11, 0x00020000
    s_mov_b32 s4, s28
    s_mov_b32 s5, s29
    s_mov_b32 s6, 0x280000
    s_mov_b32 s7, 0x00020000
    s_mov_b32 m0, s37
    s_add_u32 s37, s37, 8192
    buffer_load_dwordx4 v123, s[8:11], s36 offen lds
    s_add_u32 s36, s36, 8192
    buffer_load_dwordx4 v[8:11], v123, s[4:7], s34 offen
    s_mov_b32 exec_hi, 0
    buffer_load_dwordx2 v[12:13], v4, s[4:7], s34 offen offset:1024
    s_mov_b64 exec, -1
    s_mov_b32 m0, s37
    s_add_u32 s37, s37, 8192
    buffer_load_dwordx4 v123, s[8:11], s36 offen lds
    s_add_u32 s36, s36, 8192
    s_lshr_b32 s37, s35, 1
    s_mul_i32 s37, s37, 81920
    s_and_b32 s36, s35, 1
    s_lshl_b32 s36, s36, 10
    s_add_u32 s37, s37, s36
    s_add_u32 s37, s37, 16384
    s_mul_i32 s36, s30, 163840
    s_add_u32 s36, s36, s37
    s_lshl_b32 s48, s49, 3
    s_add_u32 s48, s48, s35
    s_lshr_b32 s48, s48, 2
    s_add_u32 s12, s28, 0xa00000
    s_addc_u32 s13, s29, 0
    s_mov_b32 s14, 0x280000
    s_mov_b32 s15, 0x00020000
    v_add_u32 v5, s47, v123
    v_and_b32 v2, 31, v1
    v_lshrrev_b32 v6, 4, v2
    v_mul_u32_u24 v6, 2304, v6
    v_lshl_add_u32 v6, v2, 4, v6
    v_add_u32 v6, 1024, v6
    v_add_u32 v6, s47, v6
    v_lshrrev_b32 v4, 5, v1
    v_mul_u32_u24 v4, 320, v4
    v_lshl_add_u32 v7, v2, 4, v4
    v_add_u32 v7, 1280, v7
    v_add_u32 v7, s47, v7
    s_mov_b32 s40, 0x000fffff
    s_mov_b32 s41, 0x000fffff
    v_mov_b32 v104, 0
    v_mov_b32 v105, 0
    v_mov_b32 v106, 0
    v_mov_b32 v107, 0
    v_mov_b32 v108, 0
    v_mov_b32 v109, 0
    v_mov_b32 v110, 0
    v_mov_b32 v111, 0
    v_mov_b32 v112, 0
    v_mov_b32 v113, 0
    v_mov_b32 v114, 0
    v_mov_b32 v115, 0
    v_mov_b32 v116, 0
    v_mov_b32 v117, 0
    v_mov_b32 v118, 0
    v_mov_b32 v119, 0
    s_mov_b32 exec_lo, 0x00100000
    s_mov_b32 exec_hi, 0x00100000
    v_mov_b32 v104, 0x3f803f80
    v_mov_b32 v105, 0x3f803f80
    v_mov_b32 v106, 0x3f803f80
    v_mov_b32 v107, 0x3f803f80
    v_mov_b32 v108, 0x3f803f80
    v_mov_b32 v109, 0x3f803f80
    v_mov_b32 v110, 0x3f803f80
    v_mov_b32 v111, 0x3f803f80
    v_mov_b32 v112, 0x3f803f80
    v_mov_b32 v113, 0x3f803f80
    v_mov_b32 v114, 0x3f803f80
    v_mov_b32 v115, 0x3f803f80
    v_mov_b32 v116, 0x3f803f80
    v_mov_b32 v117, 0x3f803f80
    v_mov_b32 v118, 0x3f803f80
    v_mov_b32 v119, 0x3f803f80
    s_mov_b64 exec, -1
    v_mov_b32 v72, 0
    v_mov_b32 v73, 0
    v_mov_b32 v74, 0
    v_mov_b32 v75, 0
    v_mov_b32 v76, 0
    v_mov_b32 v77, 0
    v_mov_b32 v78, 0
    v_mov_b32 v79, 0
    v_mov_b32 v80, 0
    v_mov_b32 v81, 0
    v_mov_b32 v82, 0
    v_mov_b32 v83, 0
    v_mov_b32 v84, 0
    v_mov_b32 v85, 0
    v_mov_b32 v86, 0
    v_mov_b32 v87, 0
    v_mov_b32 v68, 0
    v_mov_b32 v69, 0
    v_mov_b32 v70, 0
    v_mov_b32 v71, 0
    s_mov_b32 s44, 0
    s_mov_b32 s45, 0
    s_waitcnt vmcnt(0)
    s_barrier
    s_cmp_lg_u32 s48, 0
    s_cbranch_scc1 L_attn1_kernel_nd_1
    s_mov_b32 m0, s37
    s_add_u32 s37, s37, 2048
    buffer_load_dwordx4 v123, s[8:11], s36 offen lds
    s_add_u32 s36, s36, 2048
    s_mov_b32 m0, s37
    s_add_u32 s37, s37, 2048
    buffer_load_dwordx4 v123, s[8:11], s36 offen lds
    s_add_u32 s36, s36, 2048
    s_mov_b32 m0, s37
    s_add_u32 s37, s37, 2048
    buffer_load_dwordx4 v123, s[8:11], s36 offen lds
    s_add_u32 s36, s36, 2048
    s_mov_b32 m0, s37
    s_add_u32 s37, s37, 2048
    buffer_load_dwordx4 v123, s[8:11], s36 offen lds
    s_add_u32 s36, s36, 2048
    s_mov_b32 m0, s37
    s_add_u32 s37, s37, 2048
    buffer_load_dwordx4 v123, s[8:11], s36 offen lds
    s_add_u32 s36, s36, 2048
    s_mov_b32 m0, s37
    s_add_u32 s37, s37, 2048
    buffer_load_dwordx4 v123, s[8:11], s36 offen lds
    s_add_u32 s36, s36, 2048
    s_mov_b32 m0, s37
    s_add_u32 s37, s37, 2048
    buffer_load_dwordx4 v123, s[8:11], s36 offen lds
    s_add_u32 s36, s36, 2048
    s_mov_b32 m0, s37
    s_add_u32 s37, s37, 2048
    buffer_load_dwordx4 v123, s[8:11], s36 offen lds
    s_add_u32 s36, s36, 2048
    s_mov_b32 m0, s37
    s_add_u32 s37, s37, 2048
    buffer_load_dwordx4 v123, s[8:11], s36 offen lds
    s_add_u32 s36, s36, 2048
    s_mov_b32 m0, s37
    s_add_u32 s37, s37, 2048
    buffer_load_dwordx4 v123, s[8:11], s36 offen lds
    s_add_u32 s36, s36, 2048
    s_mov_b32 m0, s37
    s_add_u32 s37, s37, 2048
    buffer_load_dwordx4 v123, s[8:11], s36 offen lds
    s_add_u32 s36, s36, 2048
    s_mov_b32 m0, s37
    s_add_u32 s37, s37, 2048
    buffer_load_dwordx4 v123, s[8:11], s36 offen lds
    s_add_u32 s36, s36, 2048
L_attn1_kernel_nd_1:
    ds_read_b128 v[88:91], v5 offset:0
    ds_read_b128 v[96:99], v6 offset:0
    ds_read_b128 v[92:95], v5 offset:2560
    s_mov_b64 exec, s[40:41]
    ds_read_b128 v[104:107], v7 offset:0
    ds_read_b128 v[108:111], v7 offset:640
    s_mov_b64 exec, -1
    s_waitcnt lgkmcnt(3)
    v_mfma_f32_32x32x16_bf16 v[32:47], v[88:91], v[8:11], 0
    v_mfma_f32_32x32x8_bf16 v[32:47], v[96:97], v[12:13], v[32:47]
    s_nop 15
    v_max3_f32 v4, v32, v33, v34
    v_max3_f32 v4, v4, v35, v36
    v_max3_f32 v4, v4, v37, v38
    v_max3_f32 v4, v4, v39, v40
    v_max3_f32 v4, v4, v41, v42
    v_max3_f32 v4, v4, v43, v44
    v_max3_f32 v4, v4, v45, v46
    v_max_f32 v4, v4, v47
    v_mov_b32 v3, v4
    s_nop 1
    v_permlane32_swap_b32 v4, v3
    s_nop 1
    v_max_f32 v4, v4, v3
    v_sub_f32 v16, 0, v4
    v_mov_b32 v17, v16
    v_mov_b32 v18, v16
    v_mov_b32 v19, v16
    v_mov_b32 v20, v16
    v_mov_b32 v21, v16
    v_mov_b32 v22, v16
    v_mov_b32 v23, v16
    v_mov_b32 v24, v16
    v_mov_b32 v25, v16
    v_mov_b32 v26, v16
    v_mov_b32 v27, v16
    v_mov_b32 v28, v16
    v_mov_b32 v29, v16
    v_mov_b32 v30, v16
    v_mov_b32 v31, v16
    s_nop 1
    v_mfma_f32_32x32x16_bf16 v[32:47], v[88:91], v[8:11], v[16:31]
    v_mfma_f32_32x32x8_bf16 v[32:47], v[96:97], v[12:13], v[32:47]
L_attn1_kernel_main_2:
    s_nop 11
L_attn1_kernel_loop_3:
    s_add_u32 s46, s45, s44
    s_waitcnt lgkmcnt(0)
    v_mfma_f32_32x32x16_bf16 v[48:63], v[92:95], v[8:11], v[16:31]
    ds_read_b128 v[88:91], v5 offset:5120
    v_exp_f32 v32, v32
    v_exp_f32 v33, v33
    v_exp_f32 v34, v34
    v_exp_f32 v35, v35
    v_exp_f32 v36, v36
    v_mfma_f32_32x32x16_bf16 v[72:87], v[116:119], v[68:71], v[72:87]
    s_mov_b64 exec, s[40:41]
    ds_read_b128 v[112:115], v7 offset:2560
    ds_read_b128 v[116:119], v7 offset:3200
    s_mov_b64 exec, -1
    v_exp_f32 v37, v37
    v_exp_f32 v38, v38
    v_exp_f32 v39, v39
    v_cvt_pk_bf16_f32 v64, v32, v33
    v_cvt_pk_bf16_f32 v65, v34, v35
    v_cvt_pk_bf16_f32 v66, v36, v37
    v_cvt_pk_bf16_f32 v67, v38, v39
    v_mfma_f32_32x32x8_bf16 v[48:63], v[98:99], v[12:13], v[48:63]
    ds_read_b128 v[96:99], v6 offset:5120
    v_exp_f32 v40, v40
    v_exp_f32 v41, v41
    v_exp_f32 v42, v42
    v_exp_f32 v43, v43
    v_exp_f32 v44, v44
    v_mfma_f32_32x32x16_bf16 v[72:87], v[104:107], v[64:67], v[72:87]
    v_exp_f32 v45, v45
    v_exp_f32 v46, v46
    v_exp_f32 v47, v47
    v_cvt_pk_bf16_f32 v68, v40, v41
    v_cvt_pk_bf16_f32 v69, v42, v43
    v_cvt_pk_bf16_f32 v70, v44, v45
    v_cvt_pk_bf16_f32 v71, v46, v47
    s_waitcnt lgkmcnt(0)
    v_mfma_f32_32x32x16_bf16 v[32:47], v[88:91], v[8:11], v[16:31]
    ds_read_b128 v[92:95], v5 offset:7680
    v_exp_f32 v48, v48
    v_exp_f32 v49, v49
    v_exp_f32 v50, v50
    v_exp_f32 v51, v51
    v_exp_f32 v52, v52
    v_mfma_f32_32x32x16_bf16 v[72:87], v[108:111], v[68:71], v[72:87]
    s_mov_b64 exec, s[40:41]
    ds_read_b128 v[104:107], v7 offset:5120
    ds_read_b128 v[108:111], v7 offset:5760
    s_mov_b64 exec, -1
    v_exp_f32 v53, v53
    v_exp_f32 v54, v54
    v_exp_f32 v55, v55
    v_cvt_pk_bf16_f32 v64, v48, v49
    v_cvt_pk_bf16_f32 v65, v50, v51
    v_cvt_pk_bf16_f32 v66, v52, v53
    v_cvt_pk_bf16_f32 v67, v54, v55
    v_mfma_f32_32x32x8_bf16 v[32:47], v[96:97], v[12:13], v[32:47]
    v_exp_f32 v56, v56
    v_exp_f32 v57, v57
    v_exp_f32 v58, v58
    v_exp_f32 v59, v59
    v_exp_f32 v60, v60
    v_mfma_f32_32x32x16_bf16 v[72:87], v[112:115], v[64:67], v[72:87]
    v_exp_f32 v61, v61
    v_exp_f32 v62, v62
    v_exp_f32 v63, v63
    v_cvt_pk_bf16_f32 v68, v56, v57
    v_cvt_pk_bf16_f32 v69, v58, v59
    v_cvt_pk_bf16_f32 v70, v60, v61
    v_cvt_pk_bf16_f32 v71, v62, v63
    s_waitcnt lgkmcnt(0)
    v_mfma_f32_32x32x16_bf16 v[48:63], v[92:95], v[8:11], v[16:31]
    ds_read_b128 v[88:91], v5 offset:10240
    v_exp_f32 v32, v32
    v_exp_f32 v33, v33
    v_exp_f32 v34, v34
    v_exp_f32 v35, v35
    v_exp_f32 v36, v36
    v_mfma_f32_32x32x16_bf16 v[72:87], v[116:119], v[68:71], v[72:87]
    s_mov_b64 exec, s[40:41]
    ds_read_b128 v[112:115], v7 offset:7680
    ds_read_b128 v[116:119], v7 offset:8320
    s_mov_b64 exec, -1
    v_exp_f32 v37, v37
    v_exp_f32 v38, v38
    v_exp_f32 v39, v39
    v_cvt_pk_bf16_f32 v64, v32, v33
    v_cvt_pk_bf16_f32 v65, v34, v35
    v_cvt_pk_bf16_f32 v66, v36, v37
    v_cvt_pk_bf16_f32 v67, v38, v39
    v_mfma_f32_32x32x8_bf16 v[48:63], v[98:99], v[12:13], v[48:63]
    ds_read_b128 v[96:99], v6 offset:10240
    v_exp_f32 v40, v40
    v_exp_f32 v41, v41
    v_exp_f32 v42, v42
    v_exp_f32 v43, v43
    v_exp_f32 v44, v44
    v_mfma_f32_32x32x16_bf16 v[72:87], v[104:107], v[64:67], v[72:87]
    v_exp_f32 v45, v45
    v_exp_f32 v46, v46
    v_exp_f32 v47, v47
    v_cvt_pk_bf16_f32 v68, v40, v41
    v_cvt_pk_bf16_f32 v69, v42, v43
    v_cvt_pk_bf16_f32 v70, v44, v45
    v_cvt_pk_bf16_f32 v71, v46, v47
    s_waitcnt lgkmcnt(0)
    v_mfma_f32_32x32x16_bf16 v[32:47], v[88:91], v[8:11], v[16:31]
    ds_read_b128 v[92:95], v5 offset:12800
    v_exp_f32 v48, v48
    v_exp_f32 v49, v49
    v_exp_f32 v50, v50
    v_exp_f32 v51, v51
    v_exp_f32 v52, v52
    v_mfma_f32_32x32x16_bf16 v[72:87], v[108:111], v[68:71], v[72:87]
    s_mov_b64 exec, s[40:41]
    ds_read_b128 v[104:107], v7 offset:10240
    ds_read_b128 v[108:111], v7 offset:10880
    s_mov_b64 exec, -1
    v_exp_f32 v53, v53
    v_exp_f32 v54, v54
    v_exp_f32 v55, v55
    v_cvt_pk_bf16_f32 v64, v48, v49
    v_cvt_pk_bf16_f32 v65, v50, v51
    v_cvt_pk_bf16_f32 v66, v52, v53
    v_cvt_pk_bf16_f32 v67, v54, v55
    v_mfma_f32_32x32x8_bf16 v[32:47], v[96:97], v[12:13], v[32:47]
    v_exp_f32 v56, v56
    v_exp_f32 v57, v57
    v_exp_f32 v58, v58
    v_exp_f32 v59, v59
    v_exp_f32 v60, v60
    v_mfma_f32_32x32x16_bf16 v[72:87], v[112:115], v[64:67], v[72:87]
    v_exp_f32 v61, v61
    v_exp_f32 v62, v62
    v_exp_f32 v63, v63
    v_cvt_pk_bf16_f32 v68, v56, v57
    v_cvt_pk_bf16_f32 v69, v58, v59
    v_cvt_pk_bf16_f32 v70, v60, v61
    v_cvt_pk_bf16_f32 v71, v62, v63
    s_cmp_eq_u32 s46, 0
    s_cbranch_scc1 L_attn1_kernel_s2
L_attn1_kernel_s2r:
    s_waitcnt lgkmcnt(0)
    v_mfma_f32_32x32x16_bf16 v[48:63], v[92:95], v[8:11], v[16:31]
    ds_read_b128 v[88:91], v5 offset:15360
    v_exp_f32 v32, v32
    v_exp_f32 v33, v33
    v_exp_f32 v34, v34
    v_exp_f32 v35, v35
    v_exp_f32 v36, v36
    v_mfma_f32_32x32x16_bf16 v[72:87], v[116:119], v[68:71], v[72:87]
    s_mov_b64 exec, s[40:41]
    ds_read_b128 v[112:115], v7 offset:12800
    ds_read_b128 v[116:119], v7 offset:13440
    s_mov_b64 exec, -1
    v_exp_f32 v37, v37
    v_exp_f32 v38, v38
    v_exp_f32 v39, v39
    v_cvt_pk_bf16_f32 v64, v32, v33
    v_cvt_pk_bf16_f32 v65, v34, v35
    v_cvt_pk_bf16_f32 v66, v36, v37
    v_cvt_pk_bf16_f32 v67, v38, v39
    v_mfma_f32_32x32x8_bf16 v[48:63], v[98:99], v[12:13], v[48:63]
    ds_read_b128 v[96:99], v6 offset:15360
    v_exp_f32 v40, v40
    v_exp_f32 v41, v41
    v_exp_f32 v42, v42
    v_exp_f32 v43, v43
    v_exp_f32 v44, v44
    v_mfma_f32_32x32x16_bf16 v[72:87], v[104:107], v[64:67], v[72:87]
    v_exp_f32 v45, v45
    v_exp_f32 v46, v46
    v_exp_f32 v47, v47
    v_cvt_pk_bf16_f32 v68, v40, v41
    v_cvt_pk_bf16_f32 v69, v42, v43
    v_cvt_pk_bf16_f32 v70, v44, v45
    v_cvt_pk_bf16_f32 v71, v46, v47
    s_waitcnt lgkmcnt(0)
    v_mfma_f32_32x32x16_bf16 v[32:47], v[88:91], v[8:11], v[16:31]
    ds_read_b128 v[92:95], v5 offset:17920
    v_exp_f32 v48, v48
    v_exp_f32 v49, v49
    v_exp_f32 v50, v50
    v_exp_f32 v51, v51
    v_exp_f32 v52, v52
    v_mfma_f32_32x32x16_bf16 v[72:87], v[108:111], v[68:71], v[72:87]
    s_mov_b64 exec, s[40:41]
    ds_read_b128 v[104:107], v7 offset:15360
    ds_read_b128 v[108:111], v7 offset:16000
    s_mov_b64 exec, -1
    v_exp_f32 v53, v53
    v_exp_f32 v54, v54
    v_exp_f32 v55, v55
    v_cvt_pk_bf16_f32 v64, v48, v49
    v_cvt_pk_bf16_f32 v65, v50, v51
    v_cvt_pk_bf16_f32 v66, v52, v53
    v_cvt_pk_bf16_f32 v67, v54, v55
    v_mfma_f32_32x32x8_bf16 v[32:47], v[96:97], v[12:13], v[32:47]
    v_exp_f32 v56, v56
    v_exp_f32 v57, v57
    v_exp_f32 v58, v58
    v_exp_f32 v59, v59
    v_exp_f32 v60, v60
    v_mfma_f32_32x32x16_bf16 v[72:87], v[112:115], v[64:67], v[72:87]
    v_exp_f32 v61, v61
    v_exp_f32 v62, v62
    v_exp_f32 v63, v63
    v_cvt_pk_bf16_f32 v68, v56, v57
    v_cvt_pk_bf16_f32 v69, v58, v59
    v_cvt_pk_bf16_f32 v70, v60, v61
    v_cvt_pk_bf16_f32 v71, v62, v63
    s_waitcnt lgkmcnt(0)
    v_mfma_f32_32x32x16_bf16 v[48:63], v[92:95], v[8:11], v[16:31]
    ds_read_b128 v[88:91], v5 offset:20480
    v_exp_f32 v32, v32
    v_exp_f32 v33, v33
    v_exp_f32 v34, v34
    v_exp_f32 v35, v35
    v_exp_f32 v36, v36
    v_mfma_f32_32x32x16_bf16 v[72:87], v[116:119], v[68:71], v[72:87]
    s_mov_b64 exec, s[40:41]
    ds_read_b128 v[112:115], v7 offset:17920
    ds_read_b128 v[116:119], v7 offset:18560
    s_mov_b64 exec, -1
    v_exp_f32 v37, v37
    v_exp_f32 v38, v38
    v_exp_f32 v39, v39
    v_cvt_pk_bf16_f32 v64, v32, v33
    v_cvt_pk_bf16_f32 v65, v34, v35
    v_cvt_pk_bf16_f32 v66, v36, v37
    v_cvt_pk_bf16_f32 v67, v38, v39
    v_mfma_f32_32x32x8_bf16 v[48:63], v[98:99], v[12:13], v[48:63]
    ds_read_b128 v[96:99], v6 offset:20480
    v_exp_f32 v40, v40
    v_exp_f32 v41, v41
    v_exp_f32 v42, v42
    v_exp_f32 v43, v43
    v_exp_f32 v44, v44
    v_mfma_f32_32x32x16_bf16 v[72:87], v[104:107], v[64:67], v[72:87]
    v_exp_f32 v45, v45
    v_exp_f32 v46, v46
    v_exp_f32 v47, v47
    v_cvt_pk_bf16_f32 v68, v40, v41
    v_cvt_pk_bf16_f32 v69, v42, v43
    v_cvt_pk_bf16_f32 v70, v44, v45
    v_cvt_pk_bf16_f32 v71, v46, v47
    s_waitcnt lgkmcnt(0)
    v_mfma_f32_32x32x16_bf16 v[32:47], v[88:91], v[8:11], v[16:31]
    ds_read_b128 v[92:95], v5 offset:23040
    v_exp_f32 v48, v48
    v_exp_f32 v49, v49
    v_exp_f32 v50, v50
    v_exp_f32 v51, v51
    v_exp_f32 v52, v52
    v_mfma_f32_32x32x16_bf16 v[72:87], v[108:111], v[68:71], v[72:87]
    s_mov_b64 exec, s[40:41]
    ds_read_b128 v[104:107], v7 offset:20480
    ds_read_b128 v[108:111], v7 offset:21120
    s_mov_b64 exec, -1
    v_exp_f32 v53, v53
    v_exp_f32 v54, v54
    v_exp_f32 v55, v55
    v_cvt_pk_bf16_f32 v64, v48, v49
    v_cvt_pk_bf16_f32 v65, v50, v51
    v_cvt_pk_bf16_f32 v66, v52, v53
    v_cvt_pk_bf16_f32 v67, v54, v55
    v_mfma_f32_32x32x8_bf16 v[32:47], v[96:97], v[12:13], v[32:47]
    v_exp_f32 v56, v56
    v_exp_f32 v57, v57
    v_exp_f32 v58, v58
    v_exp_f32 v59, v59
    v_exp_f32 v60, v60
    v_mfma_f32_32x32x16_bf16 v[72:87], v[112:115], v[64:67], v[72:87]
    v_exp_f32 v61, v61
    v_exp_f32 v62, v62
    v_exp_f32 v63, v63
    v_cvt_pk_bf16_f32 v68, v56, v57
    v_cvt_pk_bf16_f32 v69, v58, v59
    v_cvt_pk_bf16_f32 v70, v60, v61
    v_cvt_pk_bf16_f32 v71, v62, v63
    s_waitcnt lgkmcnt(0)
    v_mfma_f32_32x32x16_bf16 v[48:63], v[92:95], v[8:11], v[16:31]
    ds_read_b128 v[88:91], v5 offset:25600
    v_exp_f32 v32, v32
    v_exp_f32 v33, v33
    v_exp_f32 v34, v34
    v_exp_f32 v35, v35
    v_exp_f32 v36, v36
    v_mfma_f32_32x32x16_bf16 v[72:87], v[116:119], v[68:71], v[72:87]
    s_mov_b64 exec, s[40:41]
    ds_read_b128 v[112:115], v7 offset:23040
    ds_read_b128 v[116:119], v7 offset:23680
    s_mov_b64 exec, -1
    v_exp_f32 v37, v37
    v_exp_f32 v38, v38
    v_exp_f32 v39, v39
    v_cvt_pk_bf16_f32 v64, v32, v33
    v_cvt_pk_bf16_f32 v65, v34, v35
    v_cvt_pk_bf16_f32 v66, v36, v37
    v_cvt_pk_bf16_f32 v67, v38, v39
    v_mfma_f32_32x32x8_bf16 v[48:63], v[98:99], v[12:13], v[48:63]
    ds_read_b128 v[96:99], v6 offset:25600
    v_exp_f32 v40, v40
    v_exp_f32 v41, v41
    v_exp_f32 v42, v42
    v_exp_f32 v43, v43
    v_exp_f32 v44, v44
    v_mfma_f32_32x32x16_bf16 v[72:87], v[104:107], v[64:67], v[72:87]
    v_exp_f32 v45, v45
    v_exp_f32 v46, v46
    v_exp_f32 v47, v47
    v_cvt_pk_bf16_f32 v68, v40, v41
    v_cvt_pk_bf16_f32 v69, v42, v43
    v_cvt_pk_bf16_f32 v70, v44, v45
    v_cvt_pk_bf16_f32 v71, v46, v47
    s_waitcnt lgkmcnt(0)
    v_mfma_f32_32x32x16_bf16 v[32:47], v[88:91], v[8:11], v[16:31]
    ds_read_b128 v[92:95], v5 offset:28160
    v_exp_f32 v48, v48
    v_exp_f32 v49, v49
    v_exp_f32 v50, v50
    v_exp_f32 v51, v51
    v_exp_f32 v52, v52
    v_mfma_f32_32x32x16_bf16 v[72:87], v[108:111], v[68:71], v[72:87]
    s_mov_b64 exec, s[40:41]
    ds_read_b128 v[104:107], v7 offset:25600
    ds_read_b128 v[108:111], v7 offset:26240
    s_mov_b64 exec, -1
    v_exp_f32 v53, v53
    v_exp_f32 v54, v54
    v_exp_f32 v55, v55
    v_cvt_pk_bf16_f32 v64, v48, v49
    v_cvt_pk_bf16_f32 v65, v50, v51
    v_cvt_pk_bf16_f32 v66, v52, v53
    v_cvt_pk_bf16_f32 v67, v54, v55
    v_mfma_f32_32x32x8_bf16 v[32:47], v[96:97], v[12:13], v[32:47]
    v_exp_f32 v56, v56
    v_exp_f32 v57, v57
    v_exp_f32 v58, v58
    v_exp_f32 v59, v59
    v_exp_f32 v60, v60
    v_mfma_f32_32x32x16_bf16 v[72:87], v[112:115], v[64:67], v[72:87]
    v_exp_f32 v61, v61
    v_exp_f32 v62, v62
    v_exp_f32 v63, v63
    v_cvt_pk_bf16_f32 v68, v56, v57
    v_cvt_pk_bf16_f32 v69, v58, v59
    v_cvt_pk_bf16_f32 v70, v60, v61
    v_cvt_pk_bf16_f32 v71, v62, v63
    s_waitcnt lgkmcnt(0)
    v_mfma_f32_32x32x16_bf16 v[48:63], v[92:95], v[8:11], v[16:31]
    ds_read_b128 v[88:91], v5 offset:30720
    v_exp_f32 v32, v32
    v_exp_f32 v33, v33
    v_exp_f32 v34, v34
    v_exp_f32 v35, v35
    v_exp_f32 v36, v36
    v_mfma_f32_32x32x16_bf16 v[72:87], v[116:119], v[68:71], v[72:87]
    s_mov_b64 exec, s[40:41]
    ds_read_b128 v[112:115], v7 offset:28160
    ds_read_b128 v[116:119], v7 offset:28800
    s_mov_b64 exec, -1
    v_exp_f32 v37, v37
    v_exp_f32 v38, v38
    v_exp_f32 v39, v39
    v_cvt_pk_bf16_f32 v64, v32, v33
    v_cvt_pk_bf16_f32 v65, v34, v35
    v_cvt_pk_bf16_f32 v66, v36, v37
    v_cvt_pk_bf16_f32 v67, v38, v39
    v_mfma_f32_32x32x8_bf16 v[48:63], v[98:99], v[12:13], v[48:63]
    ds_read_b128 v[96:99], v6 offset:30720
    v_exp_f32 v40, v40
    v_exp_f32 v41, v41
    v_exp_f32 v42, v42
    v_exp_f32 v43, v43
    v_exp_f32 v44, v44
    v_mfma_f32_32x32x16_bf16 v[72:87], v[104:107], v[64:67], v[72:87]
    v_exp_f32 v45, v45
    v_exp_f32 v46, v46
    v_exp_f32 v47, v47
    v_cvt_pk_bf16_f32 v68, v40, v41
    v_cvt_pk_bf16_f32 v69, v42, v43
    v_cvt_pk_bf16_f32 v70, v44, v45
    v_cvt_pk_bf16_f32 v71, v46, v47
    s_waitcnt lgkmcnt(0)
    v_mfma_f32_32x32x16_bf16 v[32:47], v[88:91], v[8:11], v[16:31]
    ds_read_b128 v[92:95], v5 offset:33280
    v_exp_f32 v48, v48
    v_exp_f32 v49, v49
    v_exp_f32 v50, v50
    v_exp_f32 v51, v51
    v_exp_f32 v52, v52
    v_mfma_f32_32x32x16_bf16 v[72:87], v[108:111], v[68:71], v[72:87]
    s_mov_b64 exec, s[40:41]
    ds_read_b128 v[104:107], v7 offset:30720
    ds_read_b128 v[108:111], v7 offset:31360
    s_mov_b64 exec, -1
    v_exp_f32 v53, v53
    v_exp_f32 v54, v54
    v_exp_f32 v55, v55
    v_cvt_pk_bf16_f32 v64, v48, v49
    v_cvt_pk_bf16_f32 v65, v50, v51
    v_cvt_pk_bf16_f32 v66, v52, v53
    v_cvt_pk_bf16_f32 v67, v54, v55
    v_mfma_f32_32x32x8_bf16 v[32:47], v[96:97], v[12:13], v[32:47]
    v_exp_f32 v56, v56
    v_exp_f32 v57, v57
    v_exp_f32 v58, v58
    v_exp_f32 v59, v59
    v_exp_f32 v60, v60
    v_mfma_f32_32x32x16_bf16 v[72:87], v[112:115], v[64:67], v[72:87]
    v_exp_f32 v61, v61
    v_exp_f32 v62, v62
    v_exp_f32 v63, v63
    v_cvt_pk_bf16_f32 v68, v56, v57
    v_cvt_pk_bf16_f32 v69, v58, v59
    v_cvt_pk_bf16_f32 v70, v60, v61
    v_cvt_pk_bf16_f32 v71, v62, v63
    s_cmp_eq_u32 s46, 0
    s_cbranch_scc1 L_attn1_kernel_s3
L_attn1_kernel_s3r:
    s_waitcnt lgkmcnt(0)
    v_mfma_f32_32x32x16_bf16 v[48:63], v[92:95], v[8:11], v[16:31]
    ds_read_b128 v[88:91], v5 offset:35840
    v_exp_f32 v32, v32
    v_exp_f32 v33, v33
    v_exp_f32 v34, v34
    v_exp_f32 v35, v35
    v_exp_f32 v36, v36
    v_mfma_f32_32x32x16_bf16 v[72:87], v[116:119], v[68:71], v[72:87]
    s_mov_b64 exec, s[40:41]
    ds_read_b128 v[112:115], v7 offset:33280
    ds_read_b128 v[116:119], v7 offset:33920
    s_mov_b64 exec, -1
    v_exp_f32 v37, v37
    v_exp_f32 v38, v38
    v_exp_f32 v39, v39
    v_cvt_pk_bf16_f32 v64, v32, v33
    v_cvt_pk_bf16_f32 v65, v34, v35
    v_cvt_pk_bf16_f32 v66, v36, v37
    v_cvt_pk_bf16_f32 v67, v38, v39
    v_mfma_f32_32x32x8_bf16 v[48:63], v[98:99], v[12:13], v[48:63]
    ds_read_b128 v[96:99], v6 offset:35840
    v_exp_f32 v40, v40
    v_exp_f32 v41, v41
    v_exp_f32 v42, v42
    v_exp_f32 v43, v43
    v_exp_f32 v44, v44
    v_mfma_f32_32x32x16_bf16 v[72:87], v[104:107], v[64:67], v[72:87]
    v_exp_f32 v45, v45
    v_exp_f32 v46, v46
    v_exp_f32 v47, v47
    v_cvt_pk_bf16_f32 v68, v40, v41
    v_cvt_pk_bf16_f32 v69, v42, v43
    v_cvt_pk_bf16_f32 v70, v44, v45
    v_cvt_pk_bf16_f32 v71, v46, v47
    s_waitcnt lgkmcnt(0)
    v_mfma_f32_32x32x16_bf16 v[32:47], v[88:91], v[8:11], v[16:31]
    ds_read_b128 v[92:95], v5 offset:38400
    v_exp_f32 v48, v48
    v_exp_f32 v49, v49
    v_exp_f32 v50, v50
    v_exp_f32 v51, v51
    v_exp_f32 v52, v52
    v_mfma_f32_32x32x16_bf16 v[72:87], v[108:111], v[68:71], v[72:87]
    s_mov_b64 exec, s[40:41]
    ds_read_b128 v[104:107], v7 offset:35840
    ds_read_b128 v[108:111], v7 offset:36480
    s_mov_b64 exec, -1
    v_exp_f32 v53, v53
    v_exp_f32 v54, v54
    v_exp_f32 v55, v55
    v_cvt_pk_bf16_f32 v64, v48, v49
    v_cvt_pk_bf16_f32 v65, v50, v51
    v_cvt_pk_bf16_f32 v66, v52, v53
    v_cvt_pk_bf16_f32 v67, v54, v55
    v_mfma_f32_32x32x8_bf16 v[32:47], v[96:97], v[12:13], v[32:47]
    v_exp_f32 v56, v56
    v_exp_f32 v57, v57
    v_exp_f32 v58, v58
    v_exp_f32 v59, v59
    v_exp_f32 v60, v60
    v_mfma_f32_32x32x16_bf16 v[72:87], v[112:115], v[64:67], v[72:87]
    v_exp_f32 v61, v61
    v_exp_f32 v62, v62
    v_exp_f32 v63, v63
    v_cvt_pk_bf16_f32 v68, v56, v57
    v_cvt_pk_bf16_f32 v69, v58, v59
    v_cvt_pk_bf16_f32 v70, v60, v61
    v_cvt_pk_bf16_f32 v71, v62, v63
    s_waitcnt lgkmcnt(0)
    v_mfma_f32_32x32x16_bf16 v[48:63], v[92:95], v[8:11], v[16:31]
    ds_read_b128 v[88:91], v5 offset:40960
    v_exp_f32 v32, v32
    v_exp_f32 v33, v33
    v_exp_f32 v34, v34
    v_exp_f32 v35, v35
    v_exp_f32 v36, v36
    v_mfma_f32_32x32x16_bf16 v[72:87], v[116:119], v[68:71], v[72:87]
    s_mov_b64 exec, s[40:41]
    ds_read_b128 v[112:115], v7 offset:38400
    ds_read_b128 v[116:119], v7 offset:39040
    s_mov_b64 exec, -1
    v_exp_f32 v37, v37
    v_exp_f32 v38, v38
    v_exp_f32 v39, v39
    v_cvt_pk_bf16_f32 v64, v32, v33
    v_cvt_pk_bf16_f32 v65, v34, v35
    v_cvt_pk_bf16_f32 v66, v36, v37
    v_cvt_pk_bf16_f32 v67, v38, v39
    v_mfma_f32_32x32x8_bf16 v[48:63], v[98:99], v[12:13], v[48:63]
    ds_read_b128 v[96:99], v6 offset:40960
    v_exp_f32 v40, v40
    v_exp_f32 v41, v41
    v_exp_f32 v42, v42
    v_exp_f32 v43, v43
    v_exp_f32 v44, v44
    v_mfma_f32_32x32x16_bf16 v[72:87], v[104:107], v[64:67], v[72:87]
    v_exp_f32 v45, v45
    v_exp_f32 v46, v46
    v_exp_f32 v47, v47
    v_cvt_pk_bf16_f32 v68, v40, v41
    v_cvt_pk_bf16_f32 v69, v42, v43
    v_cvt_pk_bf16_f32 v70, v44, v45
    v_cvt_pk_bf16_f32 v71, v46, v47
    s_waitcnt lgkmcnt(0)
    v_mfma_f32_32x32x16_bf16 v[32:47], v[88:91], v[8:11], v[16:31]
    ds_read_b128 v[92:95], v5 offset:43520
    v_exp_f32 v48, v48
    v_exp_f32 v49, v49
    v_exp_f32 v50, v50
    v_exp_f32 v51, v51
    v_exp_f32 v52, v52
    v_mfma_f32_32x32x16_bf16 v[72:87], v[108:111], v[68:71], v[72:87]
    s_mov_b64 exec, s[40:41]
    ds_read_b128 v[104:107], v7 offset:40960
    ds_read_b128 v[108:111], v7 offset:41600
    s_mov_b64 exec, -1
    v_exp_f32 v53, v53
    v_exp_f32 v54, v54
    v_exp_f32 v55, v55
    v_cvt_pk_bf16_f32 v64, v48, v49
    v_cvt_pk_bf16_f32 v65, v50, v51
    v_cvt_pk_bf16_f32 v66, v52, v53
    v_cvt_pk_bf16_f32 v67, v54, v55
    v_mfma_f32_32x32x8_bf16 v[32:47], v[96:97], v[12:13], v[32:47]
    v_exp_f32 v56, v56
    v_exp_f32 v57, v57
    v_exp_f32 v58, v58
    v_exp_f32 v59, v59
    v_exp_f32 v60, v60
    v_mfma_f32_32x32x16_bf16 v[72:87], v[112:115], v[64:67], v[72:87]
    v_exp_f32 v61, v61
    v_exp_f32 v62, v62
    v_exp_f32 v63, v63
    v_cvt_pk_bf16_f32 v68, v56, v57
    v_cvt_pk_bf16_f32 v69, v58, v59
    v_cvt_pk_bf16_f32 v70, v60, v61
    v_cvt_pk_bf16_f32 v71, v62, v63
    v_add_u32 v5, 40960, v5
    v_add_u32 v6, 40960, v6
    v_add_u32 v7, 40960, v7
    s_add_u32 s45, s45, 1
    s_cmp_lt_u32 s45, 2
    s_cbranch_scc1 L_attn1_kernel_loop_3
    v_mfma_f32_32x32x16_bf16 v[72:87], v[116:119], v[68:71], v[72:87]
    s_waitcnt lgkmcnt(0)
    v_subrev_u32 v5, 81920, v5
    v_subrev_u32 v6, 81920, v6
    v_subrev_u32 v7, 81920, v7
    s_nop 15
    s_mov_b32 s46, 0x4e800000
    v_cmp_gt_f32 vcc, s46, v80
    s_nop 1
    s_cmp_eq_u32 vcc_hi, -1
    s_cbranch_scc1 L_attn1_kernel_fin
    s_cmp_lg_u32 s44, 0
    s_cbranch_scc1 L_attn1_kernel_fin
    s_mov_b32 s44, 1
    v_mov_b32 v4, 0xff800000
    s_mov_b32 s45, 0
L_attn1_kernel_fb_4:
    ds_read_b128 v[88:91], v5 offset:0
    ds_read_b128 v[96:99], v6 offset:0
    ds_read_b128 v[92:95], v5 offset:2560
    s_waitcnt lgkmcnt(0)
    v_mfma_f32_32x32x16_bf16 v[32:47], v[88:91], v[8:11], 0
    v_mfma_f32_32x32x8_bf16 v[32:47], v[96:97], v[12:13], v[32:47]
    v_mfma_f32_32x32x16_bf16 v[48:63], v[92:95], v[8:11], 0
    v_mfma_f32_32x32x8_bf16 v[48:63], v[98:99], v[12:13], v[48:63]
    s_nop 15
    v_max3_f32 v4, v4, v32, v33
    v_max3_f32 v4, v4, v34, v35
    v_max3_f32 v4, v4, v36, v37
    v_max3_f32 v4, v4, v38, v39
    v_max3_f32 v4, v4, v40, v41
    v_max3_f32 v4, v4, v42, v43
    v_max3_f32 v4, v4, v44, v45
    v_max3_f32 v4, v4, v46, v47
    v_max3_f32 v4, v4, v48, v49
    v_max3_f32 v4, v4, v50, v51
    v_max3_f32 v4, v4, v52, v53
    v_max3_f32 v4, v4, v54, v55
    v_max3_f32 v4, v4, v56, v57
    v_max3_f32 v4, v4, v58, v59
    v_max3_f32 v4, v4, v60, v61
    v_max3_f32 v4, v4, v62, v63
    v_add_u32 v5, 5120, v5
    v_add_u32 v6, 5120, v6
    s_add_u32 s45, s45, 1
    s_cmp_lt_u32 s45, 16
    s_cbranch_scc1 L_attn1_kernel_fb_4
    v_subrev_u32 v5, 81920, v5
    v_subrev_u32 v6, 81920, v6
    v_mov_b32 v3, v4
    s_nop 1
    v_permlane32_swap_b32 v4, v3
    s_nop 1
    v_max_f32 v4, v4, v3
    v_sub_f32 v16, 0, v4
    v_mov_b32 v17, v16
    v_mov_b32 v18, v16
    v_mov_b32 v19, v16
    v_mov_b32 v20, v16
    v_mov_b32 v21, v16
    v_mov_b32 v22, v16
    v_mov_b32 v23, v16
    v_mov_b32 v24, v16
    v_mov_b32 v25, v16
    v_mov_b32 v26, v16
    v_mov_b32 v27, v16
    v_mov_b32 v28, v16
    v_mov_b32 v29, v16
    v_mov_b32 v30, v16
    v_mov_b32 v31, v16
    v_mov_b32 v72, 0
    v_mov_b32 v73, 0
    v_mov_b32 v74, 0
    v_mov_b32 v75, 0
    v_mov_b32 v76, 0
    v_mov_b32 v77, 0
    v_mov_b32 v78, 0
    v_mov_b32 v79, 0
    v_mov_b32 v80, 0
    v_mov_b32 v81, 0
    v_mov_b32 v82, 0
    v_mov_b32 v83, 0
    v_mov_b32 v84, 0
    v_mov_b32 v85, 0
    v_mov_b32 v86, 0
    v_mov_b32 v87, 0
    v_mov_b32 v68, 0
    v_mov_b32 v69, 0
    v_mov_b32 v70, 0
    v_mov_b32 v71, 0
    s_mov_b32 s45, 0
    ds_read_b128 v[88:91], v5 offset:0
    ds_read_b128 v[96:99], v6 offset:0
    ds_read_b128 v[92:95], v5 offset:2560
    s_mov_b64 exec, s[40:41]
    ds_read_b128 v[104:107], v7 offset:0
    ds_read_b128 v[108:111], v7 offset:640
    s_mov_b64 exec, -1
    s_waitcnt lgkmcnt(3)
    v_mfma_f32_32x32x16_bf16 v[32:47], v[88:91], v[8:11], v[16:31]
    v_mfma_f32_32x32x8_bf16 v[32:47], v[96:97], v[12:13], v[32:47]
    s_branch L_attn1_kernel_main_2
L_attn1_kernel_s2:
    s_waitcnt vmcnt(0)
    s_barrier
    s_cmp_lg_u32 s48, 0
    s_cbranch_scc1 L_attn1_kernel_s2r
    s_mov_b32 m0, s37
    s_add_u32 s37, s37, 2048
    buffer_load_dwordx4 v123, s[8:11], s36 offen lds
    s_add_u32 s36, s36, 2048
    s_mov_b32 m0, s37
    s_add_u32 s37, s37, 2048
    buffer_load_dwordx4 v123, s[8:11], s36 offen lds
    s_add_u32 s36, s36, 2048
    s_mov_b32 m0, s37
    s_add_u32 s37, s37, 2048
    buffer_load_dwordx4 v123, s[8:11], s36 offen lds
    s_add_u32 s36, s36, 2048
    s_mov_b32 m0, s37
    s_add_u32 s37, s37, 2048
    buffer_load_dwordx4 v123, s[8:11], s36 offen lds
    s_add_u32 s36, s36, 2048
    s_mov_b32 m0, s37
    s_add_u32 s37, s37, 2048
    buffer_load_dwordx4 v123, s[8:11], s36 offen lds
    s_add_u32 s36, s36, 2048
    s_mov_b32 m0, s37
    s_add_u32 s37, s37, 2048
    buffer_load_dwordx4 v123, s[8:11], s36 offen lds
    s_add_u32 s36, s36, 2048
    s_mov_b32 m0, s37
    s_add_u32 s37, s37, 2048
    buffer_load_dwordx4 v123, s[8:11], s36 offen lds
    s_add_u32 s36, s36, 2048
    s_mov_b32 m0, s37
    s_add_u32 s37, s37, 2048
    buffer_load_dwordx4 v123, s[8:11], s36 offen lds
    s_add_u32 s36, s36, 2048
    s_mov_b32 m0, s37
    s_add_u32 s37, s37, 2048
    buffer_load_dwordx4 v123, s[8:11], s36 offen lds
    s_add_u32 s36, s36, 2048
    s_mov_b32 m0, s37
    s_add_u32 s37, s37, 2048
    buffer_load_dwordx4 v123, s[8:11], s36 offen lds
    s_add_u32 s36, s36, 2048
    s_mov_b32 m0, s37
    s_add_u32 s37, s37, 2048
    buffer_load_dwordx4 v123, s[8:11], s36 offen lds
    s_add_u32 s36, s36, 2048
    s_mov_b32 m0, s37
    s_add_u32 s37, s37, 2048
    buffer_load_dwordx4 v123, s[8:11], s36 offen lds
    s_add_u32 s36, s36, 2048
    s_mov_b32 m0, s37
    s_add_u32 s37, s37, 2048
    buffer_load_dwordx4 v123, s[8:11], s36 offen lds
    s_add_u32 s36, s36, 2048
    s_mov_b32 m0, s37
    s_add_u32 s37, s37, 2048
    buffer_load_dwordx4 v123, s[8:11], s36 offen lds
    s_add_u32 s36, s36, 2048
    s_mov_b32 m0, s37
    s_add_u32 s37, s37, 2048
    buffer_load_dwordx4 v123, s[8:11], s36 offen lds
    s_add_u32 s36, s36, 2048
    s_mov_b32 m0, s37
    s_add_u32 s37, s37, 2048
    buffer_load_dwordx4 v123, s[8:11], s36 offen lds
    s_add_u32 s36, s36, 2048
    s_mov_b32 m0, s37
    s_add_u32 s37, s37, 2048
    buffer_load_dwordx4 v123, s[8:11], s36 offen lds
    s_add_u32 s36, s36, 2048
    s_mov_b32 m0, s37
    s_add_u32 s37, s37, 2048
    buffer_load_dwordx4 v123, s[8:11], s36 offen lds
    s_add_u32 s36, s36, 2048
    s_mov_b32 m0, s37
    s_add_u32 s37, s37, 2048
    buffer_load_dwordx4 v123, s[8:11], s36 offen lds
    s_add_u32 s36, s36, 2048
    s_mov_b32 m0, s37
    s_add_u32 s37, s37, 2048
    buffer_load_dwordx4 v123, s[8:11], s36 offen lds
    s_add_u32 s36, s36, 2048
    s_branch L_attn1_kernel_s2r
L_attn1_kernel_s3:
    s_waitcnt vmcnt(0)
    s_barrier
    s_branch L_attn1_kernel_s3r
L_attn1_kernel_fin:
    s_lshl_b32 s46, s35, 12
    v_add_u32 v5, s46, v123
    v_lshrrev_b32 v6, 2, v123
    v_add_u32 v6, s46, v6
    s_cmp_eq_u32 s49, 0
    s_cbranch_scc1 L_attn1_kernel_h0
    s_barrier
    ds_write_b128 v5, v[72:75]
    ds_write_b128 v5, v[76:79] offset:1024
    ds_write_b128 v5, v[80:83] offset:2048
    ds_write_b32 v6, v16 offset:3072
    s_waitcnt lgkmcnt(0)
    s_barrier
    s_endpgm
L_attn1_kernel_h0:
    s_lshl_b32 s52, s2, 3
    s_add_u32 s52, s52, s35
    s_lshl_b32 s52, s51, 3
    s_add_u32 s52, s52, s35
    v_lshlrev_b32 v48, 7, v1
    s_lshr_b32 s53, s50, 1
    s_mul_i32 s53, s53, 983040
    s_and_b32 s54, s50, 1
    s_mul_i32 s55, s54, 983040
    s_add_u32 s55, s55, 0x410000
    s_cmp_lt_u32 s52, 120
    s_cselect_b32 s76, s53, s55
    s_lshl_b32 s53, s52, 13
    s_add_u32 s76, s76, s53
    s_cmp_ge_u32 s52, 240
    s_cselect_b32 s76, 0x7f000000, s76
    s_sub_u32 s53, 255, s52
    s_mul_i32 s77, s54, 409600
    s_add_u32 s77, s77, 0x400000
    s_lshl_b32 s55, s53, 13
    s_add_u32 s77, s77, s55
    s_cmp_ge_u32 s53, 50
    s_cselect_b32 s77, 0x7f000000, s77
    s_add_u32 s56, s28, 0x2400000
    s_addc_u32 s57, s29, 0
    s_mov_b32 s58, 0x6e0000
    s_mov_b32 s59, 0x00020000
    buffer_load_dword v32, v48, s[56:59], s76 offen
    buffer_load_dword v33, v48, s[56:59], s77 offen
    s_mul_i32 s42, s30, 5
    s_add_u32 s42, s42, 0
    v_lshrrev_b32 v4, 5, v1
    v_add_u32 v4, s42, v4
    v_lshrrev_b32 v120, 3, v4
    v_lshlrev_b32 v120, 11, v120
    v_and_b32 v3, 3, v4
    v_lshl_add_u32 v120, v3, 9, v120
    v_and_b32 v3, 4, v4
    v_lshl_add_u32 v120, v3, 1, v120
    v_lshl_add_u32 v120, v2, 4, v120
    s_mul_i32 s42, s30, 5
    s_add_u32 s42, s42, 2
    v_lshrrev_b32 v4, 5, v1
    v_add_u32 v4, s42, v4
    v_lshrrev_b32 v121, 3, v4
    v_lshlrev_b32 v121, 11, v121
    v_and_b32 v3, 3, v4
    v_lshl_add_u32 v121, v3, 9, v121
    v_and_b32 v3, 4, v4
    v_lshl_add_u32 v121, v3, 1, v121
    v_lshl_add_u32 v121, v2, 4, v121
    s_mul_i32 s42, s30, 5
    s_add_u32 s42, s42, 4
    v_lshrrev_b32 v4, 5, v1
    v_add_u32 v4, s42, v4
    v_lshrrev_b32 v122, 3, v4
    v_lshlrev_b32 v122, 11, v122
    v_and_b32 v3, 3, v4
    v_lshl_add_u32 v122, v3, 9, v122
    v_and_b32 v3, 4, v4
    v_lshl_add_u32 v122, v3, 1, v122
    v_lshl_add_u32 v122, v2, 4, v122
    s_mul_i32 s43, s33, 40960
    s_barrier
    s_barrier
    ds_read_b32 v104, v6 offset:3072
    ds_read_b128 v[88:91], v5
    ds_read_b128 v[92:95], v5 offset:1024
    ds_read_b128 v[96:99], v5 offset:2048
    s_waitcnt lgkmcnt(3)
    v_min_f32 v3, v16, v104
    v_sub_f32 v4, v3, v16
    v_sub_f32 v3, v3, v104
    v_exp_f32 v4, v4
    v_exp_f32 v3, v3
    s_waitcnt lgkmcnt(0)
    v_mul_f32 v72, v72, v4
    v_mul_f32 v73, v73, v4
    v_mul_f32 v74, v74, v4
    v_mul_f32 v75, v75, v4
    v_mul_f32 v76, v76, v4
    v_mul_f32 v77, v77, v4
    v_mul_f32 v78, v78, v4
    v_mul_f32 v79, v79, v4
    v_mul_f32 v80, v80, v4
    v_mul_f32 v81, v81, v4
    v_mul_f32 v82, v82, v4
    v_mul_f32 v83, v83, v4
    v_fmac_f32 v72, v88, v3
    v_fmac_f32 v73, v89, v3
    v_fmac_f32 v74, v90, v3
    v_fmac_f32 v75, v91, v3
    v_fmac_f32 v76, v92, v3
    v_fmac_f32 v77, v93, v3
    v_fmac_f32 v78, v94, v3
    v_fmac_f32 v79, v95, v3
    v_fmac_f32 v80, v96, v3
    v_fmac_f32 v81, v97, v3
    v_fmac_f32 v82, v98, v3
    v_fmac_f32 v83, v99, v3
    v_mov_b32 v3, v80
    v_mov_b32 v4, v80
    s_nop 1
    v_permlane32_swap_b32 v3, v4
    s_nop 1
    v_rcp_f32 v4, v4
    s_nop 0
    v_mul_f32 v72, v72, v4
    v_mul_f32 v73, v73, v4
    v_mul_f32 v74, v74, v4
    v_mul_f32 v75, v75, v4
    v_mul_f32 v76, v76, v4
    v_mul_f32 v77, v77, v4
    v_mul_f32 v78, v78, v4
    v_mul_f32 v79, v79, v4
    v_mul_f32 v80, v80, v4
    v_mul_f32 v81, v81, v4
    v_mul_f32 v82, v82, v4
    v_mul_f32 v83, v83, v4
    v_cvt_pk_bf16_f32 v64, v72, v73
    v_cvt_pk_bf16_f32 v65, v74, v75
    v_cvt_pk_bf16_f32 v66, v76, v77
    v_cvt_pk_bf16_f32 v67, v78, v79
    v_cvt_pk_bf16_f32 v68, v80, v81
    v_cvt_pk_bf16_f32 v69, v82, v83
    buffer_store_dwordx2 v[64:65], v120, s[12:15], s43 offen
    buffer_store_dwordx2 v[66:67], v121, s[12:15], s43 offen
    s_mov_b32 exec_hi, 0
    buffer_store_dwordx2 v[68:69], v122, s[12:15], s43 offen
    s_endpgm
L_attn1_kernel_end:
    s_endpgm
.section .rodata,"a"
.p2align 6
.amdhsa_kernel attn1_kernel
  .amdhsa_next_free_vgpr 124
  .amdhsa_next_free_sgpr 100
  .amdhsa_accum_offset 124
  .amdhsa_group_segment_fixed_size 0
  .amdhsa_kernarg_size 80
  .amdhsa_user_sgpr_count 2
  .amdhsa_user_sgpr_kernarg_segment_ptr 1
  .amdhsa_system_sgpr_workgroup_id_x 1
.end_amdhsa_kernel
.text
.globl ch0_kernel
.p2align 8
.type ch0_kernel,@function
ch0_kernel:
    s_cmp_ge_u32 s2, 256
    s_cbranch_scc1 L_ch0_kernel_end
    s_load_dwordx2 s[28:29], s[0:1], 72
    s_load_dwordx4 s[20:23], s[0:1], 0
    s_load_dwordx2 s[24:25], s[0:1], 56
    v_lshrrev_b32 v2, 6, v0
    s_and_b32 s30, s2, 7
    s_lshr_b32 s31, s2, 3
    v_and_b32 v1, 63, v0
    v_readfirstlane_b32 s64, v2
    v_and_b32 v2, 3, v2
    v_lshlrev_b32 v14, 4, v1
    s_lshr_b32 s66, s30, 1
    s_lshl_b32 s66, s66, 3
    s_and_b32 s33, s31, 7
    s_add_u32 s66, s66, s33
    s_and_b32 s67, s30, 1
    s_lshl_b32 s67, s67, 2
    s_lshr_b32 s34, s31, 3
    s_add_u32 s67, s67, s34
    s_and_b32 s68, s30, 1
    s_lshl_b32 s68, s68, 3
    s_add_u32 s68, s68, s33
    s_lshr_b32 s69, s30, 1
    s_lshl_b32 s69, s69, 2
    s_add_u32 s69, s69, s34
    s_lshr_b32 s70, s30, 1
    s_lshl_b32 s70, s70, 2
    s_and_b32 s33, s31, 3
    s_add_u32 s70, s70, s33
    s_and_b32 s71, s30, 1
    s_lshl_b32 s71, s71, 3
    s_lshr_b32 s34, s31, 2
    s_add_u32 s71, s71, s34
    s_and_b32 s35, s64, 3
    s_cmp_lt_u32 s64, 4
    s_cbranch_scc1 L_ch0_kernel_cons
    v_lshrrev_b32 v3, 4, v1
    v_lshl_add_u32 v4, v2, 4, v3
    v_mul_u32_u24 v4, 3840, v4
    v_lshlrev_b32 v3, 2, v3
    v_sub_u32 v3, v1, v3
    v_and_b32 v3, 15, v3
    v_lshl_add_u32 v8, v3, 4, v4
    v_add_u32 v9, 14336, v8
    v_add_u32 v10, 28672, v8
    v_add_u32 v11, 43008, v8
    s_mul_i32 s40, s35, 5120
    s_mul_i32 s41, s35, 6144
    s_lshl_b32 s42, s35, 12
    s_mul_i32 s36, s67, 102400
    s_add_u32 s36, s36, s40
    s_add_u32 s36, s36, 0x400000
    s_mul_i32 s37, s69, 245760
    s_add_u32 s37, s37, s41
    s_mul_i32 s38, s67, 245760
    s_add_u32 s38, s38, s40
    s_add_u32 s38, s38, 0x500000
    s_lshl_b32 s39, s71, 8
    s_waitcnt lgkmcnt(0)
    s_add_u32 s8, s28, 0x2400000
    s_addc_u32 s9, s29, 0
    s_mov_b32 s10, 0x6e0000
    s_mov_b32 s11, 0x00020000
    s_mov_b32 s12, s22
    s_mov_b32 s13, s23
    s_mov_b32 s14, 0x258000
    s_mov_b32 s15, 0x00020000
    s_cmp_ge_u32 s71, 15
    s_cselect_b32 s39, 0x7f000000, s39
    s_add_u32 m0, s40, 0
    s_add_u32 s43, s36, 4096
    buffer_load_dwordx4 v14, s[8:11], s36 offen offset:0 lds
    buffer_load_dwordx4 v14, s[8:11], s36 offen offset:1024 lds
    buffer_load_dwordx4 v14, s[8:11], s36 offen offset:2048 lds
    buffer_load_dwordx4 v14, s[8:11], s36 offen offset:3072 lds
    s_add_u32 m0, s40, 4096
    s_add_u32 s36, s36, 20480
    buffer_load_dwordx4 v14, s[8:11], s43 offen lds
    s_add_u32 m0, s40, 24576
    s_add_u32 s43, s36, 4096
    buffer_load_dwordx4 v14, s[8:11], s36 offen offset:0 lds
    buffer_load_dwordx4 v14, s[8:11], s36 offen offset:1024 lds
    buffer_load_dwordx4 v14, s[8:11], s36 offen offset:2048 lds
    buffer_load_dwordx4 v14, s[8:11], s36 offen offset:3072 lds
    s_add_u32 m0, s40, 28672
    s_add_u32 s36, s36, 20480
    buffer_load_dwordx4 v14, s[8:11], s43 offen lds
    s_waitcnt vmcnt(5)
    s_barrier
    s_add_u32 m0, s40, 49152
    s_add_u32 s43, s36, 4096
    buffer_load_dwordx4 v14, s[8:11], s36 offen offset:0 lds
    buffer_load_dwordx4 v14, s[8:11], s36 offen offset:1024 lds
    buffer_load_dwordx4 v14, s[8:11], s36 offen offset:2048 lds
    buffer_load_dwordx4 v14, s[8:11], s36 offen offset:3072 lds
    s_add_u32 m0, s40, 53248
    s_add_u32 s36, s36, 20480
    buffer_load_dwordx4 v14, s[8:11], s43 offen lds
    s_add_u32 m0, s40, 73728
    s_add_u32 s43, s36, 4096
    buffer_load_dwordx4 v14, s[8:11], s36 offen offset:0 lds
    buffer_load_dwordx4 v14, s[8:11], s36 offen offset:1024 lds
    buffer_load_dwordx4 v14, s[8:11], s36 offen offset:2048 lds
    buffer_load_dwordx4 v14, s[8:11], s36 offen offset:3072 lds
    s_add_u32 m0, s40, 77824
    s_add_u32 s36, s36, 20480
    buffer_load_dwordx4 v14, s[8:11], s43 offen lds
    s_add_u32 m0, s40, 98304
    s_add_u32 s43, s36, 4096
    buffer_load_dwordx4 v14, s[8:11], s36 offen offset:0 lds
    buffer_load_dwordx4 v14, s[8:11], s36 offen offset:1024 lds
    buffer_load_dwordx4 v14, s[8:11], s36 offen offset:2048 lds
    buffer_load_dwordx4 v14, s[8:11], s36 offen offset:3072 lds
    s_add_u32 m0, s40, 102400
    s_add_u32 s36, s36, 20480
    buffer_load_dwordx4 v14, s[8:11], s43 offen lds
    s_waitcnt vmcnt(15)
    s_barrier
    s_add_u32 m0, s41, 122880
    s_add_u32 s43, s37, 4096
    buffer_load_dwordx4 v14, s[8:11], s37 offen offset:0 lds
    buffer_load_dwordx4 v14, s[8:11], s37 offen offset:1024 lds
    buffer_load_dwordx4 v14, s[8:11], s37 offen offset:2048 lds
    buffer_load_dwordx4 v14, s[8:11], s37 offen offset:3072 lds
    s_add_u32 m0, s41, 126976
    s_add_u32 s37, s37, 24576
    buffer_load_dwordx4 v14, s[8:11], s43 offen offset:0 lds
    buffer_load_dwordx4 v14, s[8:11], s43 offen offset:1024 lds
    s_waitcnt vmcnt(16)
    s_barrier
    s_add_u32 m0, s41, 0
    s_add_u32 s43, s37, 4096
    buffer_load_dwordx4 v14, s[8:11], s37 offen offset:0 lds
    buffer_load_dwordx4 v14, s[8:11], s37 offen offset:1024 lds
    buffer_load_dwordx4 v14, s[8:11], s37 offen offset:2048 lds
    buffer_load_dwordx4 v14, s[8:11], s37 offen offset:3072 lds
    s_add_u32 m0, s41, 4096
    s_add_u32 s37, s37, 24576
    buffer_load_dwordx4 v14, s[8:11], s43 offen offset:0 lds
    buffer_load_dwordx4 v14, s[8:11], s43 offen offset:1024 lds
    s_waitcnt vmcnt(17)
    s_barrier
    s_add_u32 m0, s41, 24576
    s_add_u32 s43, s37, 4096
    buffer_load_dwordx4 v14, s[8:11], s37 offen offset:0 lds
    buffer_load_dwordx4 v14, s[8:11], s37 offen offset:1024 lds
    buffer_load_dwordx4 v14, s[8:11], s37 offen offset:2048 lds
    buffer_load_dwordx4 v14, s[8:11], s37 offen offset:3072 lds
    s_add_u32 m0, s41, 28672
    s_add_u32 s37, s37, 24576
    buffer_load_dwordx4 v14, s[8:11], s43 offen offset:0 lds
    buffer_load_dwordx4 v14, s[8:11], s43 offen offset:1024 lds
    s_waitcnt vmcnt(18)
    s_barrier
    s_add_u32 m0, s41, 49152
    s_add_u32 s43, s37, 4096
    buffer_load_dwordx4 v14, s[8:11], s37 offen offset:0 lds
    buffer_load_dwordx4 v14, s[8:11], s37 offen offset:1024 lds
    buffer_load_dwordx4 v14, s[8:11], s37 offen offset:2048 lds
    buffer_load_dwordx4 v14, s[8:11], s37 offen offset:3072 lds
    s_add_u32 m0, s41, 53248
    s_add_u32 s37, s37, 24576
    buffer_load_dwordx4 v14, s[8:11], s43 offen offset:0 lds
    buffer_load_dwordx4 v14, s[8:11], s43 offen offset:1024 lds
    s_waitcnt vmcnt(18)
    s_barrier
    s_add_u32 m0, s41, 73728
    s_add_u32 s43, s37, 4096
    buffer_load_dwordx4 v14, s[8:11], s37 offen offset:0 lds
    buffer_load_dwordx4 v14, s[8:11], s37 offen offset:1024 lds
    buffer_load_dwordx4 v14, s[8:11], s37 offen offset:2048 lds
    buffer_load_dwordx4 v14, s[8:11], s37 offen offset:3072 lds
    s_add_u32 m0, s41, 77824
    s_add_u32 s37, s37, 24576
    buffer_load_dwordx4 v14, s[8:11], s43 offen offset:0 lds
    buffer_load_dwordx4 v14, s[8:11], s43 offen offset:1024 lds
    s_waitcnt vmcnt(18)
    s_barrier
    s_add_u32 m0, s41, 98304
    s_add_u32 s43, s37, 4096
    buffer_load_dwordx4 v14, s[8:11], s37 offen offset:0 lds
    buffer_load_dwordx4 v14, s[8:11], s37 offen offset:1024 lds
    buffer_load_dwordx4 v14, s[8:11], s37 offen offset:2048 lds
    buffer_load_dwordx4 v14, s[8:11], s37 offen offset:3072 lds
    s_add_u32 m0, s41, 102400
    s_add_u32 s37, s37, 24576
    buffer_load_dwordx4 v14, s[8:11], s43 offen offset:0 lds
    buffer_load_dwordx4 v14, s[8:11], s43 offen offset:1024 lds
    s_waitcnt vmcnt(18)
    s_barrier
    s_add_u32 m0, s41, 122880
    s_add_u32 s43, s37, 4096
    buffer_load_dwordx4 v14, s[8:11], s37 offen offset:0 lds
    buffer_load_dwordx4 v14, s[8:11], s37 offen offset:1024 lds
    buffer_load_dwordx4 v14, s[8:11], s37 offen offset:2048 lds
    buffer_load_dwordx4 v14, s[8:11], s37 offen offset:3072 lds
    s_add_u32 m0, s41, 126976
    s_add_u32 s37, s37, 24576
    buffer_load_dwordx4 v14, s[8:11], s43 offen offset:0 lds
    buffer_load_dwordx4 v14, s[8:11], s43 offen offset:1024 lds
    s_waitcnt vmcnt(18)
    s_barrier
    s_add_u32 m0, s41, 0
    s_add_u32 s43, s37, 4096
    buffer_load_dwordx4 v14, s[8:11], s37 offen offset:0 lds
    buffer_load_dwordx4 v14, s[8:11], s37 offen offset:1024 lds
    buffer_load_dwordx4 v14, s[8:11], s37 offen offset:2048 lds
    buffer_load_dwordx4 v14, s[8:11], s37 offen offset:3072 lds
    s_add_u32 m0, s41, 4096
    s_add_u32 s37, s37, 24576
    buffer_load_dwordx4 v14, s[8:11], s43 offen offset:0 lds
    buffer_load_dwordx4 v14, s[8:11], s43 offen offset:1024 lds
    s_waitcnt vmcnt(18)
    s_barrier
    s_add_u32 m0, s41, 24576
    s_add_u32 s43, s37, 4096
    buffer_load_dwordx4 v14, s[8:11], s37 offen offset:0 lds
    buffer_load_dwordx4 v14, s[8:11], s37 offen offset:1024 lds
    buffer_load_dwordx4 v14, s[8:11], s37 offen offset:2048 lds
    buffer_load_dwordx4 v14, s[8:11], s37 offen offset:3072 lds
    s_add_u32 m0, s41, 28672
    s_add_u32 s37, s37, 24576
    buffer_load_dwordx4 v14, s[8:11], s43 offen offset:0 lds
    buffer_load_dwordx4 v14, s[8:11], s43 offen offset:1024 lds
    s_waitcnt vmcnt(18)
    s_barrier
    s_add_u32 m0, s41, 49152
    s_add_u32 s43, s37, 4096
    buffer_load_dwordx4 v14, s[8:11], s37 offen offset:0 lds
    buffer_load_dwordx4 v14, s[8:11], s37 offen offset:1024 lds
    buffer_load_dwordx4 v14, s[8:11], s37 offen offset:2048 lds
    buffer_load_dwordx4 v14, s[8:11], s37 offen offset:3072 lds
    s_add_u32 m0, s41, 53248
    s_add_u32 s37, s37, 24576
    buffer_load_dwordx4 v14, s[8:11], s43 offen offset:0 lds
    buffer_load_dwordx4 v14, s[8:11], s43 offen offset:1024 lds
    s_waitcnt vmcnt(18)
    s_barrier
    s_add_u32 m0, s40, 73728
    s_add_u32 s43, s38, 4096
    buffer_load_dwordx4 v14, s[8:11], s38 offen offset:0 lds
    buffer_load_dwordx4 v14, s[8:11], s38 offen offset:1024 lds
    buffer_load_dwordx4 v14, s[8:11], s38 offen offset:2048 lds
    buffer_load_dwordx4 v14, s[8:11], s38 offen offset:3072 lds
    s_add_u32 m0, s40, 77824
    s_add_u32 s38, s38, 20480
    buffer_load_dwordx4 v14, s[8:11], s43 offen lds
    s_waitcnt vmcnt(17)
    s_barrier
    s_add_u32 m0, s40, 98304
    s_add_u32 s43, s38, 4096
    buffer_load_dwordx4 v14, s[8:11], s38 offen offset:0 lds
    buffer_load_dwordx4 v14, s[8:11], s38 offen offset:1024 lds
    buffer_load_dwordx4 v14, s[8:11], s38 offen offset:2048 lds
    buffer_load_dwordx4 v14, s[8:11], s38 offen offset:3072 lds
    s_add_u32 m0, s40, 102400
    s_add_u32 s38, s38, 20480
    buffer_load_dwordx4 v14, s[8:11], s43 offen lds
    s_waitcnt vmcnt(16)
    s_barrier
    s_add_u32 m0, s40, 122880
    s_add_u32 s43, s38, 4096
    buffer_load_dwordx4 v14, s[8:11], s38 offen offset:0 lds
    buffer_load_dwordx4 v14, s[8:11], s38 offen offset:1024 lds
    buffer_load_dwordx4 v14, s[8:11], s38 offen offset:2048 lds
    buffer_load_dwordx4 v14, s[8:11], s38 offen offset:3072 lds
    s_add_u32 m0, s40, 126976
    s_add_u32 s38, s38, 20480
    buffer_load_dwordx4 v14, s[8:11], s43 offen lds
    s_waitcnt vmcnt(15)
    s_barrier
    s_add_u32 m0, s40, 0
    s_add_u32 s43, s38, 4096
    buffer_load_dwordx4 v14, s[8:11], s38 offen offset:0 lds
    buffer_load_dwordx4 v14, s[8:11], s38 offen offset:1024 lds
    buffer_load_dwordx4 v14, s[8:11], s38 offen offset:2048 lds
    buffer_load_dwordx4 v14, s[8:11], s38 offen offset:3072 lds
    s_add_u32 m0, s40, 4096
    s_add_u32 s38, s38, 20480
    buffer_load_dwordx4 v14, s[8:11], s43 offen lds
    s_waitcnt vmcnt(15)
    s_barrier
    s_add_u32 m0, s40, 24576
    s_add_u32 s43, s38, 4096
    buffer_load_dwordx4 v14, s[8:11], s38 offen offset:0 lds
    buffer_load_dwordx4 v14, s[8:11], s38 offen offset:1024 lds
    buffer_load_dwordx4 v14, s[8:11], s38 offen offset:2048 lds
    buffer_load_dwordx4 v14, s[8:11], s38 offen offset:3072 lds
    s_add_u32 m0, s40, 28672
    s_add_u32 s38, s38, 20480
    buffer_load_dwordx4 v14, s[8:11], s43 offen lds
    s_waitcnt vmcnt(15)
    s_barrier
    s_add_u32 m0, s40, 49152
    s_add_u32 s43, s38, 4096
    buffer_load_dwordx4 v14, s[8:11], s38 offen offset:0 lds
    buffer_load_dwordx4 v14, s[8:11], s38 offen offset:1024 lds
    buffer_load_dwordx4 v14, s[8:11], s38 offen offset:2048 lds
    buffer_load_dwordx4 v14, s[8:11], s38 offen offset:3072 lds
    s_add_u32 m0, s40, 53248
    s_add_u32 s38, s38, 20480
    buffer_load_dwordx4 v14, s[8:11], s43 offen lds
    s_waitcnt vmcnt(15)
    s_barrier
    s_add_u32 m0, s40, 73728
    s_add_u32 s43, s38, 4096
    buffer_load_dwordx4 v14, s[8:11], s38 offen offset:0 lds
    buffer_load_dwordx4 v14, s[8:11], s38 offen offset:1024 lds
    buffer_load_dwordx4 v14, s[8:11], s38 offen offset:2048 lds
    buffer_load_dwordx4 v14, s[8:11], s38 offen offset:3072 lds
    s_add_u32 m0, s40, 77824
    s_add_u32 s38, s38, 20480
    buffer_load_dwordx4 v14, s[8:11], s43 offen lds
    s_waitcnt vmcnt(15)
    s_barrier
    s_add_u32 m0, s40, 98304
    s_add_u32 s43, s38, 4096
    buffer_load_dwordx4 v14, s[8:11], s38 offen offset:0 lds
    buffer_load_dwordx4 v14, s[8:11], s38 offen offset:1024 lds
    buffer_load_dwordx4 v14, s[8:11], s38 offen offset:2048 lds
    buffer_load_dwordx4 v14, s[8:11], s38 offen offset:3072 lds
    s_add_u32 m0, s40, 102400
    s_add_u32 s38, s38, 20480
    buffer_load_dwordx4 v14, s[8:11], s43 offen lds
    s_waitcnt vmcnt(15)
    s_barrier
    s_add_u32 m0, s40, 122880
    s_add_u32 s43, s38, 4096
    buffer_load_dwordx4 v14, s[8:11], s38 offen offset:0 lds
    buffer_load_dwordx4 v14, s[8:11], s38 offen offset:1024 lds
    buffer_load_dwordx4 v14, s[8:11], s38 offen offset:2048 lds
    buffer_load_dwordx4 v14, s[8:11], s38 offen offset:3072 lds
    s_add_u32 m0, s40, 126976
    s_add_u32 s38, s38, 20480
    buffer_load_dwordx4 v14, s[8:11], s43 offen lds
    s_waitcnt vmcnt(15)
    s_barrier
    s_add_u32 m0, s40, 0
    s_add_u32 s43, s38, 4096
    buffer_load_dwordx4 v14, s[8:11], s38 offen offset:0 lds
    buffer_load_dwordx4 v14, s[8:11], s38 offen offset:1024 lds
    buffer_load_dwordx4 v14, s[8:11], s38 offen offset:2048 lds
    buffer_load_dwordx4 v14, s[8:11], s38 offen offset:3072 lds
    s_add_u32 m0, s40, 4096
    s_add_u32 s38, s38, 20480
    buffer_load_dwordx4 v14, s[8:11], s43 offen lds
    s_waitcnt vmcnt(15)
    s_barrier
    s_add_u32 m0, s40, 24576
    s_add_u32 s43, s38, 4096
    buffer_load_dwordx4 v14, s[8:11], s38 offen offset:0 lds
    buffer_load_dwordx4 v14, s[8:11], s38 offen offset:1024 lds
    buffer_load_dwordx4 v14, s[8:11], s38 offen offset:2048 lds
    buffer_load_dwordx4 v14, s[8:11], s38 offen offset:3072 lds
    s_add_u32 m0, s40, 28672
    s_add_u32 s38, s38, 20480
    buffer_load_dwordx4 v14, s[8:11], s43 offen lds
    s_waitcnt vmcnt(15)
    s_barrier
    s_add_u32 m0, s40, 49152
    s_add_u32 s43, s38, 4096
    buffer_load_dwordx4 v14, s[8:11], s38 offen offset:0 lds
    buffer_load_dwordx4 v14, s[8:11], s38 offen offset:1024 lds
    buffer_load_dwordx4 v14, s[8:11], s38 offen offset:2048 lds
    buffer_load_dwordx4 v14, s[8:11], s38 offen offset:3072 lds
    s_add_u32 m0, s40, 53248
    s_add_u32 s38, s38, 20480
    buffer_load_dwordx4 v14, s[8:11], s43 offen lds
    s_waitcnt vmcnt(15)
    s_barrier
    s_add_u32 m0, s42, 73728
    s_nop 0
    buffer_load_dwordx4 v8, s[12:15], s39 offen offset:0 lds
    buffer_load_dwordx4 v9, s[12:15], s39 offen offset:1024 lds
    buffer_load_dwordx4 v10, s[12:15], s39 offen offset:2048 lds
    buffer_load_dwordx4 v11, s[12:15], s39 offen offset:3072 lds
    s_add_u32 s39, s39, 245760
    s_waitcnt vmcnt(14)
    s_barrier
    s_add_u32 m0, s42, 98304
    s_nop 0
    buffer_load_dwordx4 v8, s[12:15], s39 offen offset:0 lds
    buffer_load_dwordx4 v9, s[12:15], s39 offen offset:1024 lds
    buffer_load_dwordx4 v10, s[12:15], s39 offen offset:2048 lds
    buffer_load_dwordx4 v11, s[12:15], s39 offen offset:3072 lds
    s_add_u32 s39, s39, 245760
    s_waitcnt vmcnt(13)
    s_barrier
    s_add_u32 m0, s42, 122880
    s_nop 0
    buffer_load_dwordx4 v8, s[12:15], s39 offen offset:0 lds
    buffer_load_dwordx4 v9, s[12:15], s39 offen offset:1024 lds
    buffer_load_dwordx4 v10, s[12:15], s39 offen offset:2048 lds
    buffer_load_dwordx4 v11, s[12:15], s39 offen offset:3072 lds
    s_add_u32 s39, s39, 245760
    s_waitcnt vmcnt(12)
    s_barrier
    s_add_u32 m0, s42, 0
    s_nop 0
    buffer_load_dwordx4 v8, s[12:15], s39 offen offset:0 lds
    buffer_load_dwordx4 v9, s[12:15], s39 offen offset:1024 lds
    buffer_load_dwordx4 v10, s[12:15], s39 offen offset:2048 lds
    buffer_load_dwordx4 v11, s[12:15], s39 offen offset:3072 lds
    s_add_u32 s39, s39, 245760
    s_waitcnt vmcnt(12)
    s_barrier
    s_cmp_ge_u32 s71, 15
    s_cbranch_scc1 L_ch0_kernel_end
    s_add_u32 m0, s42, 24576
    s_nop 0
    buffer_load_dwordx4 v8, s[12:15], s39 offen offset:0 lds
    buffer_load_dwordx4 v9, s[12:15], s39 offen offset:1024 lds
    buffer_load_dwordx4 v10, s[12:15], s39 offen offset:2048 lds
    buffer_load_dwordx4 v11, s[12:15], s39 offen offset:3072 lds
    s_add_u32 s39, s39, 245760
    s_waitcnt vmcnt(12)
    s_barrier
    s_add_u32 m0, s42, 49152
    s_nop 0
    buffer_load_dwordx4 v8, s[12:15], s39 offen offset:0 lds
    buffer_load_dwordx4 v9, s[12:15], s39 offen offset:1024 lds
    buffer_load_dwordx4 v10, s[12:15], s39 offen offset:2048 lds
    buffer_load_dwordx4 v11, s[12:15], s39 offen offset:3072 lds
    s_add_u32 s39, s39, 245760
    s_waitcnt vmcnt(12)
    s_barrier
    s_add_u32 m0, s42, 73728
    s_nop 0
    buffer_load_dwordx4 v8, s[12:15], s39 offen offset:0 lds
    buffer_load_dwordx4 v9, s[12:15], s39 offen offset:1024 lds
    buffer_load_dwordx4 v10, s[12:15], s39 offen offset:2048 lds
    buffer_load_dwordx4 v11, s[12:15], s39 offen offset:3072 lds
    s_add_u32 s39, s39, 245760
    s_waitcnt vmcnt(12)
    s_barrier
    s_add_u32 m0, s42, 98304
    s_nop 0
    buffer_load_dwordx4 v8, s[12:15], s39 offen offset:0 lds
    buffer_load_dwordx4 v9, s[12:15], s39 offen offset:1024 lds
    buffer_load_dwordx4 v10, s[12:15], s39 offen offset:2048 lds
    buffer_load_dwordx4 v11, s[12:15], s39 offen offset:3072 lds
    s_add_u32 s39, s39, 245760
    s_waitcnt vmcnt(12)
    s_barrier
    s_add_u32 m0, s42, 122880
    s_nop 0
    buffer_load_dwordx4 v8, s[12:15], s39 offen offset:0 lds
    buffer_load_dwordx4 v9, s[12:15], s39 offen offset:1024 lds
    buffer_load_dwordx4 v10, s[12:15], s39 offen offset:2048 lds
    buffer_load_dwordx4 v11, s[12:15], s39 offen offset:3072 lds
    s_add_u32 s39, s39, 245760
    s_waitcnt vmcnt(12)
    s_barrier
    s_add_u32 m0, s42, 0
    s_nop 0
    buffer_load_dwordx4 v8, s[12:15], s39 offen offset:0 lds
    buffer_load_dwordx4 v9, s[12:15], s39 offen offset:1024 lds
    buffer_load_dwordx4 v10, s[12:15], s39 offen offset:2048 lds
    buffer_load_dwordx4 v11, s[12:15], s39 offen offset:3072 lds
    s_add_u32 s39, s39, 245760
    s_waitcnt vmcnt(12)
    s_barrier
    s_waitcnt vmcnt(8)
    s_barrier
    s_waitcnt vmcnt(4)
    s_barrier
    s_waitcnt vmcnt(0)
    s_barrier
    s_barrier
    s_endpgm
L_ch0_kernel_cons:
    s_setprio 3
    s_mov_b32 s44, 0
    s_mov_b32 s60, 24576
    v_mov_b32 v15, 1
    v_mov_b32 v13, 0
    s_waitcnt lgkmcnt(0)
    s_add_u32 s52, s28, 0x3000000
    s_addc_u32 s53, s29, 0
    s_mov_b32 s54, 0x10000
    s_mov_b32 s55, 0x00020000
    s_mov_b32 s44, 0
    s_lshr_b32 s42, s35, 1
    s_and_b32 s43, s35, 1
    s_lshl_b32 s46, s66, 1
    s_add_u32 s46, s46, s42
    v_and_b32 v3, 15, v1
    s_lshl_b32 s45, s43, 4
    v_add_u32 v3, s45, v3
    v_lshrrev_b32 v4, 4, v1
    v_mul_u32_u24 v29, 1280, v3
    v_lshl_add_u32 v29, v4, 3, v29
    v_lshrrev_b32 v5, 1, v4
    v_lshlrev_b32 v28, 9, v5
    v_and_b32 v5, 1, v4
    v_lshl_add_u32 v28, v5, 3, v28
    v_lshl_add_u32 v28, v3, 4, v28
    s_mul_i32 s47, s46, 40960
    s_mul_i32 s48, s67, 5120
    s_add_u32 s47, s47, s48
    s_mul_i32 s48, s46, 40960
    s_mul_i32 s49, s67, 160
    s_add_u32 s48, s48, s49
    s_add_u32 s49, s47, 4096
    v_lshlrev_b32 v7, 6, v3
    v_lshrrev_b32 v5, 2, v1
    v_mul_u32_u24 v5, 160, v5
    v_and_b32 v6, 3, v1
    v_lshl_add_u32 v16, v6, 3, v5
    v_add_u32 v16, s44, v16
    v_lshlrev_b32 v5, 4, v3
    v_lshl_add_u32 v17, v4, 9, v5
    s_mul_i32 s37, s46, 40960
    s_lshl_b32 s50, s46, 11
    s_lshl_b32 s43, s67, 3
    s_add_u32 s50, s50, s43
    s_add_u32 s4, s28, 0xa00000
    s_addc_u32 s5, s29, 0
    s_mov_b32 s6, 0x280000
    s_mov_b32 s7, 0x00020000
    s_mov_b32 s12, s20
    s_mov_b32 s13, s21
    s_mov_b32 s14, 0x280000
    s_mov_b32 s15, 0x00020000
    s_add_u32 s16, s28, 0xe00000
    s_addc_u32 s17, s29, 0
    s_mov_b32 s18, 0x280000
    s_mov_b32 s19, 0x00020000
    s_add_u32 s56, s28, 0x2000000
    s_addc_u32 s57, s29, 0
    s_mov_b32 s58, 0x20000
    s_mov_b32 s59, 0x00020000
    buffer_load_dwordx2 v[18:19], v29, s[12:15], s48 offen offset:0
    buffer_load_dwordx2 v[20:21], v29, s[12:15], s48 offen offset:32
    buffer_load_dwordx2 v[22:23], v29, s[12:15], s48 offen offset:64
    buffer_load_dwordx2 v[24:25], v29, s[12:15], s48 offen offset:96
    buffer_load_dwordx2 v[26:27], v29, s[12:15], s48 offen offset:128
    buffer_load_dwordx4 v[112:115], v17, s[4:7], s37 offen offset:0 sc1
    buffer_load_dwordx4 v[116:119], v17, s[4:7], s37 offen offset:2048 sc1
    s_add_u32 s37, s37, 4096
    buffer_load_dwordx4 v[120:123], v17, s[4:7], s37 offen offset:0 sc1
    buffer_load_dwordx4 v[124:127], v17, s[4:7], s37 offen offset:2048 sc1
    s_add_u32 s37, s37, 4096
    buffer_load_dwordx4 v[128:131], v17, s[4:7], s37 offen offset:0 sc1
    buffer_load_dwordx4 v[132:135], v17, s[4:7], s37 offen offset:2048 sc1
    s_add_u32 s37, s37, 4096
    buffer_load_dwordx4 v[136:139], v17, s[4:7], s37 offen offset:0 sc1
    buffer_load_dwordx4 v[140:143], v17, s[4:7], s37 offen offset:2048 sc1
    s_add_u32 s37, s37, 4096
    buffer_load_dwordx4 v[144:147], v17, s[4:7], s37 offen offset:0 sc1
    buffer_load_dwordx4 v[148:151], v17, s[4:7], s37 offen offset:2048 sc1
    s_add_u32 s37, s37, 4096
    buffer_load_dwordx4 v[152:155], v17, s[4:7], s37 offen offset:0 sc1
    buffer_load_dwordx4 v[156:159], v17, s[4:7], s37 offen offset:2048 sc1
    s_add_u32 s37, s37, 4096
    buffer_load_dwordx4 v[160:163], v17, s[4:7], s37 offen offset:0 sc1
    buffer_load_dwordx4 v[164:167], v17, s[4:7], s37 offen offset:2048 sc1
    s_add_u32 s37, s37, 4096
    buffer_load_dwordx4 v[168:171], v17, s[4:7], s37 offen offset:0 sc1
    buffer_load_dwordx4 v[172:175], v17, s[4:7], s37 offen offset:2048 sc1
    s_add_u32 s37, s37, 4096
    buffer_load_dwordx4 v[176:179], v17, s[4:7], s37 offen offset:0 sc1
    buffer_load_dwordx4 v[180:183], v17, s[4:7], s37 offen offset:2048 sc1
    s_add_u32 s37, s37, 4096
    buffer_load_dwordx4 v[184:187], v17, s[4:7], s37 offen offset:0 sc1
    buffer_load_dwordx4 v[188:191], v17, s[4:7], s37 offen offset:2048 sc1
    s_add_u32 s37, s37, 4096
    s_waitcnt vmcnt(20)
    v_lshlrev_b32 v72, 16, v18
    v_and_b32 v73, 0xffff0000, v18
    v_lshlrev_b32 v74, 16, v19
    v_and_b32 v75, 0xffff0000, v19
    v_lshlrev_b32 v76, 16, v20
    v_and_b32 v77, 0xffff0000, v20
    v_lshlrev_b32 v78, 16, v21
    v_and_b32 v79, 0xffff0000, v21
    v_lshlrev_b32 v80, 16, v22
    v_and_b32 v81, 0xffff0000, v22
    v_lshlrev_b32 v82, 16, v23
    v_and_b32 v83, 0xffff0000, v23
    v_lshlrev_b32 v84, 16, v24
    v_and_b32 v85, 0xffff0000, v24
    v_lshlrev_b32 v86, 16, v25
    v_and_b32 v87, 0xffff0000, v25
    v_lshlrev_b32 v88, 16, v26
    v_and_b32 v89, 0xffff0000, v26
    v_lshlrev_b32 v90, 16, v27
    v_and_b32 v91, 0xffff0000, v27
    s_barrier
    ds_read_b64_tr_b16 v[32:33], v16 offset:0
    ds_read_b64_tr_b16 v[34:35], v16 offset:2560
    ds_read_b64_tr_b16 v[36:37], v16 offset:32
    ds_read_b64_tr_b16 v[38:39], v16 offset:2592
    ds_read_b64_tr_b16 v[40:41], v16 offset:64
    ds_read_b64_tr_b16 v[42:43], v16 offset:2624
    ds_read_b64_tr_b16 v[44:45], v16 offset:96
    ds_read_b64_tr_b16 v[46:47], v16 offset:2656
    ds_read_b64_tr_b16 v[48:49], v16 offset:128
    ds_read_b64_tr_b16 v[50:51], v16 offset:2688
    s_waitcnt vmcnt(19)
    s_waitcnt lgkmcnt(8)
    v_mfma_f32_16x16x32_bf16 v[72:75], v[32:35], v[112:115], v[72:75]
    ds_read_b64_tr_b16 v[52:53], v16 offset:5120
    ds_read_b64_tr_b16 v[54:55], v16 offset:7680
    s_waitcnt lgkmcnt(8)
    v_mfma_f32_16x16x32_bf16 v[76:79], v[36:39], v[112:115], v[76:79]
    ds_read_b64_tr_b16 v[56:57], v16 offset:5152
    ds_read_b64_tr_b16 v[58:59], v16 offset:7712
    s_waitcnt lgkmcnt(8)
    v_mfma_f32_16x16x32_bf16 v[80:83], v[40:43], v[112:115], v[80:83]
    ds_read_b64_tr_b16 v[60:61], v16 offset:5184
    ds_read_b64_tr_b16 v[62:63], v16 offset:7744
    s_waitcnt lgkmcnt(8)
    v_mfma_f32_16x16x32_bf16 v[84:87], v[44:47], v[112:115], v[84:87]
    ds_read_b64_tr_b16 v[64:65], v16 offset:5216
    ds_read_b64_tr_b16 v[66:67], v16 offset:7776
    s_waitcnt lgkmcnt(8)
    v_mfma_f32_16x16x32_bf16 v[88:91], v[48:51], v[112:115], v[88:91]
    ds_read_b64_tr_b16 v[68:69], v16 offset:5248
    ds_read_b64_tr_b16 v[70:71], v16 offset:7808
    s_waitcnt vmcnt(18)
    s_waitcnt lgkmcnt(8)
    v_mfma_f32_16x16x32_bf16 v[72:75], v[52:55], v[116:119], v[72:75]
    ds_read_b64_tr_b16 v[32:33], v16 offset:10240
    ds_read_b64_tr_b16 v[34:35], v16 offset:12800
    s_waitcnt lgkmcnt(8)
    v_mfma_f32_16x16x32_bf16 v[76:79], v[56:59], v[116:119], v[76:79]
    ds_read_b64_tr_b16 v[36:37], v16 offset:10272
    ds_read_b64_tr_b16 v[38:39], v16 offset:12832
    s_waitcnt lgkmcnt(8)
    v_mfma_f32_16x16x32_bf16 v[80:83], v[60:63], v[116:119], v[80:83]
    ds_read_b64_tr_b16 v[40:41], v16 offset:10304
    ds_read_b64_tr_b16 v[42:43], v16 offset:12864
    s_waitcnt lgkmcnt(8)
    v_mfma_f32_16x16x32_bf16 v[84:87], v[64:67], v[116:119], v[84:87]
    ds_read_b64_tr_b16 v[44:45], v16 offset:10336
    ds_read_b64_tr_b16 v[46:47], v16 offset:12896
    s_waitcnt lgkmcnt(8)
    v_mfma_f32_16x16x32_bf16 v[88:91], v[68:71], v[116:119], v[88:91]
    ds_read_b64_tr_b16 v[48:49], v16 offset:10368
    ds_read_b64_tr_b16 v[50:51], v16 offset:12928
    s_waitcnt vmcnt(17)
    s_waitcnt lgkmcnt(8)
    v_mfma_f32_16x16x32_bf16 v[72:75], v[32:35], v[120:123], v[72:75]
    ds_read_b64_tr_b16 v[52:53], v16 offset:15360
    ds_read_b64_tr_b16 v[54:55], v16 offset:17920
    s_waitcnt lgkmcnt(8)
    v_mfma_f32_16x16x32_bf16 v[76:79], v[36:39], v[120:123], v[76:79]
    ds_read_b64_tr_b16 v[56:57], v16 offset:15392
    ds_read_b64_tr_b16 v[58:59], v16 offset:17952
    s_waitcnt lgkmcnt(8)
    v_mfma_f32_16x16x32_bf16 v[80:83], v[40:43], v[120:123], v[80:83]
    ds_read_b64_tr_b16 v[60:61], v16 offset:15424
    ds_read_b64_tr_b16 v[62:63], v16 offset:17984
    s_waitcnt lgkmcnt(8)
    v_mfma_f32_16x16x32_bf16 v[84:87], v[44:47], v[120:123], v[84:87]
    ds_read_b64_tr_b16 v[64:65], v16 offset:15456
    ds_read_b64_tr_b16 v[66:67], v16 offset:18016
    s_waitcnt lgkmcnt(8)
    v_mfma_f32_16x16x32_bf16 v[88:91], v[48:51], v[120:123], v[88:91]
    ds_read_b64_tr_b16 v[68:69], v16 offset:15488
    ds_read_b64_tr_b16 v[70:71], v16 offset:18048
    s_barrier
    s_add_u32 s60, s44, 24576
    s_cmp_gt_u32 s60, 122880
    s_cselect_b32 s60, 0, s60
    s_sub_u32 s45, s60, s44
    s_mov_b32 s44, s60
    v_add_u32 v16, s45, v16
    s_waitcnt vmcnt(16)
    s_waitcnt lgkmcnt(8)
    v_mfma_f32_16x16x32_bf16 v[72:75], v[52:55], v[124:127], v[72:75]
    ds_read_b64_tr_b16 v[32:33], v16 offset:0
    ds_read_b64_tr_b16 v[34:35], v16 offset:2560
    s_waitcnt lgkmcnt(8)
    v_mfma_f32_16x16x32_bf16 v[76:79], v[56:59], v[124:127], v[76:79]
    ds_read_b64_tr_b16 v[36:37], v16 offset:32
    ds_read_b64_tr_b16 v[38:39], v16 offset:2592
    s_waitcnt lgkmcnt(8)
    v_mfma_f32_16x16x32_bf16 v[80:83], v[60:63], v[124:127], v[80:83]
    ds_read_b64_tr_b16 v[40:41], v16 offset:64
    ds_read_b64_tr_b16 v[42:43], v16 offset:2624
    s_waitcnt lgkmcnt(8)
    v_mfma_f32_16x16x32_bf16 v[84:87], v[64:67], v[124:127], v[84:87]
    ds_read_b64_tr_b16 v[44:45], v16 offset:96
    ds_read_b64_tr_b16 v[46:47], v16 offset:2656
    s_waitcnt lgkmcnt(8)
    v_mfma_f32_16x16x32_bf16 v[88:91], v[68:71], v[124:127], v[88:91]
    ds_read_b64_tr_b16 v[48:49], v16 offset:128
    ds_read_b64_tr_b16 v[50:51], v16 offset:2688
    s_waitcnt vmcnt(15)
    s_waitcnt lgkmcnt(8)
    v_mfma_f32_16x16x32_bf16 v[72:75], v[32:35], v[128:131], v[72:75]
    ds_read_b64_tr_b16 v[52:53], v16 offset:5120
    ds_read_b64_tr_b16 v[54:55], v16 offset:7680
    s_waitcnt lgkmcnt(8)
    v_mfma_f32_16x16x32_bf16 v[76:79], v[36:39], v[128:131], v[76:79]
    ds_read_b64_tr_b16 v[56:57], v16 offset:5152
    ds_read_b64_tr_b16 v[58:59], v16 offset:7712
    s_waitcnt lgkmcnt(8)
    v_mfma_f32_16x16x32_bf16 v[80:83], v[40:43], v[128:131], v[80:83]
    ds_read_b64_tr_b16 v[60:61], v16 offset:5184
    ds_read_b64_tr_b16 v[62:63], v16 offset:7744
    s_waitcnt lgkmcnt(8)
    v_mfma_f32_16x16x32_bf16 v[84:87], v[44:47], v[128:131], v[84:87]
    ds_read_b64_tr_b16 v[64:65], v16 offset:5216
    ds_read_b64_tr_b16 v[66:67], v16 offset:7776
    s_waitcnt lgkmcnt(8)
    v_mfma_f32_16x16x32_bf16 v[88:91], v[48:51], v[128:131], v[88:91]
    ds_read_b64_tr_b16 v[68:69], v16 offset:5248
    ds_read_b64_tr_b16 v[70:71], v16 offset:7808
    s_waitcnt vmcnt(14)
    s_waitcnt lgkmcnt(8)
    v_mfma_f32_16x16x32_bf16 v[72:75], v[52:55], v[132:135], v[72:75]
    ds_read_b64_tr_b16 v[32:33], v16 offset:10240
    ds_read_b64_tr_b16 v[34:35], v16 offset:12800
    s_waitcnt lgkmcnt(8)
    v_mfma_f32_16x16x32_bf16 v[76:79], v[56:59], v[132:135], v[76:79]
    ds_read_b64_tr_b16 v[36:37], v16 offset:10272
    ds_read_b64_tr_b16 v[38:39], v16 offset:12832
    s_waitcnt lgkmcnt(8)
    v_mfma_f32_16x16x32_bf16 v[80:83], v[60:63], v[132:135], v[80:83]
    ds_read_b64_tr_b16 v[40:41], v16 offset:10304
    ds_read_b64_tr_b16 v[42:43], v16 offset:12864
    s_waitcnt lgkmcnt(8)
    v_mfma_f32_16x16x32_bf16 v[84:87], v[64:67], v[132:135], v[84:87]
    ds_read_b64_tr_b16 v[44:45], v16 offset:10336
    ds_read_b64_tr_b16 v[46:47], v16 offset:12896
    s_waitcnt lgkmcnt(8)
    v_mfma_f32_16x16x32_bf16 v[88:91], v[68:71], v[132:135], v[88:91]
    ds_read_b64_tr_b16 v[48:49], v16 offset:10368
    ds_read_b64_tr_b16 v[50:51], v16 offset:12928
    s_waitcnt vmcnt(13)
    s_waitcnt lgkmcnt(8)
    v_mfma_f32_16x16x32_bf16 v[72:75], v[32:35], v[136:139], v[72:75]
    ds_read_b64_tr_b16 v[52:53], v16 offset:15360
    ds_read_b64_tr_b16 v[54:55], v16 offset:17920
    s_waitcnt lgkmcnt(8)
    v_mfma_f32_16x16x32_bf16 v[76:79], v[36:39], v[136:139], v[76:79]
    ds_read_b64_tr_b16 v[56:57], v16 offset:15392
    ds_read_b64_tr_b16 v[58:59], v16 offset:17952
    s_waitcnt lgkmcnt(8)
    v_mfma_f32_16x16x32_bf16 v[80:83], v[40:43], v[136:139], v[80:83]
    ds_read_b64_tr_b16 v[60:61], v16 offset:15424
    ds_read_b64_tr_b16 v[62:63], v16 offset:17984
    s_waitcnt lgkmcnt(8)
    v_mfma_f32_16x16x32_bf16 v[84:87], v[44:47], v[136:139], v[84:87]
    ds_read_b64_tr_b16 v[64:65], v16 offset:15456
    ds_read_b64_tr_b16 v[66:67], v16 offset:18016
    s_waitcnt lgkmcnt(8)
    v_mfma_f32_16x16x32_bf16 v[88:91], v[48:51], v[136:139], v[88:91]
    ds_read_b64_tr_b16 v[68:69], v16 offset:15488
    ds_read_b64_tr_b16 v[70:71], v16 offset:18048
    s_barrier
    s_add_u32 s60, s44, 24576
    s_cmp_gt_u32 s60, 122880
    s_cselect_b32 s60, 0, s60
    s_sub_u32 s45, s60, s44
    s_mov_b32 s44, s60
    v_add_u32 v16, s45, v16
    s_waitcnt vmcnt(12)
    s_waitcnt lgkmcnt(8)
    v_mfma_f32_16x16x32_bf16 v[72:75], v[52:55], v[140:143], v[72:75]
    ds_read_b64_tr_b16 v[32:33], v16 offset:0
    ds_read_b64_tr_b16 v[34:35], v16 offset:2560
    s_waitcnt lgkmcnt(8)
    v_mfma_f32_16x16x32_bf16 v[76:79], v[56:59], v[140:143], v[76:79]
    ds_read_b64_tr_b16 v[36:37], v16 offset:32
    ds_read_b64_tr_b16 v[38:39], v16 offset:2592
    s_waitcnt lgkmcnt(8)
    v_mfma_f32_16x16x32_bf16 v[80:83], v[60:63], v[140:143], v[80:83]
    ds_read_b64_tr_b16 v[40:41], v16 offset:64
    ds_read_b64_tr_b16 v[42:43], v16 offset:2624
    s_waitcnt lgkmcnt(8)
    v_mfma_f32_16x16x32_bf16 v[84:87], v[64:67], v[140:143], v[84:87]
    ds_read_b64_tr_b16 v[44:45], v16 offset:96
    ds_read_b64_tr_b16 v[46:47], v16 offset:2656
    s_waitcnt lgkmcnt(8)
    v_mfma_f32_16x16x32_bf16 v[88:91], v[68:71], v[140:143], v[88:91]
    ds_read_b64_tr_b16 v[48:49], v16 offset:128
    ds_read_b64_tr_b16 v[50:51], v16 offset:2688
    s_waitcnt vmcnt(11)
    s_waitcnt lgkmcnt(8)
    v_mfma_f32_16x16x32_bf16 v[72:75], v[32:35], v[144:147], v[72:75]
    ds_read_b64_tr_b16 v[52:53], v16 offset:5120
    ds_read_b64_tr_b16 v[54:55], v16 offset:7680
    s_waitcnt lgkmcnt(8)
    v_mfma_f32_16x16x32_bf16 v[76:79], v[36:39], v[144:147], v[76:79]
    ds_read_b64_tr_b16 v[56:57], v16 offset:5152
    ds_read_b64_tr_b16 v[58:59], v16 offset:7712
    s_waitcnt lgkmcnt(8)
    v_mfma_f32_16x16x32_bf16 v[80:83], v[40:43], v[144:147], v[80:83]
    ds_read_b64_tr_b16 v[60:61], v16 offset:5184
    ds_read_b64_tr_b16 v[62:63], v16 offset:7744
    s_waitcnt lgkmcnt(8)
    v_mfma_f32_16x16x32_bf16 v[84:87], v[44:47], v[144:147], v[84:87]
    ds_read_b64_tr_b16 v[64:65], v16 offset:5216
    ds_read_b64_tr_b16 v[66:67], v16 offset:7776
    s_waitcnt lgkmcnt(8)
    v_mfma_f32_16x16x32_bf16 v[88:91], v[48:51], v[144:147], v[88:91]
    ds_read_b64_tr_b16 v[68:69], v16 offset:5248
    ds_read_b64_tr_b16 v[70:71], v16 offset:7808
    s_waitcnt vmcnt(10)
    s_waitcnt lgkmcnt(8)
    v_mfma_f32_16x16x32_bf16 v[72:75], v[52:55], v[148:151], v[72:75]
    ds_read_b64_tr_b16 v[32:33], v16 offset:10240
    ds_read_b64_tr_b16 v[34:35], v16 offset:12800
    s_waitcnt lgkmcnt(8)
    v_mfma_f32_16x16x32_bf16 v[76:79], v[56:59], v[148:151], v[76:79]
    ds_read_b64_tr_b16 v[36:37], v16 offset:10272
    ds_read_b64_tr_b16 v[38:39], v16 offset:12832
    s_waitcnt lgkmcnt(8)
    v_mfma_f32_16x16x32_bf16 v[80:83], v[60:63], v[148:151], v[80:83]
    ds_read_b64_tr_b16 v[40:41], v16 offset:10304
    ds_read_b64_tr_b16 v[42:43], v16 offset:12864
    s_waitcnt lgkmcnt(8)
    v_mfma_f32_16x16x32_bf16 v[84:87], v[64:67], v[148:151], v[84:87]
    ds_read_b64_tr_b16 v[44:45], v16 offset:10336
    ds_read_b64_tr_b16 v[46:47], v16 offset:12896
    s_waitcnt lgkmcnt(8)
    v_mfma_f32_16x16x32_bf16 v[88:91], v[68:71], v[148:151], v[88:91]
    ds_read_b64_tr_b16 v[48:49], v16 offset:10368
    ds_read_b64_tr_b16 v[50:51], v16 offset:12928
    s_waitcnt vmcnt(9)
    s_waitcnt lgkmcnt(8)
    v_mfma_f32_16x16x32_bf16 v[72:75], v[32:35], v[152:155], v[72:75]
    ds_read_b64_tr_b16 v[52:53], v16 offset:15360
    ds_read_b64_tr_b16 v[54:55], v16 offset:17920
    s_waitcnt lgkmcnt(8)
    v_mfma_f32_16x16x32_bf16 v[76:79], v[36:39], v[152:155], v[76:79]
    ds_read_b64_tr_b16 v[56:57], v16 offset:15392
    ds_read_b64_tr_b16 v[58:59], v16 offset:17952
    s_waitcnt lgkmcnt(8)
    v_mfma_f32_16x16x32_bf16 v[80:83], v[40:43], v[152:155], v[80:83]
    ds_read_b64_tr_b16 v[60:61], v16 offset:15424
    ds_read_b64_tr_b16 v[62:63], v16 offset:17984
    s_waitcnt lgkmcnt(8)
    v_mfma_f32_16x16x32_bf16 v[84:87], v[44:47], v[152:155], v[84:87]
    ds_read_b64_tr_b16 v[64:65], v16 offset:15456
    ds_read_b64_tr_b16 v[66:67], v16 offset:18016
    s_waitcnt lgkmcnt(8)
    v_mfma_f32_16x16x32_bf16 v[88:91], v[48:51], v[152:155], v[88:91]
    ds_read_b64_tr_b16 v[68:69], v16 offset:15488
    ds_read_b64_tr_b16 v[70:71], v16 offset:18048
    s_barrier
    s_add_u32 s60, s44, 24576
    s_cmp_gt_u32 s60, 122880
    s_cselect_b32 s60, 0, s60
    s_sub_u32 s45, s60, s44
    s_mov_b32 s44, s60
    v_add_u32 v16, s45, v16
    s_waitcnt vmcnt(8)
    s_waitcnt lgkmcnt(8)
    v_mfma_f32_16x16x32_bf16 v[72:75], v[52:55], v[156:159], v[72:75]
    ds_read_b64_tr_b16 v[32:33], v16 offset:0
    ds_read_b64_tr_b16 v[34:35], v16 offset:2560
    s_waitcnt lgkmcnt(8)
    v_mfma_f32_16x16x32_bf16 v[76:79], v[56:59], v[156:159], v[76:79]
    ds_read_b64_tr_b16 v[36:37], v16 offset:32
    ds_read_b64_tr_b16 v[38:39], v16 offset:2592
    s_waitcnt lgkmcnt(8)
    v_mfma_f32_16x16x32_bf16 v[80:83], v[60:63], v[156:159], v[80:83]
    ds_read_b64_tr_b16 v[40:41], v16 offset:64
    ds_read_b64_tr_b16 v[42:43], v16 offset:2624
    s_waitcnt lgkmcnt(8)
    v_mfma_f32_16x16x32_bf16 v[84:87], v[64:67], v[156:159], v[84:87]
    ds_read_b64_tr_b16 v[44:45], v16 offset:96
    ds_read_b64_tr_b16 v[46:47], v16 offset:2656
    s_waitcnt lgkmcnt(8)
    v_mfma_f32_16x16x32_bf16 v[88:91], v[68:71], v[156:159], v[88:91]
    ds_read_b64_tr_b16 v[48:49], v16 offset:128
    ds_read_b64_tr_b16 v[50:51], v16 offset:2688
    s_waitcnt vmcnt(7)
    s_waitcnt lgkmcnt(8)
    v_mfma_f32_16x16x32_bf16 v[72:75], v[32:35], v[160:163], v[72:75]
    ds_read_b64_tr_b16 v[52:53], v16 offset:5120
    ds_read_b64_tr_b16 v[54:55], v16 offset:7680
    s_waitcnt lgkmcnt(8)
    v_mfma_f32_16x16x32_bf16 v[76:79], v[36:39], v[160:163], v[76:79]
    ds_read_b64_tr_b16 v[56:57], v16 offset:5152
    ds_read_b64_tr_b16 v[58:59], v16 offset:7712
    s_waitcnt lgkmcnt(8)
    v_mfma_f32_16x16x32_bf16 v[80:83], v[40:43], v[160:163], v[80:83]
    ds_read_b64_tr_b16 v[60:61], v16 offset:5184
    ds_read_b64_tr_b16 v[62:63], v16 offset:7744
    s_waitcnt lgkmcnt(8)
    v_mfma_f32_16x16x32_bf16 v[84:87], v[44:47], v[160:163], v[84:87]
    ds_read_b64_tr_b16 v[64:65], v16 offset:5216
    ds_read_b64_tr_b16 v[66:67], v16 offset:7776
    s_waitcnt lgkmcnt(8)
    v_mfma_f32_16x16x32_bf16 v[88:91], v[48:51], v[160:163], v[88:91]
    ds_read_b64_tr_b16 v[68:69], v16 offset:5248
    ds_read_b64_tr_b16 v[70:71], v16 offset:7808
    s_waitcnt vmcnt(6)
    s_waitcnt lgkmcnt(8)
    v_mfma_f32_16x16x32_bf16 v[72:75], v[52:55], v[164:167], v[72:75]
    ds_read_b64_tr_b16 v[32:33], v16 offset:10240
    ds_read_b64_tr_b16 v[34:35], v16 offset:12800
    s_waitcnt lgkmcnt(8)
    v_mfma_f32_16x16x32_bf16 v[76:79], v[56:59], v[164:167], v[76:79]
    ds_read_b64_tr_b16 v[36:37], v16 offset:10272
    ds_read_b64_tr_b16 v[38:39], v16 offset:12832
    s_waitcnt lgkmcnt(8)
    v_mfma_f32_16x16x32_bf16 v[80:83], v[60:63], v[164:167], v[80:83]
    ds_read_b64_tr_b16 v[40:41], v16 offset:10304
    ds_read_b64_tr_b16 v[42:43], v16 offset:12864
    s_waitcnt lgkmcnt(8)
    v_mfma_f32_16x16x32_bf16 v[84:87], v[64:67], v[164:167], v[84:87]
    ds_read_b64_tr_b16 v[44:45], v16 offset:10336
    ds_read_b64_tr_b16 v[46:47], v16 offset:12896
    s_waitcnt lgkmcnt(8)
    v_mfma_f32_16x16x32_bf16 v[88:91], v[68:71], v[164:167], v[88:91]
    ds_read_b64_tr_b16 v[48:49], v16 offset:10368
    ds_read_b64_tr_b16 v[50:51], v16 offset:12928
    s_waitcnt vmcnt(5)
    s_waitcnt lgkmcnt(8)
    v_mfma_f32_16x16x32_bf16 v[72:75], v[32:35], v[168:171], v[72:75]
    ds_read_b64_tr_b16 v[52:53], v16 offset:15360
    ds_read_b64_tr_b16 v[54:55], v16 offset:17920
    s_waitcnt lgkmcnt(8)
    v_mfma_f32_16x16x32_bf16 v[76:79], v[36:39], v[168:171], v[76:79]
    ds_read_b64_tr_b16 v[56:57], v16 offset:15392
    ds_read_b64_tr_b16 v[58:59], v16 offset:17952
    s_waitcnt lgkmcnt(8)
    v_mfma_f32_16x16x32_bf16 v[80:83], v[40:43], v[168:171], v[80:83]
    ds_read_b64_tr_b16 v[60:61], v16 offset:15424
    ds_read_b64_tr_b16 v[62:63], v16 offset:17984
    s_waitcnt lgkmcnt(8)
    v_mfma_f32_16x16x32_bf16 v[84:87], v[44:47], v[168:171], v[84:87]
    ds_read_b64_tr_b16 v[64:65], v16 offset:15456
    ds_read_b64_tr_b16 v[66:67], v16 offset:18016
    s_waitcnt lgkmcnt(8)
    v_mfma_f32_16x16x32_bf16 v[88:91], v[48:51], v[168:171], v[88:91]
    ds_read_b64_tr_b16 v[68:69], v16 offset:15488
    ds_read_b64_tr_b16 v[70:71], v16 offset:18048
    s_barrier
    s_add_u32 s60, s44, 24576
    s_cmp_gt_u32 s60, 122880
    s_cselect_b32 s60, 0, s60
    s_sub_u32 s45, s60, s44
    s_mov_b32 s44, s60
    v_add_u32 v16, s45, v16
    s_waitcnt vmcnt(4)
    s_waitcnt lgkmcnt(8)
    v_mfma_f32_16x16x32_bf16 v[72:75], v[52:55], v[172:175], v[72:75]
    ds_read_b64_tr_b16 v[32:33], v16 offset:0
    ds_read_b64_tr_b16 v[34:35], v16 offset:2560
    s_waitcnt lgkmcnt(8)
    v_mfma_f32_16x16x32_bf16 v[76:79], v[56:59], v[172:175], v[76:79]
    ds_read_b64_tr_b16 v[36:37], v16 offset:32
    ds_read_b64_tr_b16 v[38:39], v16 offset:2592
    s_waitcnt lgkmcnt(8)
    v_mfma_f32_16x16x32_bf16 v[80:83], v[60:63], v[172:175], v[80:83]
    ds_read_b64_tr_b16 v[40:41], v16 offset:64
    ds_read_b64_tr_b16 v[42:43], v16 offset:2624
    s_waitcnt lgkmcnt(8)
    v_mfma_f32_16x16x32_bf16 v[84:87], v[64:67], v[172:175], v[84:87]
    ds_read_b64_tr_b16 v[44:45], v16 offset:96
    ds_read_b64_tr_b16 v[46:47], v16 offset:2656
    s_waitcnt lgkmcnt(8)
    v_mfma_f32_16x16x32_bf16 v[88:91], v[68:71], v[172:175], v[88:91]
    ds_read_b64_tr_b16 v[48:49], v16 offset:128
    ds_read_b64_tr_b16 v[50:51], v16 offset:2688
    s_waitcnt vmcnt(3)
    s_waitcnt lgkmcnt(8)
    v_mfma_f32_16x16x32_bf16 v[72:75], v[32:35], v[176:179], v[72:75]
    ds_read_b64_tr_b16 v[52:53], v16 offset:5120
    ds_read_b64_tr_b16 v[54:55], v16 offset:7680
    s_waitcnt lgkmcnt(8)
    v_mfma_f32_16x16x32_bf16 v[76:79], v[36:39], v[176:179], v[76:79]
    ds_read_b64_tr_b16 v[56:57], v16 offset:5152
    ds_read_b64_tr_b16 v[58:59], v16 offset:7712
    s_waitcnt lgkmcnt(8)
    v_mfma_f32_16x16x32_bf16 v[80:83], v[40:43], v[176:179], v[80:83]
    ds_read_b64_tr_b16 v[60:61], v16 offset:5184
    ds_read_b64_tr_b16 v[62:63], v16 offset:7744
    s_waitcnt lgkmcnt(8)
    v_mfma_f32_16x16x32_bf16 v[84:87], v[44:47], v[176:179], v[84:87]
    ds_read_b64_tr_b16 v[64:65], v16 offset:5216
    ds_read_b64_tr_b16 v[66:67], v16 offset:7776
    s_waitcnt lgkmcnt(8)
    v_mfma_f32_16x16x32_bf16 v[88:91], v[48:51], v[176:179], v[88:91]
    ds_read_b64_tr_b16 v[68:69], v16 offset:5248
    ds_read_b64_tr_b16 v[70:71], v16 offset:7808
    s_waitcnt vmcnt(2)
    s_waitcnt lgkmcnt(8)
    v_mfma_f32_16x16x32_bf16 v[72:75], v[52:55], v[180:183], v[72:75]
    ds_read_b64_tr_b16 v[32:33], v16 offset:10240
    ds_read_b64_tr_b16 v[34:35], v16 offset:12800
    s_waitcnt lgkmcnt(8)
    v_mfma_f32_16x16x32_bf16 v[76:79], v[56:59], v[180:183], v[76:79]
    ds_read_b64_tr_b16 v[36:37], v16 offset:10272
    ds_read_b64_tr_b16 v[38:39], v16 offset:12832
    s_waitcnt lgkmcnt(8)
    v_mfma_f32_16x16x32_bf16 v[80:83], v[60:63], v[180:183], v[80:83]
    ds_read_b64_tr_b16 v[40:41], v16 offset:10304
    ds_read_b64_tr_b16 v[42:43], v16 offset:12864
    s_waitcnt lgkmcnt(8)
    v_mfma_f32_16x16x32_bf16 v[84:87], v[64:67], v[180:183], v[84:87]
    ds_read_b64_tr_b16 v[44:45], v16 offset:10336
    ds_read_b64_tr_b16 v[46:47], v16 offset:12896
    s_waitcnt lgkmcnt(8)
    v_mfma_f32_16x16x32_bf16 v[88:91], v[68:71], v[180:183], v[88:91]
    ds_read_b64_tr_b16 v[48:49], v16 offset:10368
    ds_read_b64_tr_b16 v[50:51], v16 offset:12928
    s_waitcnt vmcnt(1)
    s_waitcnt lgkmcnt(8)
    v_mfma_f32_16x16x32_bf16 v[72:75], v[32:35], v[184:187], v[72:75]
    ds_read_b64_tr_b16 v[52:53], v16 offset:15360
    ds_read_b64_tr_b16 v[54:55], v16 offset:17920
    s_waitcnt lgkmcnt(8)
    v_mfma_f32_16x16x32_bf16 v[76:79], v[36:39], v[184:187], v[76:79]
    ds_read_b64_tr_b16 v[56:57], v16 offset:15392
    ds_read_b64_tr_b16 v[58:59], v16 offset:17952
    s_waitcnt lgkmcnt(8)
    v_mfma_f32_16x16x32_bf16 v[80:83], v[40:43], v[184:187], v[80:83]
    ds_read_b64_tr_b16 v[60:61], v16 offset:15424
    ds_read_b64_tr_b16 v[62:63], v16 offset:17984
    s_waitcnt lgkmcnt(8)
    v_mfma_f32_16x16x32_bf16 v[84:87], v[44:47], v[184:187], v[84:87]
    ds_read_b64_tr_b16 v[64:65], v16 offset:15456
    ds_read_b64_tr_b16 v[66:67], v16 offset:18016
    s_waitcnt lgkmcnt(8)
    v_mfma_f32_16x16x32_bf16 v[88:91], v[48:51], v[184:187], v[88:91]
    ds_read_b64_tr_b16 v[68:69], v16 offset:15488
    ds_read_b64_tr_b16 v[70:71], v16 offset:18048
    s_barrier
    s_add_u32 s60, s44, 24576
    s_cmp_gt_u32 s60, 122880
    s_cselect_b32 s60, 0, s60
    s_sub_u32 s45, s60, s44
    s_mov_b32 s44, s60
    v_add_u32 v16, s45, v16
    s_waitcnt vmcnt(0)
    s_waitcnt lgkmcnt(8)
    v_mfma_f32_16x16x32_bf16 v[72:75], v[52:55], v[188:191], v[72:75]
    s_waitcnt lgkmcnt(6)
    v_mfma_f32_16x16x32_bf16 v[76:79], v[56:59], v[188:191], v[76:79]
    s_waitcnt lgkmcnt(4)
    v_mfma_f32_16x16x32_bf16 v[80:83], v[60:63], v[188:191], v[80:83]
    s_waitcnt lgkmcnt(2)
    v_mfma_f32_16x16x32_bf16 v[84:87], v[64:67], v[188:191], v[84:87]
    s_waitcnt lgkmcnt(0)
    v_mfma_f32_16x16x32_bf16 v[88:91], v[68:71], v[188:191], v[88:91]
    s_waitcnt  lgkmcnt(0)
    s_nop 7
    v_cvt_pk_bf16_f32 v92, v72, v73
    v_cvt_pk_bf16_f32 v93, v74, v75
    buffer_store_dwordx2 v[92:93], v28, s[16:19], s47 offen offset:0 sc1
    v_cvt_pk_bf16_f32 v94, v76, v77
    v_cvt_pk_bf16_f32 v95, v78, v79
    buffer_store_dwordx2 v[94:95], v28, s[16:19], s47 offen offset:1024 sc1
    v_cvt_pk_bf16_f32 v96, v80, v81
    v_cvt_pk_bf16_f32 v97, v82, v83
    buffer_store_dwordx2 v[96:97], v28, s[16:19], s47 offen offset:2048 sc1
    v_cvt_pk_bf16_f32 v98, v84, v85
    v_cvt_pk_bf16_f32 v99, v86, v87
    buffer_store_dwordx2 v[98:99], v28, s[16:19], s47 offen offset:3072 sc1
    v_cvt_pk_bf16_f32 v100, v88, v89
    v_cvt_pk_bf16_f32 v101, v90, v91
    buffer_store_dwordx2 v[100:101], v28, s[16:19], s49 offen sc1
    v_lshlrev_b32 v72, 16, v92
    v_and_b32 v73, 0xffff0000, v92
    v_lshlrev_b32 v74, 16, v93
    v_and_b32 v75, 0xffff0000, v93
    v_pk_add_f32 v[32:33], v[72:73], v[74:75]
    v_pk_mul_f32 v[34:35], v[72:73], v[72:73]
    v_pk_fma_f32 v[34:35], v[74:75], v[74:75], v[34:35]
    v_lshlrev_b32 v76, 16, v94
    v_and_b32 v77, 0xffff0000, v94
    v_lshlrev_b32 v78, 16, v95
    v_and_b32 v79, 0xffff0000, v95
    v_pk_add_f32 v[32:33], v[32:33], v[76:77]
    v_pk_fma_f32 v[34:35], v[76:77], v[76:77], v[34:35]
    v_pk_add_f32 v[32:33], v[32:33], v[78:79]
    v_pk_fma_f32 v[34:35], v[78:79], v[78:79], v[34:35]
    v_lshlrev_b32 v80, 16, v96
    v_and_b32 v81, 0xffff0000, v96
    v_lshlrev_b32 v82, 16, v97
    v_and_b32 v83, 0xffff0000, v97
    v_pk_add_f32 v[32:33], v[32:33], v[80:81]
    v_pk_fma_f32 v[34:35], v[80:81], v[80:81], v[34:35]
    v_pk_add_f32 v[32:33], v[32:33], v[82:83]
    v_pk_fma_f32 v[34:35], v[82:83], v[82:83], v[34:35]
    v_lshlrev_b32 v84, 16, v98
    v_and_b32 v85, 0xffff0000, v98
    v_lshlrev_b32 v86, 16, v99
    v_and_b32 v87, 0xffff0000, v99
    v_pk_add_f32 v[32:33], v[32:33], v[84:85]
    v_pk_fma_f32 v[34:35], v[84:85], v[84:85], v[34:35]
    v_pk_add_f32 v[32:33], v[32:33], v[86:87]
    v_pk_fma_f32 v[34:35], v[86:87], v[86:87], v[34:35]
    v_lshlrev_b32 v88, 16, v100
    v_and_b32 v89, 0xffff0000, v100
    v_lshlrev_b32 v90, 16, v101
    v_and_b32 v91, 0xffff0000, v101
    v_pk_add_f32 v[32:33], v[32:33], v[88:89]
    v_pk_fma_f32 v[34:35], v[88:89], v[88:89], v[34:35]
    v_pk_add_f32 v[32:33], v[32:33], v[90:91]
    v_pk_fma_f32 v[34:35], v[90:91], v[90:91], v[34:35]
    v_add_f32 v32, v32, v33
    v_add_f32 v33, v34, v35
    v_mov_b32 v34, v32
    v_mov_b32 v35, v33
    s_nop 1
    v_permlane16_swap_b32 v32, v34
    v_permlane16_swap_b32 v33, v35
    s_nop 1
    v_add_f32 v32, v32, v34
    v_add_f32 v33, v33, v35
    v_mov_b32 v34, v32
    v_mov_b32 v35, v33
    s_nop 1
    v_permlane32_swap_b32 v32, v34
    v_permlane32_swap_b32 v33, v35
    s_nop 1
    v_add_f32 v32, v32, v34
    v_add_f32 v33, v33, v35
    s_mov_b64 exec, 0xffff
    buffer_store_dwordx2 v[32:33], v7, s[56:59], s50 offen sc1
    s_mov_b64 exec, -1
    s_and_b32 s61, s35, 1
    s_lshl_b32 s43, s67, 1
    s_add_u32 s61, s61, s43
    s_lshl_b32 s62, s46, 7
    s_add_u32 s62, s62, 0
    s_waitcnt vmcnt(0)
    s_mov_b64 exec, 1
    buffer_atomic_add v15, v13, s[52:55], s62 offen sc1
    s_mov_b64 exec, -1
    s_mov_b32 s44, 122880
    s_lshl_b32 s42, s68, 2
    s_add_u32 s42, s42, s35
    v_and_b32 v3, 31, v1
    v_lshlrev_b32 v3, 6, v3
    v_and_b32 v4, 32, v1
    v_add_u32 v16, v3, v4
    s_add_u32 s56, s28, 0x2080000
    s_addc_u32 s57, s29, 0
    s_mov_b32 s58, 0x5000
    s_mov_b32 s59, 0x00020000
    s_lshl_b32 s63, s35, 10
    s_add_u32 m0, s63, 147456
    s_mul_i32 s62, s69, 768
    s_add_u32 s62, s62, 8192
    buffer_load_dwordx4 v14, s[56:59], s62 offen lds
    v_lshrrev_b32 v3, 2, v1
    v_and_b32 v3, 3, v3
    v_lshrrev_b32 v5, 5, v1
    v_lshl_add_u32 v3, v5, 3, v3
    v_mul_u32_u24 v3, 192, v3
    v_and_b32 v4, 3, v1
    v_lshl_add_u32 v3, v4, 3, v3
    v_and_b32 v5, 16, v1
    v_lshl_add_u32 v18, v5, 1, v3
    v_add_u32 v18, s44, v18
    s_add_u32 s4, s28, 0xe00000
    s_addc_u32 s5, s29, 0
    s_mov_b32 s6, 0x280000
    s_mov_b32 s7, 0x00020000
    s_add_u32 s12, s28, 0x2000000
    s_addc_u32 s13, s29, 0
    s_mov_b32 s14, 0x20000
    s_mov_b32 s15, 0x00020000
    s_add_u32 s16, s28, 0x1600000
    s_addc_u32 s17, s29, 0
    s_mov_b32 s18, 0x600000
    s_mov_b32 s19, 0x00020000
    s_mul_i32 s48, s42, 98304
    s_mul_i32 s47, s69, 6144
    s_add_u32 s48, s48, s47
    s_add_u32 s47, s48, 4096
    s_waitcnt vmcnt(0)
    s_lshl_b32 s63, s35, 10
    s_add_u32 s63, s63, 147456
    v_lshrrev_b32 v6, 5, v1
    v_lshlrev_b32 v6, 4, v6
    v_add_u32 v6, s63, v6
    ds_read_b128 v[88:91], v6 offset:0
    ds_read_b128 v[92:95], v6 offset:32
    ds_read_b128 v[96:99], v6 offset:64
    ds_read_b128 v[100:103], v6 offset:96
    ds_read_b128 v[104:107], v6 offset:128
    ds_read_b128 v[108:111], v6 offset:160
    ds_read_b128 v[112:115], v6 offset:192
    ds_read_b128 v[116:119], v6 offset:224
    ds_read_b128 v[120:123], v6 offset:256
    ds_read_b128 v[124:127], v6 offset:288
    ds_read_b128 v[128:131], v6 offset:320
    ds_read_b128 v[132:135], v6 offset:352
    s_waitcnt lgkmcnt(0)
    ds_read_b128 v[136:139], v6 offset:384
    ds_read_b128 v[140:143], v6 offset:416
    ds_read_b128 v[144:147], v6 offset:448
    ds_read_b128 v[148:151], v6 offset:480
    ds_read_b128 v[152:155], v6 offset:512
    ds_read_b128 v[156:159], v6 offset:544
    ds_read_b128 v[160:163], v6 offset:576
    ds_read_b128 v[164:167], v6 offset:608
    ds_read_b128 v[168:171], v6 offset:640
    ds_read_b128 v[172:175], v6 offset:672
    ds_read_b128 v[176:179], v6 offset:704
    ds_read_b128 v[180:183], v6 offset:736
    s_waitcnt lgkmcnt(0)
    s_waitcnt lgkmcnt(0)
    s_lshl_b32 s62, s42, 7
    s_add_u32 s62, s62, 0
    s_mov_b32 s63, 0
L_ch0_kernel_poll_1:
    buffer_load_dword v12, v13, s[52:55], s62 offen sc1
    s_waitcnt vmcnt(0)
    v_readfirstlane_b32 s61, v12
    s_add_u32 s63, s63, 1
    s_cmp_ge_u32 s61, 16
    s_cbranch_scc1 L_ch0_kernel_go_2
    s_cmp_ge_u32 s63, 0x400000
    s_cbranch_scc1 L_ch0_kernel_go_2
    s_sleep 1
    s_branch L_ch0_kernel_poll_1
L_ch0_kernel_go_2:
    s_lshl_b32 s62, s42, 11
    buffer_load_dwordx4 v[184:187], v16, s[12:15], s62 offen sc1
    buffer_load_dwordx4 v[188:191], v16, s[12:15], s62 offen offset:16 sc1
    s_mul_i32 s37, s42, 40960
    buffer_load_dwordx4 v[192:195], v14, s[4:7], s37 offen offset:0 sc1
    buffer_load_dwordx4 v[196:199], v14, s[4:7], s37 offen offset:1024 sc1
    s_add_u32 s37, s37, 2048
    buffer_load_dwordx4 v[200:203], v14, s[4:7], s37 offen offset:0 sc1
    buffer_load_dwordx4 v[204:207], v14, s[4:7], s37 offen offset:1024 sc1
    s_add_u32 s37, s37, 2048
    buffer_load_dwordx4 v[208:211], v14, s[4:7], s37 offen offset:0 sc1
    buffer_load_dwordx4 v[212:215], v14, s[4:7], s37 offen offset:1024 sc1
    s_add_u32 s37, s37, 2048
    buffer_load_dwordx4 v[216:219], v14, s[4:7], s37 offen offset:0 sc1
    s_waitcnt vmcnt(7)
    v_add_f32 v26, v184, v186
    v_add_f32 v28, v185, v187
    v_add_f32 v27, v188, v190
    v_add_f32 v29, v189, v191
    v_add_f32 v26, v26, v27
    v_add_f32 v28, v28, v29
    v_mov_b32 v3, v26
    v_mov_b32 v4, v28
    s_nop 1
    v_permlane32_swap_b32 v26, v3
    v_permlane32_swap_b32 v28, v4
    s_nop 1
    v_add_f32 v26, v26, v3
    v_add_f32 v28, v28, v4
    v_mul_f32 v26, 0x3acccccd, v26
    v_mul_f32 v28, 0x3acccccd, v28
    v_fma_f32 v28, -v26, v26, v28
    v_max_f32 v28, 0, v28
    v_add_f32 v28, 0x3727c5ac, v28
    v_rsq_f32 v30, v28
    s_nop 0
    v_sub_f32 v31, 0, v26
    v_pk_mul_f32 v[88:89], v[30:31], v[88:89] op_sel:[1,0] op_sel_hi:[1,1]
    v_pk_mul_f32 v[90:91], v[30:31], v[90:91] op_sel:[1,0] op_sel_hi:[1,1]
    v_pk_mul_f32 v[92:93], v[30:31], v[92:93] op_sel:[1,0] op_sel_hi:[1,1]
    v_pk_mul_f32 v[94:95], v[30:31], v[94:95] op_sel:[1,0] op_sel_hi:[1,1]
    v_pk_mul_f32 v[96:97], v[30:31], v[96:97] op_sel:[1,0] op_sel_hi:[1,1]
    v_pk_mul_f32 v[98:99], v[30:31], v[98:99] op_sel:[1,0] op_sel_hi:[1,1]
    v_pk_mul_f32 v[100:101], v[30:31], v[100:101] op_sel:[1,0] op_sel_hi:[1,1]
    v_pk_mul_f32 v[102:103], v[30:31], v[102:103] op_sel:[1,0] op_sel_hi:[1,1]
    v_pk_mul_f32 v[104:105], v[30:31], v[104:105] op_sel:[1,0] op_sel_hi:[1,1]
    v_pk_mul_f32 v[106:107], v[30:31], v[106:107] op_sel:[1,0] op_sel_hi:[1,1]
    v_pk_mul_f32 v[108:109], v[30:31], v[108:109] op_sel:[1,0] op_sel_hi:[1,1]
    v_pk_mul_f32 v[110:111], v[30:31], v[110:111] op_sel:[1,0] op_sel_hi:[1,1]
    v_pk_mul_f32 v[112:113], v[30:31], v[112:113] op_sel:[1,0] op_sel_hi:[1,1]
    v_pk_mul_f32 v[114:115], v[30:31], v[114:115] op_sel:[1,0] op_sel_hi:[1,1]
    v_pk_mul_f32 v[116:117], v[30:31], v[116:117] op_sel:[1,0] op_sel_hi:[1,1]
    v_pk_mul_f32 v[118:119], v[30:31], v[118:119] op_sel:[1,0] op_sel_hi:[1,1]
    v_pk_mul_f32 v[120:121], v[30:31], v[120:121] op_sel:[1,0] op_sel_hi:[1,1]
    v_pk_mul_f32 v[122:123], v[30:31], v[122:123] op_sel:[1,0] op_sel_hi:[1,1]
    v_pk_mul_f32 v[124:125], v[30:31], v[124:125] op_sel:[1,0] op_sel_hi:[1,1]
    v_pk_mul_f32 v[126:127], v[30:31], v[126:127] op_sel:[1,0] op_sel_hi:[1,1]
    v_pk_mul_f32 v[128:129], v[30:31], v[128:129] op_sel:[1,0] op_sel_hi:[1,1]
    v_pk_mul_f32 v[130:131], v[30:31], v[130:131] op_sel:[1,0] op_sel_hi:[1,1]
    v_pk_mul_f32 v[132:133], v[30:31], v[132:133] op_sel:[1,0] op_sel_hi:[1,1]
    v_pk_mul_f32 v[134:135], v[30:31], v[134:135] op_sel:[1,0] op_sel_hi:[1,1]
    v_pk_mul_f32 v[136:137], v[30:31], v[136:137] op_sel:[1,0] op_sel_hi:[1,1]
    v_pk_mul_f32 v[138:139], v[30:31], v[138:139] op_sel:[1,0] op_sel_hi:[1,1]
    v_pk_mul_f32 v[140:141], v[30:31], v[140:141] op_sel:[1,0] op_sel_hi:[1,1]
    v_pk_mul_f32 v[142:143], v[30:31], v[142:143] op_sel:[1,0] op_sel_hi:[1,1]
    v_pk_mul_f32 v[144:145], v[30:31], v[144:145] op_sel:[1,0] op_sel_hi:[1,1]
    v_pk_mul_f32 v[146:147], v[30:31], v[146:147] op_sel:[1,0] op_sel_hi:[1,1]
    v_pk_mul_f32 v[148:149], v[30:31], v[148:149] op_sel:[1,0] op_sel_hi:[1,1]
    v_pk_mul_f32 v[150:151], v[30:31], v[150:151] op_sel:[1,0] op_sel_hi:[1,1]
    v_pk_mul_f32 v[152:153], v[30:31], v[152:153] op_sel:[1,0] op_sel_hi:[1,1]
    v_pk_mul_f32 v[154:155], v[30:31], v[154:155] op_sel:[1,0] op_sel_hi:[1,1]
    v_pk_mul_f32 v[156:157], v[30:31], v[156:157] op_sel:[1,0] op_sel_hi:[1,1]
    v_pk_mul_f32 v[158:159], v[30:31], v[158:159] op_sel:[1,0] op_sel_hi:[1,1]
    v_pk_mul_f32 v[160:161], v[30:31], v[160:161] op_sel:[1,0] op_sel_hi:[1,1]
    v_pk_mul_f32 v[162:163], v[30:31], v[162:163] op_sel:[1,0] op_sel_hi:[1,1]
    v_pk_mul_f32 v[164:165], v[30:31], v[164:165] op_sel:[1,0] op_sel_hi:[1,1]
    v_pk_mul_f32 v[166:167], v[30:31], v[166:167] op_sel:[1,0] op_sel_hi:[1,1]
    v_pk_mul_f32 v[168:169], v[30:31], v[168:169] op_sel:[1,0] op_sel_hi:[1,1]
    v_pk_mul_f32 v[170:171], v[30:31], v[170:171] op_sel:[1,0] op_sel_hi:[1,1]
    v_pk_mul_f32 v[172:173], v[30:31], v[172:173] op_sel:[1,0] op_sel_hi:[1,1]
    v_pk_mul_f32 v[174:175], v[30:31], v[174:175] op_sel:[1,0] op_sel_hi:[1,1]
    v_pk_mul_f32 v[176:177], v[30:31], v[176:177] op_sel:[1,0] op_sel_hi:[1,1]
    v_pk_mul_f32 v[178:179], v[30:31], v[178:179] op_sel:[1,0] op_sel_hi:[1,1]
    v_pk_mul_f32 v[180:181], v[30:31], v[180:181] op_sel:[1,0] op_sel_hi:[1,1]
    v_pk_mul_f32 v[182:183], v[30:31], v[182:183] op_sel:[1,0] op_sel_hi:[1,1]
    s_mov_b32 s50, 5
    ds_read_b64_tr_b16 v[40:41], v18 offset:0
    ds_read_b64_tr_b16 v[42:43], v18 offset:768
    ds_read_b64_tr_b16 v[44:45], v18 offset:64
    ds_read_b64_tr_b16 v[46:47], v18 offset:832
    ds_read_b64_tr_b16 v[48:49], v18 offset:128
    ds_read_b64_tr_b16 v[50:51], v18 offset:896
    ds_read_b64_tr_b16 v[52:53], v18 offset:12288
    ds_read_b64_tr_b16 v[54:55], v18 offset:13056
    ds_read_b64_tr_b16 v[56:57], v18 offset:12352
    ds_read_b64_tr_b16 v[58:59], v18 offset:13120
    ds_read_b64_tr_b16 v[60:61], v18 offset:12416
    ds_read_b64_tr_b16 v[62:63], v18 offset:13184
L_ch0_kernel_loop_3:
    s_waitcnt vmcnt(6)
    s_waitcnt lgkmcnt(10)
    v_mfma_f32_32x32x16_bf16 v[88:103], v[40:43], v[192:195], v[88:103]
    buffer_load_dwordx4 v[220:223], v14, s[4:7], s37 offen offset:1024 sc1
    s_add_u32 s37, s37, 2048
    s_waitcnt lgkmcnt(8)
    v_mfma_f32_32x32x16_bf16 v[104:119], v[44:47], v[192:195], v[104:119]
    ds_read_b64_tr_b16 v[64:65], v18 offset:3072
    ds_read_b64_tr_b16 v[66:67], v18 offset:3840
    ds_read_b64_tr_b16 v[68:69], v18 offset:3136
    s_waitcnt lgkmcnt(9)
    v_mfma_f32_32x32x16_bf16 v[120:135], v[48:51], v[192:195], v[120:135]
    ds_read_b64_tr_b16 v[70:71], v18 offset:3904
    ds_read_b64_tr_b16 v[72:73], v18 offset:3200
    s_waitcnt lgkmcnt(9)
    v_mfma_f32_32x32x16_bf16 v[136:151], v[52:55], v[192:195], v[136:151]
    ds_read_b64_tr_b16 v[74:75], v18 offset:3968
    ds_read_b64_tr_b16 v[76:77], v18 offset:15360
    ds_read_b64_tr_b16 v[78:79], v18 offset:16128
    s_waitcnt lgkmcnt(10)
    v_mfma_f32_32x32x16_bf16 v[152:167], v[56:59], v[192:195], v[152:167]
    ds_read_b64_tr_b16 v[80:81], v18 offset:15424
    ds_read_b64_tr_b16 v[82:83], v18 offset:16192
    s_waitcnt lgkmcnt(10)
    v_mfma_f32_32x32x16_bf16 v[168:183], v[60:63], v[192:195], v[168:183]
    ds_read_b64_tr_b16 v[84:85], v18 offset:15488
    ds_read_b64_tr_b16 v[86:87], v18 offset:16256
    s_cmp_eq_u32 s50, 1
    s_cselect_b32 s37, 0x7f000000, s37
    s_waitcnt vmcnt(6)
    s_waitcnt lgkmcnt(10)
    v_mfma_f32_32x32x16_bf16 v[88:103], v[64:67], v[196:199], v[88:103]
    buffer_load_dwordx4 v[192:195], v14, s[4:7], s37 offen offset:0 sc1
    s_waitcnt lgkmcnt(8)
    v_mfma_f32_32x32x16_bf16 v[104:119], v[68:71], v[196:199], v[104:119]
    ds_read_b64_tr_b16 v[40:41], v18 offset:6144
    ds_read_b64_tr_b16 v[42:43], v18 offset:6912
    ds_read_b64_tr_b16 v[44:45], v18 offset:6208
    s_waitcnt lgkmcnt(9)
    v_mfma_f32_32x32x16_bf16 v[120:135], v[72:75], v[196:199], v[120:135]
    ds_read_b64_tr_b16 v[46:47], v18 offset:6976
    ds_read_b64_tr_b16 v[48:49], v18 offset:6272
    s_waitcnt lgkmcnt(9)
    v_mfma_f32_32x32x16_bf16 v[136:151], v[76:79], v[196:199], v[136:151]
    ds_read_b64_tr_b16 v[50:51], v18 offset:7040
    ds_read_b64_tr_b16 v[52:53], v18 offset:18432
    ds_read_b64_tr_b16 v[54:55], v18 offset:19200
    s_waitcnt lgkmcnt(10)
    v_mfma_f32_32x32x16_bf16 v[152:167], v[80:83], v[196:199], v[152:167]
    ds_read_b64_tr_b16 v[56:57], v18 offset:18496
    ds_read_b64_tr_b16 v[58:59], v18 offset:19264
    s_waitcnt lgkmcnt(10)
    v_mfma_f32_32x32x16_bf16 v[168:183], v[84:87], v[196:199], v[168:183]
    ds_read_b64_tr_b16 v[60:61], v18 offset:18560
    ds_read_b64_tr_b16 v[62:63], v18 offset:19328
    s_waitcnt vmcnt(6)
    s_waitcnt lgkmcnt(10)
    v_mfma_f32_32x32x16_bf16 v[88:103], v[40:43], v[200:203], v[88:103]
    buffer_load_dwordx4 v[196:199], v14, s[4:7], s37 offen offset:1024 sc1
    s_add_u32 s37, s37, 2048
    s_waitcnt lgkmcnt(8)
    v_mfma_f32_32x32x16_bf16 v[104:119], v[44:47], v[200:203], v[104:119]
    ds_read_b64_tr_b16 v[64:65], v18 offset:9216
    ds_read_b64_tr_b16 v[66:67], v18 offset:9984
    s_barrier
    s_add_u32 s60, s44, 24576
    s_cmp_gt_u32 s60, 122880
    s_cselect_b32 s60, 0, s60
    s_sub_u32 s45, s60, s44
    s_mov_b32 s44, s60
    s_waitcnt lgkmcnt(8)
    v_mfma_f32_32x32x16_bf16 v[120:135], v[48:51], v[200:203], v[120:135]
    ds_read_b64_tr_b16 v[68:69], v18 offset:9280
    ds_read_b64_tr_b16 v[70:71], v18 offset:10048
    ds_read_b64_tr_b16 v[72:73], v18 offset:9344
    s_waitcnt lgkmcnt(9)
    v_mfma_f32_32x32x16_bf16 v[136:151], v[52:55], v[200:203], v[136:151]
    ds_read_b64_tr_b16 v[74:75], v18 offset:10112
    ds_read_b64_tr_b16 v[76:77], v18 offset:21504
    ds_read_b64_tr_b16 v[78:79], v18 offset:22272
    s_waitcnt lgkmcnt(10)
    v_mfma_f32_32x32x16_bf16 v[152:167], v[56:59], v[200:203], v[152:167]
    ds_read_b64_tr_b16 v[80:81], v18 offset:21568
    ds_read_b64_tr_b16 v[82:83], v18 offset:22336
    ds_read_b64_tr_b16 v[84:85], v18 offset:21632
    s_waitcnt lgkmcnt(11)
    v_mfma_f32_32x32x16_bf16 v[168:183], v[60:63], v[200:203], v[168:183]
    ds_read_b64_tr_b16 v[86:87], v18 offset:22400
    v_add_u32 v18, s45, v18
    s_waitcnt vmcnt(6)
    s_waitcnt lgkmcnt(10)
    v_mfma_f32_32x32x16_bf16 v[88:103], v[64:67], v[204:207], v[88:103]
    buffer_load_dwordx4 v[200:203], v14, s[4:7], s37 offen offset:0 sc1
    s_waitcnt lgkmcnt(8)
    v_mfma_f32_32x32x16_bf16 v[104:119], v[68:71], v[204:207], v[104:119]
    ds_read_b64_tr_b16 v[40:41], v18 offset:0
    ds_read_b64_tr_b16 v[42:43], v18 offset:768
    ds_read_b64_tr_b16 v[44:45], v18 offset:64
    s_waitcnt lgkmcnt(9)
    v_mfma_f32_32x32x16_bf16 v[120:135], v[72:75], v[204:207], v[120:135]
    ds_read_b64_tr_b16 v[46:47], v18 offset:832
    ds_read_b64_tr_b16 v[48:49], v18 offset:128
    s_waitcnt lgkmcnt(9)
    v_mfma_f32_32x32x16_bf16 v[136:151], v[76:79], v[204:207], v[136:151]
    ds_read_b64_tr_b16 v[50:51], v18 offset:896
    ds_read_b64_tr_b16 v[52:53], v18 offset:12288
    ds_read_b64_tr_b16 v[54:55], v18 offset:13056
    s_waitcnt lgkmcnt(10)
    v_mfma_f32_32x32x16_bf16 v[152:167], v[80:83], v[204:207], v[152:167]
    ds_read_b64_tr_b16 v[56:57], v18 offset:12352
    ds_read_b64_tr_b16 v[58:59], v18 offset:13120
    s_waitcnt lgkmcnt(10)
    v_mfma_f32_32x32x16_bf16 v[168:183], v[84:87], v[204:207], v[168:183]
    ds_read_b64_tr_b16 v[60:61], v18 offset:12416
    ds_read_b64_tr_b16 v[62:63], v18 offset:13184
    s_waitcnt vmcnt(6)
    s_waitcnt lgkmcnt(10)
    v_mfma_f32_32x32x16_bf16 v[88:103], v[40:43], v[208:211], v[88:103]
    buffer_load_dwordx4 v[204:207], v14, s[4:7], s37 offen offset:1024 sc1
    s_add_u32 s37, s37, 2048
    s_waitcnt lgkmcnt(8)
    v_mfma_f32_32x32x16_bf16 v[104:119], v[44:47], v[208:211], v[104:119]
    ds_read_b64_tr_b16 v[64:65], v18 offset:3072
    ds_read_b64_tr_b16 v[66:67], v18 offset:3840
    ds_read_b64_tr_b16 v[68:69], v18 offset:3136
    s_waitcnt lgkmcnt(9)
    v_mfma_f32_32x32x16_bf16 v[120:135], v[48:51], v[208:211], v[120:135]
    ds_read_b64_tr_b16 v[70:71], v18 offset:3904
    ds_read_b64_tr_b16 v[72:73], v18 offset:3200
    s_waitcnt lgkmcnt(9)
    v_mfma_f32_32x32x16_bf16 v[136:151], v[52:55], v[208:211], v[136:151]
    ds_read_b64_tr_b16 v[74:75], v18 offset:3968
    ds_read_b64_tr_b16 v[76:77], v18 offset:15360
    ds_read_b64_tr_b16 v[78:79], v18 offset:16128
    s_waitcnt lgkmcnt(10)
    v_mfma_f32_32x32x16_bf16 v[152:167], v[56:59], v[208:211], v[152:167]
    ds_read_b64_tr_b16 v[80:81], v18 offset:15424
    ds_read_b64_tr_b16 v[82:83], v18 offset:16192
    s_waitcnt lgkmcnt(10)
    v_mfma_f32_32x32x16_bf16 v[168:183], v[60:63], v[208:211], v[168:183]
    ds_read_b64_tr_b16 v[84:85], v18 offset:15488
    ds_read_b64_tr_b16 v[86:87], v18 offset:16256
    s_waitcnt vmcnt(6)
    s_waitcnt lgkmcnt(10)
    v_mfma_f32_32x32x16_bf16 v[88:103], v[64:67], v[212:215], v[88:103]
    buffer_load_dwordx4 v[208:211], v14, s[4:7], s37 offen offset:0 sc1
    s_waitcnt lgkmcnt(8)
    v_mfma_f32_32x32x16_bf16 v[104:119], v[68:71], v[212:215], v[104:119]
    ds_read_b64_tr_b16 v[40:41], v18 offset:6144
    ds_read_b64_tr_b16 v[42:43], v18 offset:6912
    ds_read_b64_tr_b16 v[44:45], v18 offset:6208
    s_waitcnt lgkmcnt(9)
    v_mfma_f32_32x32x16_bf16 v[120:135], v[72:75], v[212:215], v[120:135]
    ds_read_b64_tr_b16 v[46:47], v18 offset:6976
    ds_read_b64_tr_b16 v[48:49], v18 offset:6272
    s_waitcnt lgkmcnt(9)
    v_mfma_f32_32x32x16_bf16 v[136:151], v[76:79], v[212:215], v[136:151]
    ds_read_b64_tr_b16 v[50:51], v18 offset:7040
    ds_read_b64_tr_b16 v[52:53], v18 offset:18432
    ds_read_b64_tr_b16 v[54:55], v18 offset:19200
    s_waitcnt lgkmcnt(10)
    v_mfma_f32_32x32x16_bf16 v[152:167], v[80:83], v[212:215], v[152:167]
    ds_read_b64_tr_b16 v[56:57], v18 offset:18496
    ds_read_b64_tr_b16 v[58:59], v18 offset:19264
    s_waitcnt lgkmcnt(10)
    v_mfma_f32_32x32x16_bf16 v[168:183], v[84:87], v[212:215], v[168:183]
    ds_read_b64_tr_b16 v[60:61], v18 offset:18560
    ds_read_b64_tr_b16 v[62:63], v18 offset:19328
    s_waitcnt vmcnt(6)
    s_waitcnt lgkmcnt(10)
    v_mfma_f32_32x32x16_bf16 v[88:103], v[40:43], v[216:219], v[88:103]
    buffer_load_dwordx4 v[212:215], v14, s[4:7], s37 offen offset:1024 sc1
    s_add_u32 s37, s37, 2048
    s_waitcnt lgkmcnt(8)
    v_mfma_f32_32x32x16_bf16 v[104:119], v[44:47], v[216:219], v[104:119]
    ds_read_b64_tr_b16 v[64:65], v18 offset:9216
    ds_read_b64_tr_b16 v[66:67], v18 offset:9984
    s_barrier
    s_add_u32 s60, s44, 24576
    s_cmp_gt_u32 s60, 122880
    s_cselect_b32 s60, 0, s60
    s_sub_u32 s45, s60, s44
    s_mov_b32 s44, s60
    s_waitcnt lgkmcnt(8)
    v_mfma_f32_32x32x16_bf16 v[120:135], v[48:51], v[216:219], v[120:135]
    ds_read_b64_tr_b16 v[68:69], v18 offset:9280
    ds_read_b64_tr_b16 v[70:71], v18 offset:10048
    ds_read_b64_tr_b16 v[72:73], v18 offset:9344
    s_waitcnt lgkmcnt(9)
    v_mfma_f32_32x32x16_bf16 v[136:151], v[52:55], v[216:219], v[136:151]
    ds_read_b64_tr_b16 v[74:75], v18 offset:10112
    ds_read_b64_tr_b16 v[76:77], v18 offset:21504
    ds_read_b64_tr_b16 v[78:79], v18 offset:22272
    s_waitcnt lgkmcnt(10)
    v_mfma_f32_32x32x16_bf16 v[152:167], v[56:59], v[216:219], v[152:167]
    ds_read_b64_tr_b16 v[80:81], v18 offset:21568
    ds_read_b64_tr_b16 v[82:83], v18 offset:22336
    ds_read_b64_tr_b16 v[84:85], v18 offset:21632
    s_waitcnt lgkmcnt(11)
    v_mfma_f32_32x32x16_bf16 v[168:183], v[60:63], v[216:219], v[168:183]
    ds_read_b64_tr_b16 v[86:87], v18 offset:22400
    v_add_u32 v18, s45, v18
    s_waitcnt vmcnt(6)
    s_waitcnt lgkmcnt(10)
    v_mfma_f32_32x32x16_bf16 v[88:103], v[64:67], v[220:223], v[88:103]
    buffer_load_dwordx4 v[216:219], v14, s[4:7], s37 offen offset:0 sc1
    s_waitcnt lgkmcnt(8)
    v_mfma_f32_32x32x16_bf16 v[104:119], v[68:71], v[220:223], v[104:119]
    ds_read_b64_tr_b16 v[40:41], v18 offset:0
    ds_read_b64_tr_b16 v[42:43], v18 offset:768
    ds_read_b64_tr_b16 v[44:45], v18 offset:64
    s_waitcnt lgkmcnt(9)
    v_mfma_f32_32x32x16_bf16 v[120:135], v[72:75], v[220:223], v[120:135]
    ds_read_b64_tr_b16 v[46:47], v18 offset:832
    ds_read_b64_tr_b16 v[48:49], v18 offset:128
    s_waitcnt lgkmcnt(9)
    v_mfma_f32_32x32x16_bf16 v[136:151], v[76:79], v[220:223], v[136:151]
    ds_read_b64_tr_b16 v[50:51], v18 offset:896
    ds_read_b64_tr_b16 v[52:53], v18 offset:12288
    ds_read_b64_tr_b16 v[54:55], v18 offset:13056
    s_waitcnt lgkmcnt(10)
    v_mfma_f32_32x32x16_bf16 v[152:167], v[80:83], v[220:223], v[152:167]
    ds_read_b64_tr_b16 v[56:57], v18 offset:12352
    ds_read_b64_tr_b16 v[58:59], v18 offset:13120
    s_waitcnt lgkmcnt(10)
    v_mfma_f32_32x32x16_bf16 v[168:183], v[84:87], v[220:223], v[168:183]
    ds_read_b64_tr_b16 v[60:61], v18 offset:12416
    ds_read_b64_tr_b16 v[62:63], v18 offset:13184
    s_sub_u32 s50, s50, 1
    s_cmp_lg_u32 s50, 0
    s_cbranch_scc1 L_ch0_kernel_loop_3
    s_waitcnt  lgkmcnt(0)
    s_nop 7
    v_mul_f32 v30, v30, v30
    v_pk_mul_f32 v[136:137], v[30:31], v[136:137] op_sel_hi:[0,1]
    v_max_f32 v88, 0, v88
    v_max_f32 v89, 0, v89
    v_pk_mul_f32 v[88:89], v[88:89], v[136:137]
    v_pk_mul_f32 v[138:139], v[30:31], v[138:139] op_sel_hi:[0,1]
    v_max_f32 v90, 0, v90
    v_max_f32 v91, 0, v91
    v_pk_mul_f32 v[90:91], v[90:91], v[138:139]
    v_pk_mul_f32 v[140:141], v[30:31], v[140:141] op_sel_hi:[0,1]
    v_max_f32 v92, 0, v92
    v_max_f32 v93, 0, v93
    v_pk_mul_f32 v[92:93], v[92:93], v[140:141]
    v_pk_mul_f32 v[142:143], v[30:31], v[142:143] op_sel_hi:[0,1]
    v_max_f32 v94, 0, v94
    v_max_f32 v95, 0, v95
    v_pk_mul_f32 v[94:95], v[94:95], v[142:143]
    v_pk_mul_f32 v[144:145], v[30:31], v[144:145] op_sel_hi:[0,1]
    v_max_f32 v96, 0, v96
    v_max_f32 v97, 0, v97
    v_pk_mul_f32 v[96:97], v[96:97], v[144:145]
    v_pk_mul_f32 v[146:147], v[30:31], v[146:147] op_sel_hi:[0,1]
    v_max_f32 v98, 0, v98
    v_max_f32 v99, 0, v99
    v_pk_mul_f32 v[98:99], v[98:99], v[146:147]
    v_pk_mul_f32 v[148:149], v[30:31], v[148:149] op_sel_hi:[0,1]
    v_max_f32 v100, 0, v100
    v_max_f32 v101, 0, v101
    v_pk_mul_f32 v[100:101], v[100:101], v[148:149]
    v_pk_mul_f32 v[150:151], v[30:31], v[150:151] op_sel_hi:[0,1]
    v_max_f32 v102, 0, v102
    v_max_f32 v103, 0, v103
    v_pk_mul_f32 v[102:103], v[102:103], v[150:151]
    v_cvt_pk_bf16_f32 v136, v88, v89
    v_cvt_pk_bf16_f32 v137, v90, v91
    v_cvt_pk_bf16_f32 v138, v96, v97
    v_cvt_pk_bf16_f32 v139, v98, v99
    buffer_store_dwordx4 v[136:139], v14, s[16:19], s48 offen offset:0 sc1
    v_cvt_pk_bf16_f32 v140, v92, v93
    v_cvt_pk_bf16_f32 v141, v94, v95
    v_cvt_pk_bf16_f32 v142, v100, v101
    v_cvt_pk_bf16_f32 v143, v102, v103
    buffer_store_dwordx4 v[140:143], v14, s[16:19], s48 offen offset:1024 sc1
    v_pk_mul_f32 v[152:153], v[30:31], v[152:153] op_sel_hi:[0,1]
    v_max_f32 v104, 0, v104
    v_max_f32 v105, 0, v105
    v_pk_mul_f32 v[104:105], v[104:105], v[152:153]
    v_pk_mul_f32 v[154:155], v[30:31], v[154:155] op_sel_hi:[0,1]
    v_max_f32 v106, 0, v106
    v_max_f32 v107, 0, v107
    v_pk_mul_f32 v[106:107], v[106:107], v[154:155]
    v_pk_mul_f32 v[156:157], v[30:31], v[156:157] op_sel_hi:[0,1]
    v_max_f32 v108, 0, v108
    v_max_f32 v109, 0, v109
    v_pk_mul_f32 v[108:109], v[108:109], v[156:157]
    v_pk_mul_f32 v[158:159], v[30:31], v[158:159] op_sel_hi:[0,1]
    v_max_f32 v110, 0, v110
    v_max_f32 v111, 0, v111
    v_pk_mul_f32 v[110:111], v[110:111], v[158:159]
    v_pk_mul_f32 v[160:161], v[30:31], v[160:161] op_sel_hi:[0,1]
    v_max_f32 v112, 0, v112
    v_max_f32 v113, 0, v113
    v_pk_mul_f32 v[112:113], v[112:113], v[160:161]
    v_pk_mul_f32 v[162:163], v[30:31], v[162:163] op_sel_hi:[0,1]
    v_max_f32 v114, 0, v114
    v_max_f32 v115, 0, v115
    v_pk_mul_f32 v[114:115], v[114:115], v[162:163]
    v_pk_mul_f32 v[164:165], v[30:31], v[164:165] op_sel_hi:[0,1]
    v_max_f32 v116, 0, v116
    v_max_f32 v117, 0, v117
    v_pk_mul_f32 v[116:117], v[116:117], v[164:165]
    v_pk_mul_f32 v[166:167], v[30:31], v[166:167] op_sel_hi:[0,1]
    v_max_f32 v118, 0, v118
    v_max_f32 v119, 0, v119
    v_pk_mul_f32 v[118:119], v[118:119], v[166:167]
    v_cvt_pk_bf16_f32 v152, v104, v105
    v_cvt_pk_bf16_f32 v153, v106, v107
    v_cvt_pk_bf16_f32 v154, v112, v113
    v_cvt_pk_bf16_f32 v155, v114, v115
    buffer_store_dwordx4 v[152:155], v14, s[16:19], s48 offen offset:2048 sc1
    v_cvt_pk_bf16_f32 v156, v108, v109
    v_cvt_pk_bf16_f32 v157, v110, v111
    v_cvt_pk_bf16_f32 v158, v116, v117
    v_cvt_pk_bf16_f32 v159, v118, v119
    buffer_store_dwordx4 v[156:159], v14, s[16:19], s48 offen offset:3072 sc1
    v_pk_mul_f32 v[168:169], v[30:31], v[168:169] op_sel_hi:[0,1]
    v_max_f32 v120, 0, v120
    v_max_f32 v121, 0, v121
    v_pk_mul_f32 v[120:121], v[120:121], v[168:169]
    v_pk_mul_f32 v[170:171], v[30:31], v[170:171] op_sel_hi:[0,1]
    v_max_f32 v122, 0, v122
    v_max_f32 v123, 0, v123
    v_pk_mul_f32 v[122:123], v[122:123], v[170:171]
    v_pk_mul_f32 v[172:173], v[30:31], v[172:173] op_sel_hi:[0,1]
    v_max_f32 v124, 0, v124
    v_max_f32 v125, 0, v125
    v_pk_mul_f32 v[124:125], v[124:125], v[172:173]
    v_pk_mul_f32 v[174:175], v[30:31], v[174:175] op_sel_hi:[0,1]
    v_max_f32 v126, 0, v126
    v_max_f32 v127, 0, v127
    v_pk_mul_f32 v[126:127], v[126:127], v[174:175]
    v_pk_mul_f32 v[176:177], v[30:31], v[176:177] op_sel_hi:[0,1]
    v_max_f32 v128, 0, v128
    v_max_f32 v129, 0, v129
    v_pk_mul_f32 v[128:129], v[128:129], v[176:177]
    v_pk_mul_f32 v[178:179], v[30:31], v[178:179] op_sel_hi:[0,1]
    v_max_f32 v130, 0, v130
    v_max_f32 v131, 0, v131
    v_pk_mul_f32 v[130:131], v[130:131], v[178:179]
    v_pk_mul_f32 v[180:181], v[30:31], v[180:181] op_sel_hi:[0,1]
    v_max_f32 v132, 0, v132
    v_max_f32 v133, 0, v133
    v_pk_mul_f32 v[132:133], v[132:133], v[180:181]
    v_pk_mul_f32 v[182:183], v[30:31], v[182:183] op_sel_hi:[0,1]
    v_max_f32 v134, 0, v134
    v_max_f32 v135, 0, v135
    v_pk_mul_f32 v[134:135], v[134:135], v[182:183]
    v_cvt_pk_bf16_f32 v168, v120, v121
    v_cvt_pk_bf16_f32 v169, v122, v123
    v_cvt_pk_bf16_f32 v170, v128, v129
    v_cvt_pk_bf16_f32 v171, v130, v131
    buffer_store_dwordx4 v[168:171], v14, s[16:19], s47 offen offset:0 sc1
    v_cvt_pk_bf16_f32 v172, v124, v125
    v_cvt_pk_bf16_f32 v173, v126, v127
    v_cvt_pk_bf16_f32 v174, v132, v133
    v_cvt_pk_bf16_f32 v175, v134, v135
    buffer_store_dwordx4 v[172:175], v14, s[16:19], s47 offen offset:1024 sc1
    s_lshl_b32 s62, s42, 7
    s_add_u32 s62, s62, 8192
    s_waitcnt vmcnt(0)
    s_mov_b64 exec, 1
    buffer_atomic_add v15, v13, s[52:55], s62 offen sc1
    s_mov_b64 exec, -1
    s_mov_b32 s44, 73728
    s_lshr_b32 s42, s35, 1
    s_and_b32 s43, s35, 1
    s_lshl_b32 s46, s66, 1
    s_add_u32 s46, s46, s42
    v_and_b32 v3, 15, v1
    s_lshl_b32 s45, s43, 4
    v_add_u32 v3, s45, v3
    v_lshrrev_b32 v4, 4, v1
    v_lshrrev_b32 v5, 1, v4
    v_lshlrev_b32 v29, 9, v5
    v_and_b32 v5, 1, v4
    v_lshl_add_u32 v29, v5, 3, v29
    v_lshl_add_u32 v29, v3, 4, v29
    v_lshrrev_b32 v5, 1, v4
    v_lshlrev_b32 v28, 9, v5
    v_and_b32 v5, 1, v4
    v_lshl_add_u32 v28, v5, 3, v28
    v_lshl_add_u32 v28, v3, 4, v28
    s_mul_i32 s47, s46, 40960
    s_mul_i32 s48, s67, 5120
    s_add_u32 s47, s47, s48
    s_mul_i32 s48, s46, 40960
    s_mul_i32 s49, s67, 160
    s_add_u32 s48, s48, s49
    s_add_u32 s49, s47, 4096
    v_lshlrev_b32 v7, 6, v3
    v_lshrrev_b32 v5, 2, v1
    v_mul_u32_u24 v5, 160, v5
    v_and_b32 v6, 3, v1
    v_lshl_add_u32 v16, v6, 3, v5
    v_add_u32 v16, s44, v16
    v_lshlrev_b32 v5, 4, v3
    v_lshl_add_u32 v17, v4, 9, v5
    s_mul_i32 s37, s46, 98304
    s_lshl_b32 s50, s46, 11
    s_lshl_b32 s43, s67, 3
    s_add_u32 s50, s50, s43
    s_add_u32 s4, s28, 0x1600000
    s_addc_u32 s5, s29, 0
    s_mov_b32 s6, 0x600000
    s_mov_b32 s7, 0x00020000
    s_add_u32 s12, s28, 0xe00000
    s_addc_u32 s13, s29, 0
    s_mov_b32 s14, 0x280000
    s_mov_b32 s15, 0x00020000
    s_add_u32 s16, s28, 0x1200000
    s_addc_u32 s17, s29, 0
    s_mov_b32 s18, 0x280000
    s_mov_b32 s19, 0x00020000
    s_add_u32 s56, s28, 0x2040000
    s_addc_u32 s57, s29, 0
    s_mov_b32 s58, 0x20000
    s_mov_b32 s59, 0x00020000
    buffer_load_dwordx2 v[18:19], v29, s[12:15], s47 offen offset:0 sc1
    buffer_load_dwordx2 v[20:21], v29, s[12:15], s47 offen offset:1024 sc1
    buffer_load_dwordx2 v[22:23], v29, s[12:15], s47 offen offset:2048 sc1
    buffer_load_dwordx2 v[24:25], v29, s[12:15], s47 offen offset:3072 sc1
    buffer_load_dwordx2 v[26:27], v29, s[12:15], s49 offen sc1
    s_waitcnt vmcnt(0)
    v_lshlrev_b32 v72, 16, v18
    v_and_b32 v73, 0xffff0000, v18
    v_lshlrev_b32 v74, 16, v19
    v_and_b32 v75, 0xffff0000, v19
    v_lshlrev_b32 v76, 16, v20
    v_and_b32 v77, 0xffff0000, v20
    v_lshlrev_b32 v78, 16, v21
    v_and_b32 v79, 0xffff0000, v21
    v_lshlrev_b32 v80, 16, v22
    v_and_b32 v81, 0xffff0000, v22
    v_lshlrev_b32 v82, 16, v23
    v_and_b32 v83, 0xffff0000, v23
    v_lshlrev_b32 v84, 16, v24
    v_and_b32 v85, 0xffff0000, v24
    v_lshlrev_b32 v86, 16, v25
    v_and_b32 v87, 0xffff0000, v25
    v_lshlrev_b32 v88, 16, v26
    v_and_b32 v89, 0xffff0000, v26
    v_lshlrev_b32 v90, 16, v27
    v_and_b32 v91, 0xffff0000, v27
    s_lshl_b32 s62, s46, 7
    s_add_u32 s62, s62, 8192
    s_mov_b32 s63, 0
L_ch0_kernel_poll_4:
    buffer_load_dword v12, v13, s[52:55], s62 offen sc1
    s_waitcnt vmcnt(0)
    v_readfirstlane_b32 s61, v12
    s_add_u32 s63, s63, 1
    s_cmp_ge_u32 s61, 16
    s_cbranch_scc1 L_ch0_kernel_go_5
    s_cmp_ge_u32 s63, 0x400000
    s_cbranch_scc1 L_ch0_kernel_go_5
    s_sleep 1
    s_branch L_ch0_kernel_poll_4
L_ch0_kernel_go_5:
    buffer_load_dwordx4 v[112:115], v17, s[4:7], s37 offen offset:0 sc1
    buffer_load_dwordx4 v[116:119], v17, s[4:7], s37 offen offset:2048 sc1
    s_add_u32 s37, s37, 4096
    buffer_load_dwordx4 v[120:123], v17, s[4:7], s37 offen offset:0 sc1
    buffer_load_dwordx4 v[124:127], v17, s[4:7], s37 offen offset:2048 sc1
    s_add_u32 s37, s37, 4096
    buffer_load_dwordx4 v[128:131], v17, s[4:7], s37 offen offset:0 sc1
    buffer_load_dwordx4 v[132:135], v17, s[4:7], s37 offen offset:2048 sc1
    s_add_u32 s37, s37, 4096
    buffer_load_dwordx4 v[136:139], v17, s[4:7], s37 offen offset:0 sc1
    buffer_load_dwordx4 v[140:143], v17, s[4:7], s37 offen offset:2048 sc1
    s_add_u32 s37, s37, 4096
    ds_read_b64_tr_b16 v[32:33], v16 offset:0
    ds_read_b64_tr_b16 v[34:35], v16 offset:2560
    ds_read_b64_tr_b16 v[36:37], v16 offset:32
    ds_read_b64_tr_b16 v[38:39], v16 offset:2592
    ds_read_b64_tr_b16 v[40:41], v16 offset:64
    ds_read_b64_tr_b16 v[42:43], v16 offset:2624
    ds_read_b64_tr_b16 v[44:45], v16 offset:96
    ds_read_b64_tr_b16 v[46:47], v16 offset:2656
    ds_read_b64_tr_b16 v[48:49], v16 offset:128
    ds_read_b64_tr_b16 v[50:51], v16 offset:2688
    s_mov_b32 s51, 6
L_ch0_kernel_loop_6:
    s_cmp_eq_u32 s51, 1
    s_cselect_b32 s37, 0x7f000000, s37
    s_waitcnt vmcnt(7)
    s_waitcnt lgkmcnt(8)
    v_mfma_f32_16x16x32_bf16 v[72:75], v[32:35], v[112:115], v[72:75]
    ds_read_b64_tr_b16 v[52:53], v16 offset:5120
    ds_read_b64_tr_b16 v[54:55], v16 offset:7680
    s_waitcnt lgkmcnt(8)
    v_mfma_f32_16x16x32_bf16 v[76:79], v[36:39], v[112:115], v[76:79]
    ds_read_b64_tr_b16 v[56:57], v16 offset:5152
    ds_read_b64_tr_b16 v[58:59], v16 offset:7712
    s_waitcnt lgkmcnt(8)
    v_mfma_f32_16x16x32_bf16 v[80:83], v[40:43], v[112:115], v[80:83]
    ds_read_b64_tr_b16 v[60:61], v16 offset:5184
    ds_read_b64_tr_b16 v[62:63], v16 offset:7744
    s_waitcnt lgkmcnt(8)
    v_mfma_f32_16x16x32_bf16 v[84:87], v[44:47], v[112:115], v[84:87]
    ds_read_b64_tr_b16 v[64:65], v16 offset:5216
    ds_read_b64_tr_b16 v[66:67], v16 offset:7776
    s_waitcnt lgkmcnt(8)
    v_mfma_f32_16x16x32_bf16 v[88:91], v[48:51], v[112:115], v[88:91]
    ds_read_b64_tr_b16 v[68:69], v16 offset:5248
    ds_read_b64_tr_b16 v[70:71], v16 offset:7808
    buffer_load_dwordx4 v[112:115], v17, s[4:7], s37 offen offset:0 sc1
    s_waitcnt vmcnt(7)
    s_waitcnt lgkmcnt(8)
    v_mfma_f32_16x16x32_bf16 v[72:75], v[52:55], v[116:119], v[72:75]
    ds_read_b64_tr_b16 v[32:33], v16 offset:10240
    ds_read_b64_tr_b16 v[34:35], v16 offset:12800
    s_waitcnt lgkmcnt(8)
    v_mfma_f32_16x16x32_bf16 v[76:79], v[56:59], v[116:119], v[76:79]
    ds_read_b64_tr_b16 v[36:37], v16 offset:10272
    ds_read_b64_tr_b16 v[38:39], v16 offset:12832
    s_waitcnt lgkmcnt(8)
    v_mfma_f32_16x16x32_bf16 v[80:83], v[60:63], v[116:119], v[80:83]
    ds_read_b64_tr_b16 v[40:41], v16 offset:10304
    ds_read_b64_tr_b16 v[42:43], v16 offset:12864
    s_waitcnt lgkmcnt(8)
    v_mfma_f32_16x16x32_bf16 v[84:87], v[64:67], v[116:119], v[84:87]
    ds_read_b64_tr_b16 v[44:45], v16 offset:10336
    ds_read_b64_tr_b16 v[46:47], v16 offset:12896
    s_waitcnt lgkmcnt(8)
    v_mfma_f32_16x16x32_bf16 v[88:91], v[68:71], v[116:119], v[88:91]
    ds_read_b64_tr_b16 v[48:49], v16 offset:10368
    ds_read_b64_tr_b16 v[50:51], v16 offset:12928
    buffer_load_dwordx4 v[116:119], v17, s[4:7], s37 offen offset:2048 sc1
    s_add_u32 s37, s37, 4096
    s_waitcnt vmcnt(7)
    s_waitcnt lgkmcnt(8)
    v_mfma_f32_16x16x32_bf16 v[72:75], v[32:35], v[120:123], v[72:75]
    ds_read_b64_tr_b16 v[52:53], v16 offset:15360
    ds_read_b64_tr_b16 v[54:55], v16 offset:17920
    s_waitcnt lgkmcnt(8)
    v_mfma_f32_16x16x32_bf16 v[76:79], v[36:39], v[120:123], v[76:79]
    ds_read_b64_tr_b16 v[56:57], v16 offset:15392
    ds_read_b64_tr_b16 v[58:59], v16 offset:17952
    s_waitcnt lgkmcnt(8)
    v_mfma_f32_16x16x32_bf16 v[80:83], v[40:43], v[120:123], v[80:83]
    ds_read_b64_tr_b16 v[60:61], v16 offset:15424
    ds_read_b64_tr_b16 v[62:63], v16 offset:17984
    s_waitcnt lgkmcnt(8)
    v_mfma_f32_16x16x32_bf16 v[84:87], v[44:47], v[120:123], v[84:87]
    ds_read_b64_tr_b16 v[64:65], v16 offset:15456
    ds_read_b64_tr_b16 v[66:67], v16 offset:18016
    s_waitcnt lgkmcnt(8)
    v_mfma_f32_16x16x32_bf16 v[88:91], v[48:51], v[120:123], v[88:91]
    ds_read_b64_tr_b16 v[68:69], v16 offset:15488
    ds_read_b64_tr_b16 v[70:71], v16 offset:18048
    buffer_load_dwordx4 v[120:123], v17, s[4:7], s37 offen offset:0 sc1
    s_barrier
    s_add_u32 s60, s44, 24576
    s_cmp_gt_u32 s60, 122880
    s_cselect_b32 s60, 0, s60
    s_sub_u32 s45, s60, s44
    s_mov_b32 s44, s60
    v_add_u32 v16, s45, v16
    s_waitcnt vmcnt(7)
    s_waitcnt lgkmcnt(8)
    v_mfma_f32_16x16x32_bf16 v[72:75], v[52:55], v[124:127], v[72:75]
    ds_read_b64_tr_b16 v[32:33], v16 offset:0
    ds_read_b64_tr_b16 v[34:35], v16 offset:2560
    s_waitcnt lgkmcnt(8)
    v_mfma_f32_16x16x32_bf16 v[76:79], v[56:59], v[124:127], v[76:79]
    ds_read_b64_tr_b16 v[36:37], v16 offset:32
    ds_read_b64_tr_b16 v[38:39], v16 offset:2592
    s_waitcnt lgkmcnt(8)
    v_mfma_f32_16x16x32_bf16 v[80:83], v[60:63], v[124:127], v[80:83]
    ds_read_b64_tr_b16 v[40:41], v16 offset:64
    ds_read_b64_tr_b16 v[42:43], v16 offset:2624
    s_waitcnt lgkmcnt(8)
    v_mfma_f32_16x16x32_bf16 v[84:87], v[64:67], v[124:127], v[84:87]
    ds_read_b64_tr_b16 v[44:45], v16 offset:96
    ds_read_b64_tr_b16 v[46:47], v16 offset:2656
    s_waitcnt lgkmcnt(8)
    v_mfma_f32_16x16x32_bf16 v[88:91], v[68:71], v[124:127], v[88:91]
    ds_read_b64_tr_b16 v[48:49], v16 offset:128
    ds_read_b64_tr_b16 v[50:51], v16 offset:2688
    buffer_load_dwordx4 v[124:127], v17, s[4:7], s37 offen offset:2048 sc1
    s_add_u32 s37, s37, 4096
    s_waitcnt vmcnt(7)
    s_waitcnt lgkmcnt(8)
    v_mfma_f32_16x16x32_bf16 v[72:75], v[32:35], v[128:131], v[72:75]
    ds_read_b64_tr_b16 v[52:53], v16 offset:5120
    ds_read_b64_tr_b16 v[54:55], v16 offset:7680
    s_waitcnt lgkmcnt(8)
    v_mfma_f32_16x16x32_bf16 v[76:79], v[36:39], v[128:131], v[76:79]
    ds_read_b64_tr_b16 v[56:57], v16 offset:5152
    ds_read_b64_tr_b16 v[58:59], v16 offset:7712
    s_waitcnt lgkmcnt(8)
    v_mfma_f32_16x16x32_bf16 v[80:83], v[40:43], v[128:131], v[80:83]
    ds_read_b64_tr_b16 v[60:61], v16 offset:5184
    ds_read_b64_tr_b16 v[62:63], v16 offset:7744
    s_waitcnt lgkmcnt(8)
    v_mfma_f32_16x16x32_bf16 v[84:87], v[44:47], v[128:131], v[84:87]
    ds_read_b64_tr_b16 v[64:65], v16 offset:5216
    ds_read_b64_tr_b16 v[66:67], v16 offset:7776
    s_waitcnt lgkmcnt(8)
    v_mfma_f32_16x16x32_bf16 v[88:91], v[48:51], v[128:131], v[88:91]
    ds_read_b64_tr_b16 v[68:69], v16 offset:5248
    ds_read_b64_tr_b16 v[70:71], v16 offset:7808
    buffer_load_dwordx4 v[128:131], v17, s[4:7], s37 offen offset:0 sc1
    s_waitcnt vmcnt(7)
    s_waitcnt lgkmcnt(8)
    v_mfma_f32_16x16x32_bf16 v[72:75], v[52:55], v[132:135], v[72:75]
    ds_read_b64_tr_b16 v[32:33], v16 offset:10240
    ds_read_b64_tr_b16 v[34:35], v16 offset:12800
    s_waitcnt lgkmcnt(8)
    v_mfma_f32_16x16x32_bf16 v[76:79], v[56:59], v[132:135], v[76:79]
    ds_read_b64_tr_b16 v[36:37], v16 offset:10272
    ds_read_b64_tr_b16 v[38:39], v16 offset:12832
    s_waitcnt lgkmcnt(8)
    v_mfma_f32_16x16x32_bf16 v[80:83], v[60:63], v[132:135], v[80:83]
    ds_read_b64_tr_b16 v[40:41], v16 offset:10304
    ds_read_b64_tr_b16 v[42:43], v16 offset:12864
    s_waitcnt lgkmcnt(8)
    v_mfma_f32_16x16x32_bf16 v[84:87], v[64:67], v[132:135], v[84:87]
    ds_read_b64_tr_b16 v[44:45], v16 offset:10336
    ds_read_b64_tr_b16 v[46:47], v16 offset:12896
    s_waitcnt lgkmcnt(8)
    v_mfma_f32_16x16x32_bf16 v[88:91], v[68:71], v[132:135], v[88:91]
    ds_read_b64_tr_b16 v[48:49], v16 offset:10368
    ds_read_b64_tr_b16 v[50:51], v16 offset:12928
    buffer_load_dwordx4 v[132:135], v17, s[4:7], s37 offen offset:2048 sc1
    s_add_u32 s37, s37, 4096
    s_waitcnt vmcnt(7)
    s_waitcnt lgkmcnt(8)
    v_mfma_f32_16x16x32_bf16 v[72:75], v[32:35], v[136:139], v[72:75]
    ds_read_b64_tr_b16 v[52:53], v16 offset:15360
    ds_read_b64_tr_b16 v[54:55], v16 offset:17920
    s_waitcnt lgkmcnt(8)
    v_mfma_f32_16x16x32_bf16 v[76:79], v[36:39], v[136:139], v[76:79]
    ds_read_b64_tr_b16 v[56:57], v16 offset:15392
    ds_read_b64_tr_b16 v[58:59], v16 offset:17952
    s_waitcnt lgkmcnt(8)
    v_mfma_f32_16x16x32_bf16 v[80:83], v[40:43], v[136:139], v[80:83]
    ds_read_b64_tr_b16 v[60:61], v16 offset:15424
    ds_read_b64_tr_b16 v[62:63], v16 offset:17984
    s_waitcnt lgkmcnt(8)
    v_mfma_f32_16x16x32_bf16 v[84:87], v[44:47], v[136:139], v[84:87]
    ds_read_b64_tr_b16 v[64:65], v16 offset:15456
    ds_read_b64_tr_b16 v[66:67], v16 offset:18016
    s_waitcnt lgkmcnt(8)
    v_mfma_f32_16x16x32_bf16 v[88:91], v[48:51], v[136:139], v[88:91]
    ds_read_b64_tr_b16 v[68:69], v16 offset:15488
    ds_read_b64_tr_b16 v[70:71], v16 offset:18048
    buffer_load_dwordx4 v[136:139], v17, s[4:7], s37 offen offset:0 sc1
    s_barrier
    s_add_u32 s60, s44, 24576
    s_cmp_gt_u32 s60, 122880
    s_cselect_b32 s60, 0, s60
    s_sub_u32 s45, s60, s44
    s_mov_b32 s44, s60
    v_add_u32 v16, s45, v16
    s_waitcnt vmcnt(7)
    s_waitcnt lgkmcnt(8)
    v_mfma_f32_16x16x32_bf16 v[72:75], v[52:55], v[140:143], v[72:75]
    ds_read_b64_tr_b16 v[32:33], v16 offset:0
    ds_read_b64_tr_b16 v[34:35], v16 offset:2560
    s_waitcnt lgkmcnt(8)
    v_mfma_f32_16x16x32_bf16 v[76:79], v[56:59], v[140:143], v[76:79]
    ds_read_b64_tr_b16 v[36:37], v16 offset:32
    ds_read_b64_tr_b16 v[38:39], v16 offset:2592
    s_waitcnt lgkmcnt(8)
    v_mfma_f32_16x16x32_bf16 v[80:83], v[60:63], v[140:143], v[80:83]
    ds_read_b64_tr_b16 v[40:41], v16 offset:64
    ds_read_b64_tr_b16 v[42:43], v16 offset:2624
    s_waitcnt lgkmcnt(8)
    v_mfma_f32_16x16x32_bf16 v[84:87], v[64:67], v[140:143], v[84:87]
    ds_read_b64_tr_b16 v[44:45], v16 offset:96
    ds_read_b64_tr_b16 v[46:47], v16 offset:2656
    s_waitcnt lgkmcnt(8)
    v_mfma_f32_16x16x32_bf16 v[88:91], v[68:71], v[140:143], v[88:91]
    ds_read_b64_tr_b16 v[48:49], v16 offset:128
    ds_read_b64_tr_b16 v[50:51], v16 offset:2688
    buffer_load_dwordx4 v[140:143], v17, s[4:7], s37 offen offset:2048 sc1
    s_add_u32 s37, s37, 4096
    s_sub_u32 s51, s51, 1
    s_cmp_lg_u32 s51, 0
    s_cbranch_scc1 L_ch0_kernel_loop_6
    s_waitcnt  lgkmcnt(0)
    s_nop 7
    v_cvt_pk_bf16_f32 v92, v72, v73
    v_cvt_pk_bf16_f32 v93, v74, v75
    buffer_store_dwordx2 v[92:93], v28, s[16:19], s47 offen offset:0 sc1
    v_cvt_pk_bf16_f32 v94, v76, v77
    v_cvt_pk_bf16_f32 v95, v78, v79
    buffer_store_dwordx2 v[94:95], v28, s[16:19], s47 offen offset:1024 sc1
    v_cvt_pk_bf16_f32 v96, v80, v81
    v_cvt_pk_bf16_f32 v97, v82, v83
    buffer_store_dwordx2 v[96:97], v28, s[16:19], s47 offen offset:2048 sc1
    v_cvt_pk_bf16_f32 v98, v84, v85
    v_cvt_pk_bf16_f32 v99, v86, v87
    buffer_store_dwordx2 v[98:99], v28, s[16:19], s47 offen offset:3072 sc1
    v_cvt_pk_bf16_f32 v100, v88, v89
    v_cvt_pk_bf16_f32 v101, v90, v91
    buffer_store_dwordx2 v[100:101], v28, s[16:19], s49 offen sc1
    v_lshlrev_b32 v72, 16, v92
    v_and_b32 v73, 0xffff0000, v92
    v_lshlrev_b32 v74, 16, v93
    v_and_b32 v75, 0xffff0000, v93
    v_pk_add_f32 v[32:33], v[72:73], v[74:75]
    v_pk_mul_f32 v[34:35], v[72:73], v[72:73]
    v_pk_fma_f32 v[34:35], v[74:75], v[74:75], v[34:35]
    v_lshlrev_b32 v76, 16, v94
    v_and_b32 v77, 0xffff0000, v94
    v_lshlrev_b32 v78, 16, v95
    v_and_b32 v79, 0xffff0000, v95
    v_pk_add_f32 v[32:33], v[32:33], v[76:77]
    v_pk_fma_f32 v[34:35], v[76:77], v[76:77], v[34:35]
    v_pk_add_f32 v[32:33], v[32:33], v[78:79]
    v_pk_fma_f32 v[34:35], v[78:79], v[78:79], v[34:35]
    v_lshlrev_b32 v80, 16, v96
    v_and_b32 v81, 0xffff0000, v96
    v_lshlrev_b32 v82, 16, v97
    v_and_b32 v83, 0xffff0000, v97
    v_pk_add_f32 v[32:33], v[32:33], v[80:81]
    v_pk_fma_f32 v[34:35], v[80:81], v[80:81], v[34:35]
    v_pk_add_f32 v[32:33], v[32:33], v[82:83]
    v_pk_fma_f32 v[34:35], v[82:83], v[82:83], v[34:35]
    v_lshlrev_b32 v84, 16, v98
    v_and_b32 v85, 0xffff0000, v98
    v_lshlrev_b32 v86, 16, v99
    v_and_b32 v87, 0xffff0000, v99
    v_pk_add_f32 v[32:33], v[32:33], v[84:85]
    v_pk_fma_f32 v[34:35], v[84:85], v[84:85], v[34:35]
    v_pk_add_f32 v[32:33], v[32:33], v[86:87]
    v_pk_fma_f32 v[34:35], v[86:87], v[86:87], v[34:35]
    v_lshlrev_b32 v88, 16, v100
    v_and_b32 v89, 0xffff0000, v100
    v_lshlrev_b32 v90, 16, v101
    v_and_b32 v91, 0xffff0000, v101
    v_pk_add_f32 v[32:33], v[32:33], v[88:89]
    v_pk_fma_f32 v[34:35], v[88:89], v[88:89], v[34:35]
    v_pk_add_f32 v[32:33], v[32:33], v[90:91]
    v_pk_fma_f32 v[34:35], v[90:91], v[90:91], v[34:35]
    v_add_f32 v32, v32, v33
    v_add_f32 v33, v34, v35
    v_mov_b32 v34, v32
    v_mov_b32 v35, v33
    s_nop 1
    v_permlane16_swap_b32 v32, v34
    v_permlane16_swap_b32 v33, v35
    s_nop 1
    v_add_f32 v32, v32, v34
    v_add_f32 v33, v33, v35
    v_mov_b32 v34, v32
    v_mov_b32 v35, v33
    s_nop 1
    v_permlane32_swap_b32 v32, v34
    v_permlane32_swap_b32 v33, v35
    s_nop 1
    v_add_f32 v32, v32, v34
    v_add_f32 v33, v33, v35
    s_mov_b64 exec, 0xffff
    buffer_store_dwordx2 v[32:33], v7, s[56:59], s50 offen sc1
    s_mov_b64 exec, -1
    s_and_b32 s61, s35, 1
    s_lshl_b32 s43, s67, 1
    s_add_u32 s61, s61, s43
    s_lshl_b32 s62, s46, 7
    s_add_u32 s62, s62, 16384
    s_waitcnt vmcnt(0)
    s_mov_b64 exec, 1
    buffer_atomic_add v15, v13, s[52:55], s62 offen sc1
    s_mov_b64 exec, -1
    s_cmp_ge_u32 s71, 15
    s_cbranch_scc1 L_ch0_kernel_end
    s_mov_b32 s44, 73728
    s_lshl_b32 s42, s70, 2
    s_add_u32 s42, s42, s35
    v_and_b32 v3, 31, v1
    v_lshlrev_b32 v3, 6, v3
    v_and_b32 v4, 32, v1
    v_add_u32 v16, v3, v4
    s_add_u32 s56, s28, 0x2080000
    s_addc_u32 s57, s29, 0
    s_mov_b32 s58, 0x5000
    s_mov_b32 s59, 0x00020000
    s_lshl_b32 s63, s35, 10
    s_add_u32 m0, s63, 147456
    s_mul_i32 s62, s71, 512
    buffer_load_dwordx4 v14, s[56:59], s62 offen lds
    v_lshrrev_b32 v3, 2, v1
    v_and_b32 v3, 3, v3
    v_and_b32 v4, 3, v1
    v_lshlrev_b32 v4, 3, v4
    v_lshl_add_u32 v4, v3, 6, v4
    v_and_b32 v5, 16, v1
    v_lshl_add_u32 v4, v5, 1, v4
    v_lshl_add_u32 v4, v2, 6, v4
    v_lshlrev_b32 v3, 8, v3
    v_lshrrev_b32 v5, 5, v1
    v_lshl_add_u32 v3, v5, 11, v3
    v_add_u32 v3, s44, v3
    v_add_u32 v5, 0, v4
    v_and_b32 v5, 255, v5
    v_add_u32 v18, v5, v3
    v_add_u32 v5, 64, v4
    v_and_b32 v5, 255, v5
    v_add_u32 v19, v5, v3
    v_add_u32 v5, 128, v4
    v_and_b32 v5, 255, v5
    v_add_u32 v20, v5, v3
    v_add_u32 v5, 192, v4
    v_and_b32 v5, 255, v5
    v_add_u32 v21, v5, v3
    s_add_u32 s4, s28, 0x1200000
    s_addc_u32 s5, s29, 0
    s_mov_b32 s6, 0x280000
    s_mov_b32 s7, 0x00020000
    s_add_u32 s12, s28, 0x2040000
    s_addc_u32 s13, s29, 0
    s_mov_b32 s14, 0x20000
    s_mov_b32 s15, 0x00020000
    s_cmp_ge_u32 s71, 10
    s_cbranch_scc1 L_ch0_kernel_v
    s_cmp_ge_u32 s71, 5
    s_cselect_b32 s47, 5, 0
    s_sub_u32 s47, s71, s47
    s_cmp_ge_u32 s71, 5
    s_cbranch_scc1 L_ch0_kernel_isk_7
    s_mov_b32 s16, s28
    s_mov_b32 s17, s29
    s_mov_b32 s18, 0x280000
    s_mov_b32 s19, 0x00020000
    v_lshrrev_b32 v5, 5, v1
    v_and_b32 v6, 31, v1
    s_lshl_b32 s46, s47, 5
    s_mul_i32 s48, s42, 1280
    v_lshlrev_b32 v190, 4, v6
    v_lshlrev_b32 v191, 3, v6
    v_sub_u32 v191, 0x800000, v191
    s_add_u32 s49, s35, 0
    s_and_b32 s49, s49, 3
    s_lshl_b32 s49, s49, 3
    s_add_u32 s49, s49, s46
    v_add3_u32 v3, s49, v5, 0
    v_mul_u32_u24 v4, 205, v3
    v_lshrrev_b32 v4, 10, v4
    v_mul_u32_u24 v7, 5, v4
    v_sub_u32 v3, v3, v7
    v_mul_u32_u24 v136, 81920, v4
    v_lshrrev_b32 v7, 1, v3
    v_lshl_add_u32 v136, v7, 9, v136
    v_and_b32 v7, 1, v3
    v_lshl_add_u32 v136, v7, 3, v136
    v_lshrrev_b32 v7, 2, v3
    v_mad_u32_u24 v7, v7, v191, v190
    v_add3_u32 v136, v136, v7, s48
    v_and_b32 v136, 0x7fffff, v136
    v_add3_u32 v3, s49, v5, 2
    v_mul_u32_u24 v4, 205, v3
    v_lshrrev_b32 v4, 10, v4
    v_mul_u32_u24 v7, 5, v4
    v_sub_u32 v3, v3, v7
    v_mul_u32_u24 v137, 81920, v4
    v_lshrrev_b32 v7, 1, v3
    v_lshl_add_u32 v137, v7, 9, v137
    v_and_b32 v7, 1, v3
    v_lshl_add_u32 v137, v7, 3, v137
    v_lshrrev_b32 v7, 2, v3
    v_mad_u32_u24 v7, v7, v191, v190
    v_add3_u32 v137, v137, v7, s48
    v_and_b32 v137, 0x7fffff, v137
    v_add3_u32 v3, s49, v5, 4
    v_mul_u32_u24 v4, 205, v3
    v_lshrrev_b32 v4, 10, v4
    v_mul_u32_u24 v7, 5, v4
    v_sub_u32 v3, v3, v7
    v_mul_u32_u24 v138, 81920, v4
    v_lshrrev_b32 v7, 1, v3
    v_lshl_add_u32 v138, v7, 9, v138
    v_and_b32 v7, 1, v3
    v_lshl_add_u32 v138, v7, 3, v138
    v_lshrrev_b32 v7, 2, v3
    v_mad_u32_u24 v7, v7, v191, v190
    v_add3_u32 v138, v138, v7, s48
    v_and_b32 v138, 0x7fffff, v138
    v_add3_u32 v3, s49, v5, 6
    v_mul_u32_u24 v4, 205, v3
    v_lshrrev_b32 v4, 10, v4
    v_mul_u32_u24 v7, 5, v4
    v_sub_u32 v3, v3, v7
    v_mul_u32_u24 v139, 81920, v4
    v_lshrrev_b32 v7, 1, v3
    v_lshl_add_u32 v139, v7, 9, v139
    v_and_b32 v7, 1, v3
    v_lshl_add_u32 v139, v7, 3, v139
    v_lshrrev_b32 v7, 2, v3
    v_mad_u32_u24 v7, v7, v191, v190
    v_add3_u32 v139, v139, v7, s48
    v_and_b32 v139, 0x7fffff, v139
    s_add_u32 s49, s35, 1
    s_and_b32 s49, s49, 3
    s_lshl_b32 s49, s49, 3
    s_add_u32 s49, s49, s46
    v_add3_u32 v3, s49, v5, 0
    v_mul_u32_u24 v4, 205, v3
    v_lshrrev_b32 v4, 10, v4
    v_mul_u32_u24 v7, 5, v4
    v_sub_u32 v3, v3, v7
    v_mul_u32_u24 v140, 81920, v4
    v_lshrrev_b32 v7, 1, v3
    v_lshl_add_u32 v140, v7, 9, v140
    v_and_b32 v7, 1, v3
    v_lshl_add_u32 v140, v7, 3, v140
    v_lshrrev_b32 v7, 2, v3
    v_mad_u32_u24 v7, v7, v191, v190
    v_add3_u32 v140, v140, v7, s48
    v_and_b32 v140, 0x7fffff, v140
    v_add3_u32 v3, s49, v5, 2
    v_mul_u32_u24 v4, 205, v3
    v_lshrrev_b32 v4, 10, v4
    v_mul_u32_u24 v7, 5, v4
    v_sub_u32 v3, v3, v7
    v_mul_u32_u24 v141, 81920, v4
    v_lshrrev_b32 v7, 1, v3
    v_lshl_add_u32 v141, v7, 9, v141
    v_and_b32 v7, 1, v3
    v_lshl_add_u32 v141, v7, 3, v141
    v_lshrrev_b32 v7, 2, v3
    v_mad_u32_u24 v7, v7, v191, v190
    v_add3_u32 v141, v141, v7, s48
    v_and_b32 v141, 0x7fffff, v141
    v_add3_u32 v3, s49, v5, 4
    v_mul_u32_u24 v4, 205, v3
    v_lshrrev_b32 v4, 10, v4
    v_mul_u32_u24 v7, 5, v4
    v_sub_u32 v3, v3, v7
    v_mul_u32_u24 v142, 81920, v4
    v_lshrrev_b32 v7, 1, v3
    v_lshl_add_u32 v142, v7, 9, v142
    v_and_b32 v7, 1, v3
    v_lshl_add_u32 v142, v7, 3, v142
    v_lshrrev_b32 v7, 2, v3
    v_mad_u32_u24 v7, v7, v191, v190
    v_add3_u32 v142, v142, v7, s48
    v_and_b32 v142, 0x7fffff, v142
    v_add3_u32 v3, s49, v5, 6
    v_mul_u32_u24 v4, 205, v3
    v_lshrrev_b32 v4, 10, v4
    v_mul_u32_u24 v7, 5, v4
    v_sub_u32 v3, v3, v7
    v_mul_u32_u24 v143, 81920, v4
    v_lshrrev_b32 v7, 1, v3
    v_lshl_add_u32 v143, v7, 9, v143
    v_and_b32 v7, 1, v3
    v_lshl_add_u32 v143, v7, 3, v143
    v_lshrrev_b32 v7, 2, v3
    v_mad_u32_u24 v7, v7, v191, v190
    v_add3_u32 v143, v143, v7, s48
    v_and_b32 v143, 0x7fffff, v143
    s_add_u32 s49, s35, 2
    s_and_b32 s49, s49, 3
    s_lshl_b32 s49, s49, 3
    s_add_u32 s49, s49, s46
    v_add3_u32 v3, s49, v5, 0
    v_mul_u32_u24 v4, 205, v3
    v_lshrrev_b32 v4, 10, v4
    v_mul_u32_u24 v7, 5, v4
    v_sub_u32 v3, v3, v7
    v_mul_u32_u24 v144, 81920, v4
    v_lshrrev_b32 v7, 1, v3
    v_lshl_add_u32 v144, v7, 9, v144
    v_and_b32 v7, 1, v3
    v_lshl_add_u32 v144, v7, 3, v144
    v_lshrrev_b32 v7, 2, v3
    v_mad_u32_u24 v7, v7, v191, v190
    v_add3_u32 v144, v144, v7, s48
    v_and_b32 v144, 0x7fffff, v144
    v_add3_u32 v3, s49, v5, 2
    v_mul_u32_u24 v4, 205, v3
    v_lshrrev_b32 v4, 10, v4
    v_mul_u32_u24 v7, 5, v4
    v_sub_u32 v3, v3, v7
    v_mul_u32_u24 v145, 81920, v4
    v_lshrrev_b32 v7, 1, v3
    v_lshl_add_u32 v145, v7, 9, v145
    v_and_b32 v7, 1, v3
    v_lshl_add_u32 v145, v7, 3, v145
    v_lshrrev_b32 v7, 2, v3
    v_mad_u32_u24 v7, v7, v191, v190
    v_add3_u32 v145, v145, v7, s48
    v_and_b32 v145, 0x7fffff, v145
    v_add3_u32 v3, s49, v5, 4
    v_mul_u32_u24 v4, 205, v3
    v_lshrrev_b32 v4, 10, v4
    v_mul_u32_u24 v7, 5, v4
    v_sub_u32 v3, v3, v7
    v_mul_u32_u24 v146, 81920, v4
    v_lshrrev_b32 v7, 1, v3
    v_lshl_add_u32 v146, v7, 9, v146
    v_and_b32 v7, 1, v3
    v_lshl_add_u32 v146, v7, 3, v146
    v_lshrrev_b32 v7, 2, v3
    v_mad_u32_u24 v7, v7, v191, v190
    v_add3_u32 v146, v146, v7, s48
    v_and_b32 v146, 0x7fffff, v146
    v_add3_u32 v3, s49, v5, 6
    v_mul_u32_u24 v4, 205, v3
    v_lshrrev_b32 v4, 10, v4
    v_mul_u32_u24 v7, 5, v4
    v_sub_u32 v3, v3, v7
    v_mul_u32_u24 v147, 81920, v4
    v_lshrrev_b32 v7, 1, v3
    v_lshl_add_u32 v147, v7, 9, v147
    v_and_b32 v7, 1, v3
    v_lshl_add_u32 v147, v7, 3, v147
    v_lshrrev_b32 v7, 2, v3
    v_mad_u32_u24 v7, v7, v191, v190
    v_add3_u32 v147, v147, v7, s48
    v_and_b32 v147, 0x7fffff, v147
    s_add_u32 s49, s35, 3
    s_and_b32 s49, s49, 3
    s_lshl_b32 s49, s49, 3
    s_add_u32 s49, s49, s46
    v_add3_u32 v3, s49, v5, 0
    v_mul_u32_u24 v4, 205, v3
    v_lshrrev_b32 v4, 10, v4
    v_mul_u32_u24 v7, 5, v4
    v_sub_u32 v3, v3, v7
    v_mul_u32_u24 v148, 81920, v4
    v_lshrrev_b32 v7, 1, v3
    v_lshl_add_u32 v148, v7, 9, v148
    v_and_b32 v7, 1, v3
    v_lshl_add_u32 v148, v7, 3, v148
    v_lshrrev_b32 v7, 2, v3
    v_mad_u32_u24 v7, v7, v191, v190
    v_add3_u32 v148, v148, v7, s48
    v_and_b32 v148, 0x7fffff, v148
    v_add3_u32 v3, s49, v5, 2
    v_mul_u32_u24 v4, 205, v3
    v_lshrrev_b32 v4, 10, v4
    v_mul_u32_u24 v7, 5, v4
    v_sub_u32 v3, v3, v7
    v_mul_u32_u24 v149, 81920, v4
    v_lshrrev_b32 v7, 1, v3
    v_lshl_add_u32 v149, v7, 9, v149
    v_and_b32 v7, 1, v3
    v_lshl_add_u32 v149, v7, 3, v149
    v_lshrrev_b32 v7, 2, v3
    v_mad_u32_u24 v7, v7, v191, v190
    v_add3_u32 v149, v149, v7, s48
    v_and_b32 v149, 0x7fffff, v149
    v_add3_u32 v3, s49, v5, 4
    v_mul_u32_u24 v4, 205, v3
    v_lshrrev_b32 v4, 10, v4
    v_mul_u32_u24 v7, 5, v4
    v_sub_u32 v3, v3, v7
    v_mul_u32_u24 v150, 81920, v4
    v_lshrrev_b32 v7, 1, v3
    v_lshl_add_u32 v150, v7, 9, v150
    v_and_b32 v7, 1, v3
    v_lshl_add_u32 v150, v7, 3, v150
    v_lshrrev_b32 v7, 2, v3
    v_mad_u32_u24 v7, v7, v191, v190
    v_add3_u32 v150, v150, v7, s48
    v_and_b32 v150, 0x7fffff, v150
    v_add3_u32 v3, s49, v5, 6
    v_mul_u32_u24 v4, 205, v3
    v_lshrrev_b32 v4, 10, v4
    v_mul_u32_u24 v7, 5, v4
    v_sub_u32 v3, v3, v7
    v_mul_u32_u24 v151, 81920, v4
    v_lshrrev_b32 v7, 1, v3
    v_lshl_add_u32 v151, v7, 9, v151
    v_and_b32 v7, 1, v3
    v_lshl_add_u32 v151, v7, 3, v151
    v_lshrrev_b32 v7, 2, v3
    v_mad_u32_u24 v7, v7, v191, v190
    v_add3_u32 v151, v151, v7, s48
    v_and_b32 v151, 0x7fffff, v151
    s_mov_b32 s51, 0x3ea52b5c
    s_branch L_ch0_kernel_join_8
L_ch0_kernel_isk_7:
    s_add_u32 s16, s28, 0x400000
    s_addc_u32 s17, s29, 0
    s_mov_b32 s18, 0x500000
    s_mov_b32 s19, 0x00020000
    v_lshrrev_b32 v5, 5, v1
    v_and_b32 v6, 31, v1
    s_lshl_b32 s46, s47, 5
    s_mul_i32 s48, s42, 2560
    v_lshlrev_b32 v190, 4, v6
    v_lshrrev_b32 v191, 4, v6
    v_mul_u32_u24 v191, 2304, v191
    s_and_b32 s49, s42, 1
    s_mul_i32 s49, s49, 2552
    s_sub_u32 s49, 0x800000, s49
    v_add_u32 v191, s49, v191
    s_add_u32 s49, s35, 0
    s_and_b32 s49, s49, 3
    s_lshl_b32 s49, s49, 3
    s_add_u32 s49, s49, s46
    v_add3_u32 v3, s49, v5, 0
    v_mul_u32_u24 v4, 205, v3
    v_lshrrev_b32 v4, 10, v4
    v_mul_u32_u24 v7, 5, v4
    v_sub_u32 v3, v3, v7
    v_mul_u32_u24 v136, 163840, v4
    v_lshrrev_b32 v7, 1, v3
    v_lshl_add_u32 v136, v7, 9, v136
    v_and_b32 v7, 1, v3
    v_lshl_add_u32 v136, v7, 3, v136
    v_lshrrev_b32 v7, 2, v3
    v_mad_u32_u24 v7, v7, v191, v190
    v_add3_u32 v136, v136, v7, s48
    v_and_b32 v136, 0x7fffff, v136
    v_add3_u32 v3, s49, v5, 2
    v_mul_u32_u24 v4, 205, v3
    v_lshrrev_b32 v4, 10, v4
    v_mul_u32_u24 v7, 5, v4
    v_sub_u32 v3, v3, v7
    v_mul_u32_u24 v137, 163840, v4
    v_lshrrev_b32 v7, 1, v3
    v_lshl_add_u32 v137, v7, 9, v137
    v_and_b32 v7, 1, v3
    v_lshl_add_u32 v137, v7, 3, v137
    v_lshrrev_b32 v7, 2, v3
    v_mad_u32_u24 v7, v7, v191, v190
    v_add3_u32 v137, v137, v7, s48
    v_and_b32 v137, 0x7fffff, v137
    v_add3_u32 v3, s49, v5, 4
    v_mul_u32_u24 v4, 205, v3
    v_lshrrev_b32 v4, 10, v4
    v_mul_u32_u24 v7, 5, v4
    v_sub_u32 v3, v3, v7
    v_mul_u32_u24 v138, 163840, v4
    v_lshrrev_b32 v7, 1, v3
    v_lshl_add_u32 v138, v7, 9, v138
    v_and_b32 v7, 1, v3
    v_lshl_add_u32 v138, v7, 3, v138
    v_lshrrev_b32 v7, 2, v3
    v_mad_u32_u24 v7, v7, v191, v190
    v_add3_u32 v138, v138, v7, s48
    v_and_b32 v138, 0x7fffff, v138
    v_add3_u32 v3, s49, v5, 6
    v_mul_u32_u24 v4, 205, v3
    v_lshrrev_b32 v4, 10, v4
    v_mul_u32_u24 v7, 5, v4
    v_sub_u32 v3, v3, v7
    v_mul_u32_u24 v139, 163840, v4
    v_lshrrev_b32 v7, 1, v3
    v_lshl_add_u32 v139, v7, 9, v139
    v_and_b32 v7, 1, v3
    v_lshl_add_u32 v139, v7, 3, v139
    v_lshrrev_b32 v7, 2, v3
    v_mad_u32_u24 v7, v7, v191, v190
    v_add3_u32 v139, v139, v7, s48
    v_and_b32 v139, 0x7fffff, v139
    s_add_u32 s49, s35, 1
    s_and_b32 s49, s49, 3
    s_lshl_b32 s49, s49, 3
    s_add_u32 s49, s49, s46
    v_add3_u32 v3, s49, v5, 0
    v_mul_u32_u24 v4, 205, v3
    v_lshrrev_b32 v4, 10, v4
    v_mul_u32_u24 v7, 5, v4
    v_sub_u32 v3, v3, v7
    v_mul_u32_u24 v140, 163840, v4
    v_lshrrev_b32 v7, 1, v3
    v_lshl_add_u32 v140, v7, 9, v140
    v_and_b32 v7, 1, v3
    v_lshl_add_u32 v140, v7, 3, v140
    v_lshrrev_b32 v7, 2, v3
    v_mad_u32_u24 v7, v7, v191, v190
    v_add3_u32 v140, v140, v7, s48
    v_and_b32 v140, 0x7fffff, v140
    v_add3_u32 v3, s49, v5, 2
    v_mul_u32_u24 v4, 205, v3
    v_lshrrev_b32 v4, 10, v4
    v_mul_u32_u24 v7, 5, v4
    v_sub_u32 v3, v3, v7
    v_mul_u32_u24 v141, 163840, v4
    v_lshrrev_b32 v7, 1, v3
    v_lshl_add_u32 v141, v7, 9, v141
    v_and_b32 v7, 1, v3
    v_lshl_add_u32 v141, v7, 3, v141
    v_lshrrev_b32 v7, 2, v3
    v_mad_u32_u24 v7, v7, v191, v190
    v_add3_u32 v141, v141, v7, s48
    v_and_b32 v141, 0x7fffff, v141
    v_add3_u32 v3, s49, v5, 4
    v_mul_u32_u24 v4, 205, v3
    v_lshrrev_b32 v4, 10, v4
    v_mul_u32_u24 v7, 5, v4
    v_sub_u32 v3, v3, v7
    v_mul_u32_u24 v142, 163840, v4
    v_lshrrev_b32 v7, 1, v3
    v_lshl_add_u32 v142, v7, 9, v142
    v_and_b32 v7, 1, v3
    v_lshl_add_u32 v142, v7, 3, v142
    v_lshrrev_b32 v7, 2, v3
    v_mad_u32_u24 v7, v7, v191, v190
    v_add3_u32 v142, v142, v7, s48
    v_and_b32 v142, 0x7fffff, v142
    v_add3_u32 v3, s49, v5, 6
    v_mul_u32_u24 v4, 205, v3
    v_lshrrev_b32 v4, 10, v4
    v_mul_u32_u24 v7, 5, v4
    v_sub_u32 v3, v3, v7
    v_mul_u32_u24 v143, 163840, v4
    v_lshrrev_b32 v7, 1, v3
    v_lshl_add_u32 v143, v7, 9, v143
    v_and_b32 v7, 1, v3
    v_lshl_add_u32 v143, v7, 3, v143
    v_lshrrev_b32 v7, 2, v3
    v_mad_u32_u24 v7, v7, v191, v190
    v_add3_u32 v143, v143, v7, s48
    v_and_b32 v143, 0x7fffff, v143
    s_add_u32 s49, s35, 2
    s_and_b32 s49, s49, 3
    s_lshl_b32 s49, s49, 3
    s_add_u32 s49, s49, s46
    v_add3_u32 v3, s49, v5, 0
    v_mul_u32_u24 v4, 205, v3
    v_lshrrev_b32 v4, 10, v4
    v_mul_u32_u24 v7, 5, v4
    v_sub_u32 v3, v3, v7
    v_mul_u32_u24 v144, 163840, v4
    v_lshrrev_b32 v7, 1, v3
    v_lshl_add_u32 v144, v7, 9, v144
    v_and_b32 v7, 1, v3
    v_lshl_add_u32 v144, v7, 3, v144
    v_lshrrev_b32 v7, 2, v3
    v_mad_u32_u24 v7, v7, v191, v190
    v_add3_u32 v144, v144, v7, s48
    v_and_b32 v144, 0x7fffff, v144
    v_add3_u32 v3, s49, v5, 2
    v_mul_u32_u24 v4, 205, v3
    v_lshrrev_b32 v4, 10, v4
    v_mul_u32_u24 v7, 5, v4
    v_sub_u32 v3, v3, v7
    v_mul_u32_u24 v145, 163840, v4
    v_lshrrev_b32 v7, 1, v3
    v_lshl_add_u32 v145, v7, 9, v145
    v_and_b32 v7, 1, v3
    v_lshl_add_u32 v145, v7, 3, v145
    v_lshrrev_b32 v7, 2, v3
    v_mad_u32_u24 v7, v7, v191, v190
    v_add3_u32 v145, v145, v7, s48
    v_and_b32 v145, 0x7fffff, v145
    v_add3_u32 v3, s49, v5, 4
    v_mul_u32_u24 v4, 205, v3
    v_lshrrev_b32 v4, 10, v4
    v_mul_u32_u24 v7, 5, v4
    v_sub_u32 v3, v3, v7
    v_mul_u32_u24 v146, 163840, v4
    v_lshrrev_b32 v7, 1, v3
    v_lshl_add_u32 v146, v7, 9, v146
    v_and_b32 v7, 1, v3
    v_lshl_add_u32 v146, v7, 3, v146
    v_lshrrev_b32 v7, 2, v3
    v_mad_u32_u24 v7, v7, v191, v190
    v_add3_u32 v146, v146, v7, s48
    v_and_b32 v146, 0x7fffff, v146
    v_add3_u32 v3, s49, v5, 6
    v_mul_u32_u24 v4, 205, v3
    v_lshrrev_b32 v4, 10, v4
    v_mul_u32_u24 v7, 5, v4
    v_sub_u32 v3, v3, v7
    v_mul_u32_u24 v147, 163840, v4
    v_lshrrev_b32 v7, 1, v3
    v_lshl_add_u32 v147, v7, 9, v147
    v_and_b32 v7, 1, v3
    v_lshl_add_u32 v147, v7, 3, v147
    v_lshrrev_b32 v7, 2, v3
    v_mad_u32_u24 v7, v7, v191, v190
    v_add3_u32 v147, v147, v7, s48
    v_and_b32 v147, 0x7fffff, v147
    s_add_u32 s49, s35, 3
    s_and_b32 s49, s49, 3
    s_lshl_b32 s49, s49, 3
    s_add_u32 s49, s49, s46
    v_add3_u32 v3, s49, v5, 0
    v_mul_u32_u24 v4, 205, v3
    v_lshrrev_b32 v4, 10, v4
    v_mul_u32_u24 v7, 5, v4
    v_sub_u32 v3, v3, v7
    v_mul_u32_u24 v148, 163840, v4
    v_lshrrev_b32 v7, 1, v3
    v_lshl_add_u32 v148, v7, 9, v148
    v_and_b32 v7, 1, v3
    v_lshl_add_u32 v148, v7, 3, v148
    v_lshrrev_b32 v7, 2, v3
    v_mad_u32_u24 v7, v7, v191, v190
    v_add3_u32 v148, v148, v7, s48
    v_and_b32 v148, 0x7fffff, v148
    v_add3_u32 v3, s49, v5, 2
    v_mul_u32_u24 v4, 205, v3
    v_lshrrev_b32 v4, 10, v4
    v_mul_u32_u24 v7, 5, v4
    v_sub_u32 v3, v3, v7
    v_mul_u32_u24 v149, 163840, v4
    v_lshrrev_b32 v7, 1, v3
    v_lshl_add_u32 v149, v7, 9, v149
    v_and_b32 v7, 1, v3
    v_lshl_add_u32 v149, v7, 3, v149
    v_lshrrev_b32 v7, 2, v3
    v_mad_u32_u24 v7, v7, v191, v190
    v_add3_u32 v149, v149, v7, s48
    v_and_b32 v149, 0x7fffff, v149
    v_add3_u32 v3, s49, v5, 4
    v_mul_u32_u24 v4, 205, v3
    v_lshrrev_b32 v4, 10, v4
    v_mul_u32_u24 v7, 5, v4
    v_sub_u32 v3, v3, v7
    v_mul_u32_u24 v150, 163840, v4
    v_lshrrev_b32 v7, 1, v3
    v_lshl_add_u32 v150, v7, 9, v150
    v_and_b32 v7, 1, v3
    v_lshl_add_u32 v150, v7, 3, v150
    v_lshrrev_b32 v7, 2, v3
    v_mad_u32_u24 v7, v7, v191, v190
    v_add3_u32 v150, v150, v7, s48
    v_and_b32 v150, 0x7fffff, v150
    v_add3_u32 v3, s49, v5, 6
    v_mul_u32_u24 v4, 205, v3
    v_lshrrev_b32 v4, 10, v4
    v_mul_u32_u24 v7, 5, v4
    v_sub_u32 v3, v3, v7
    v_mul_u32_u24 v151, 163840, v4
    v_lshrrev_b32 v7, 1, v3
    v_lshl_add_u32 v151, v7, 9, v151
    v_and_b32 v7, 1, v3
    v_lshl_add_u32 v151, v7, 3, v151
    v_lshrrev_b32 v7, 2, v3
    v_mad_u32_u24 v7, v7, v191, v190
    v_add3_u32 v151, v151, v7, s48
    v_and_b32 v151, 0x7fffff, v151
    s_mov_b32 s51, 1.0
L_ch0_kernel_join_8:
    s_waitcnt vmcnt(0)
    s_lshl_b32 s63, s35, 10
    s_add_u32 s63, s63, 147456
    v_lshrrev_b32 v6, 5, v1
    v_lshlrev_b32 v6, 4, v6
    v_add_u32 v6, s63, v6
    s_add_u32 s49, s35, 0
    s_and_b32 s49, s49, 3
    s_lshl_b32 s49, s49, 7
    v_add_u32 v7, s49, v6
    ds_read_b128 v[72:75], v7 offset:0
    ds_read_b128 v[76:79], v7 offset:32
    ds_read_b128 v[80:83], v7 offset:64
    ds_read_b128 v[84:87], v7 offset:96
    s_add_u32 s49, s35, 1
    s_and_b32 s49, s49, 3
    s_lshl_b32 s49, s49, 7
    v_add_u32 v7, s49, v6
    ds_read_b128 v[88:91], v7 offset:0
    ds_read_b128 v[92:95], v7 offset:32
    ds_read_b128 v[96:99], v7 offset:64
    ds_read_b128 v[100:103], v7 offset:96
    s_add_u32 s49, s35, 2
    s_and_b32 s49, s49, 3
    s_lshl_b32 s49, s49, 7
    v_add_u32 v7, s49, v6
    ds_read_b128 v[104:107], v7 offset:0
    ds_read_b128 v[108:111], v7 offset:32
    ds_read_b128 v[112:115], v7 offset:64
    ds_read_b128 v[116:119], v7 offset:96
    s_waitcnt lgkmcnt(0)
    s_add_u32 s49, s35, 3
    s_and_b32 s49, s49, 3
    s_lshl_b32 s49, s49, 7
    v_add_u32 v7, s49, v6
    ds_read_b128 v[120:123], v7 offset:0
    ds_read_b128 v[124:127], v7 offset:32
    ds_read_b128 v[128:131], v7 offset:64
    ds_read_b128 v[132:135], v7 offset:96
    s_waitcnt lgkmcnt(0)
    s_lshl_b32 s62, s42, 7
    s_add_u32 s62, s62, 16384
    s_mov_b32 s63, 0
L_ch0_kernel_poll_9:
    buffer_load_dword v12, v13, s[52:55], s62 offen sc1
    s_waitcnt vmcnt(0)
    v_readfirstlane_b32 s61, v12
    s_add_u32 s63, s63, 1
    s_cmp_ge_u32 s61, 16
    s_cbranch_scc1 L_ch0_kernel_go_10
    s_cmp_ge_u32 s63, 0x400000
    s_cbranch_scc1 L_ch0_kernel_go_10
    s_sleep 1
    s_branch L_ch0_kernel_poll_9
L_ch0_kernel_go_10:
    s_lshl_b32 s62, s42, 11
    buffer_load_dwordx4 v[152:155], v16, s[12:15], s62 offen sc1
    buffer_load_dwordx4 v[156:159], v16, s[12:15], s62 offen offset:16 sc1
    s_mul_i32 s37, s42, 40960
    buffer_load_dwordx4 v[192:195], v14, s[4:7], s37 offen offset:0 sc1
    buffer_load_dwordx4 v[196:199], v14, s[4:7], s37 offen offset:1024 sc1
    s_add_u32 s37, s37, 2048
    buffer_load_dwordx4 v[200:203], v14, s[4:7], s37 offen offset:0 sc1
    buffer_load_dwordx4 v[204:207], v14, s[4:7], s37 offen offset:1024 sc1
    s_add_u32 s37, s37, 2048
    buffer_load_dwordx4 v[208:211], v14, s[4:7], s37 offen offset:0 sc1
    buffer_load_dwordx4 v[212:215], v14, s[4:7], s37 offen offset:1024 sc1
    s_add_u32 s37, s37, 2048
    buffer_load_dwordx4 v[216:219], v14, s[4:7], s37 offen offset:0 sc1
    s_waitcnt vmcnt(7)
    v_add_f32 v26, v152, v154
    v_add_f32 v28, v153, v155
    v_add_f32 v27, v156, v158
    v_add_f32 v29, v157, v159
    v_add_f32 v26, v26, v27
    v_add_f32 v28, v28, v29
    v_mov_b32 v3, v26
    v_mov_b32 v4, v28
    s_nop 1
    v_permlane32_swap_b32 v26, v3
    v_permlane32_swap_b32 v28, v4
    s_nop 1
    v_add_f32 v26, v26, v3
    v_add_f32 v28, v28, v4
    v_mul_f32 v26, 0x3acccccd, v26
    v_mul_f32 v28, 0x3acccccd, v28
    v_fma_f32 v28, -v26, v26, v28
    v_max_f32 v28, 0, v28
    v_add_f32 v28, 0x3727c5ac, v28
    v_rsq_f32 v30, v28
    s_nop 0
    v_sub_f32 v31, 0, v26
    v_pk_mul_f32 v[72:73], v[30:31], v[72:73] op_sel:[1,0] op_sel_hi:[1,1]
    v_pk_mul_f32 v[74:75], v[30:31], v[74:75] op_sel:[1,0] op_sel_hi:[1,1]
    v_pk_mul_f32 v[76:77], v[30:31], v[76:77] op_sel:[1,0] op_sel_hi:[1,1]
    v_pk_mul_f32 v[78:79], v[30:31], v[78:79] op_sel:[1,0] op_sel_hi:[1,1]
    v_pk_mul_f32 v[80:81], v[30:31], v[80:81] op_sel:[1,0] op_sel_hi:[1,1]
    v_pk_mul_f32 v[82:83], v[30:31], v[82:83] op_sel:[1,0] op_sel_hi:[1,1]
    v_pk_mul_f32 v[84:85], v[30:31], v[84:85] op_sel:[1,0] op_sel_hi:[1,1]
    v_pk_mul_f32 v[86:87], v[30:31], v[86:87] op_sel:[1,0] op_sel_hi:[1,1]
    v_pk_mul_f32 v[88:89], v[30:31], v[88:89] op_sel:[1,0] op_sel_hi:[1,1]
    v_pk_mul_f32 v[90:91], v[30:31], v[90:91] op_sel:[1,0] op_sel_hi:[1,1]
    v_pk_mul_f32 v[92:93], v[30:31], v[92:93] op_sel:[1,0] op_sel_hi:[1,1]
    v_pk_mul_f32 v[94:95], v[30:31], v[94:95] op_sel:[1,0] op_sel_hi:[1,1]
    v_pk_mul_f32 v[96:97], v[30:31], v[96:97] op_sel:[1,0] op_sel_hi:[1,1]
    v_pk_mul_f32 v[98:99], v[30:31], v[98:99] op_sel:[1,0] op_sel_hi:[1,1]
    v_pk_mul_f32 v[100:101], v[30:31], v[100:101] op_sel:[1,0] op_sel_hi:[1,1]
    v_pk_mul_f32 v[102:103], v[30:31], v[102:103] op_sel:[1,0] op_sel_hi:[1,1]
    v_pk_mul_f32 v[104:105], v[30:31], v[104:105] op_sel:[1,0] op_sel_hi:[1,1]
    v_pk_mul_f32 v[106:107], v[30:31], v[106:107] op_sel:[1,0] op_sel_hi:[1,1]
    v_pk_mul_f32 v[108:109], v[30:31], v[108:109] op_sel:[1,0] op_sel_hi:[1,1]
    v_pk_mul_f32 v[110:111], v[30:31], v[110:111] op_sel:[1,0] op_sel_hi:[1,1]
    v_pk_mul_f32 v[112:113], v[30:31], v[112:113] op_sel:[1,0] op_sel_hi:[1,1]
    v_pk_mul_f32 v[114:115], v[30:31], v[114:115] op_sel:[1,0] op_sel_hi:[1,1]
    v_pk_mul_f32 v[116:117], v[30:31], v[116:117] op_sel:[1,0] op_sel_hi:[1,1]
    v_pk_mul_f32 v[118:119], v[30:31], v[118:119] op_sel:[1,0] op_sel_hi:[1,1]
    v_pk_mul_f32 v[120:121], v[30:31], v[120:121] op_sel:[1,0] op_sel_hi:[1,1]
    v_pk_mul_f32 v[122:123], v[30:31], v[122:123] op_sel:[1,0] op_sel_hi:[1,1]
    v_pk_mul_f32 v[124:125], v[30:31], v[124:125] op_sel:[1,0] op_sel_hi:[1,1]
    v_pk_mul_f32 v[126:127], v[30:31], v[126:127] op_sel:[1,0] op_sel_hi:[1,1]
    v_pk_mul_f32 v[128:129], v[30:31], v[128:129] op_sel:[1,0] op_sel_hi:[1,1]
    v_pk_mul_f32 v[130:131], v[30:31], v[130:131] op_sel:[1,0] op_sel_hi:[1,1]
    v_pk_mul_f32 v[132:133], v[30:31], v[132:133] op_sel:[1,0] op_sel_hi:[1,1]
    v_pk_mul_f32 v[134:135], v[30:31], v[134:135] op_sel:[1,0] op_sel_hi:[1,1]
    s_mov_b32 s50, 5
    ds_read_b64_tr_b16 v[40:41], v18 offset:0
    ds_read_b64_tr_b16 v[42:43], v18 offset:1024
    ds_read_b64_tr_b16 v[44:45], v19 offset:0
    ds_read_b64_tr_b16 v[46:47], v19 offset:1024
    ds_read_b64_tr_b16 v[48:49], v20 offset:0
    ds_read_b64_tr_b16 v[50:51], v20 offset:1024
    ds_read_b64_tr_b16 v[52:53], v21 offset:0
    ds_read_b64_tr_b16 v[54:55], v21 offset:1024
L_ch0_kernel_loop_11:
    s_waitcnt vmcnt(6)
    s_waitcnt lgkmcnt(6)
    v_mfma_f32_32x32x16_bf16 v[72:87], v[40:43], v[192:195], v[72:87]
    buffer_load_dwordx4 v[220:223], v14, s[4:7], s37 offen offset:1024 sc1
    s_add_u32 s37, s37, 2048
    s_waitcnt lgkmcnt(4)
    v_mfma_f32_32x32x16_bf16 v[88:103], v[44:47], v[192:195], v[88:103]
    ds_read_b64_tr_b16 v[56:57], v18 offset:4096
    ds_read_b64_tr_b16 v[58:59], v18 offset:5120
    ds_read_b64_tr_b16 v[60:61], v19 offset:4096
    s_waitcnt lgkmcnt(5)
    v_mfma_f32_32x32x16_bf16 v[104:119], v[48:51], v[192:195], v[104:119]
    ds_read_b64_tr_b16 v[62:63], v19 offset:5120
    ds_read_b64_tr_b16 v[64:65], v20 offset:4096
    ds_read_b64_tr_b16 v[66:67], v20 offset:5120
    s_waitcnt lgkmcnt(6)
    v_mfma_f32_32x32x16_bf16 v[120:135], v[52:55], v[192:195], v[120:135]
    ds_read_b64_tr_b16 v[68:69], v21 offset:4096
    ds_read_b64_tr_b16 v[70:71], v21 offset:5120
    s_cmp_eq_u32 s50, 1
    s_cselect_b32 s37, 0x7f000000, s37
    s_waitcnt vmcnt(6)
    s_waitcnt lgkmcnt(6)
    v_mfma_f32_32x32x16_bf16 v[72:87], v[56:59], v[196:199], v[72:87]
    buffer_load_dwordx4 v[192:195], v14, s[4:7], s37 offen offset:0 sc1
    s_waitcnt lgkmcnt(4)
    v_mfma_f32_32x32x16_bf16 v[88:103], v[60:63], v[196:199], v[88:103]
    ds_read_b64_tr_b16 v[40:41], v18 offset:8192
    ds_read_b64_tr_b16 v[42:43], v18 offset:9216
    ds_read_b64_tr_b16 v[44:45], v19 offset:8192
    s_waitcnt lgkmcnt(5)
    v_mfma_f32_32x32x16_bf16 v[104:119], v[64:67], v[196:199], v[104:119]
    ds_read_b64_tr_b16 v[46:47], v19 offset:9216
    ds_read_b64_tr_b16 v[48:49], v20 offset:8192
    ds_read_b64_tr_b16 v[50:51], v20 offset:9216
    s_waitcnt lgkmcnt(6)
    v_mfma_f32_32x32x16_bf16 v[120:135], v[68:71], v[196:199], v[120:135]
    ds_read_b64_tr_b16 v[52:53], v21 offset:8192
    ds_read_b64_tr_b16 v[54:55], v21 offset:9216
    s_waitcnt vmcnt(6)
    s_waitcnt lgkmcnt(6)
    v_mfma_f32_32x32x16_bf16 v[72:87], v[40:43], v[200:203], v[72:87]
    buffer_load_dwordx4 v[196:199], v14, s[4:7], s37 offen offset:1024 sc1
    s_add_u32 s37, s37, 2048
    s_waitcnt lgkmcnt(4)
    v_mfma_f32_32x32x16_bf16 v[88:103], v[44:47], v[200:203], v[88:103]
    ds_read_b64_tr_b16 v[56:57], v18 offset:12288
    ds_read_b64_tr_b16 v[58:59], v18 offset:13312
    s_barrier
    s_add_u32 s60, s44, 24576
    s_cmp_gt_u32 s60, 122880
    s_cselect_b32 s60, 0, s60
    s_sub_u32 s45, s60, s44
    s_mov_b32 s44, s60
    ds_read_b64_tr_b16 v[60:61], v19 offset:12288
    ds_read_b64_tr_b16 v[62:63], v19 offset:13312
    s_waitcnt lgkmcnt(6)
    v_mfma_f32_32x32x16_bf16 v[104:119], v[48:51], v[200:203], v[104:119]
    ds_read_b64_tr_b16 v[64:65], v20 offset:12288
    ds_read_b64_tr_b16 v[66:67], v20 offset:13312
    ds_read_b64_tr_b16 v[68:69], v21 offset:12288
    ds_read_b64_tr_b16 v[70:71], v21 offset:13312
    s_waitcnt lgkmcnt(8)
    v_mfma_f32_32x32x16_bf16 v[120:135], v[52:55], v[200:203], v[120:135]
    v_add_u32 v18, s45, v18
    v_add_u32 v19, s45, v19
    v_add_u32 v20, s45, v20
    v_add_u32 v21, s45, v21
    s_waitcnt vmcnt(6)
    s_waitcnt lgkmcnt(6)
    v_mfma_f32_32x32x16_bf16 v[72:87], v[56:59], v[204:207], v[72:87]
    buffer_load_dwordx4 v[200:203], v14, s[4:7], s37 offen offset:0 sc1
    s_waitcnt lgkmcnt(4)
    v_mfma_f32_32x32x16_bf16 v[88:103], v[60:63], v[204:207], v[88:103]
    ds_read_b64_tr_b16 v[40:41], v18 offset:0
    ds_read_b64_tr_b16 v[42:43], v18 offset:1024
    ds_read_b64_tr_b16 v[44:45], v19 offset:0
    s_waitcnt lgkmcnt(5)
    v_mfma_f32_32x32x16_bf16 v[104:119], v[64:67], v[204:207], v[104:119]
    ds_read_b64_tr_b16 v[46:47], v19 offset:1024
    ds_read_b64_tr_b16 v[48:49], v20 offset:0
    ds_read_b64_tr_b16 v[50:51], v20 offset:1024
    s_waitcnt lgkmcnt(6)
    v_mfma_f32_32x32x16_bf16 v[120:135], v[68:71], v[204:207], v[120:135]
    ds_read_b64_tr_b16 v[52:53], v21 offset:0
    ds_read_b64_tr_b16 v[54:55], v21 offset:1024
    s_waitcnt vmcnt(6)
    s_waitcnt lgkmcnt(6)
    v_mfma_f32_32x32x16_bf16 v[72:87], v[40:43], v[208:211], v[72:87]
    buffer_load_dwordx4 v[204:207], v14, s[4:7], s37 offen offset:1024 sc1
    s_add_u32 s37, s37, 2048
    s_waitcnt lgkmcnt(4)
    v_mfma_f32_32x32x16_bf16 v[88:103], v[44:47], v[208:211], v[88:103]
    ds_read_b64_tr_b16 v[56:57], v18 offset:4096
    ds_read_b64_tr_b16 v[58:59], v18 offset:5120
    ds_read_b64_tr_b16 v[60:61], v19 offset:4096
    s_waitcnt lgkmcnt(5)
    v_mfma_f32_32x32x16_bf16 v[104:119], v[48:51], v[208:211], v[104:119]
    ds_read_b64_tr_b16 v[62:63], v19 offset:5120
    ds_read_b64_tr_b16 v[64:65], v20 offset:4096
    ds_read_b64_tr_b16 v[66:67], v20 offset:5120
    s_waitcnt lgkmcnt(6)
    v_mfma_f32_32x32x16_bf16 v[120:135], v[52:55], v[208:211], v[120:135]
    ds_read_b64_tr_b16 v[68:69], v21 offset:4096
    ds_read_b64_tr_b16 v[70:71], v21 offset:5120
    s_waitcnt vmcnt(6)
    s_waitcnt lgkmcnt(6)
    v_mfma_f32_32x32x16_bf16 v[72:87], v[56:59], v[212:215], v[72:87]
    buffer_load_dwordx4 v[208:211], v14, s[4:7], s37 offen offset:0 sc1
    s_waitcnt lgkmcnt(4)
    v_mfma_f32_32x32x16_bf16 v[88:103], v[60:63], v[212:215], v[88:103]
    ds_read_b64_tr_b16 v[40:41], v18 offset:8192
    ds_read_b64_tr_b16 v[42:43], v18 offset:9216
    ds_read_b64_tr_b16 v[44:45], v19 offset:8192
    s_waitcnt lgkmcnt(5)
    v_mfma_f32_32x32x16_bf16 v[104:119], v[64:67], v[212:215], v[104:119]
    ds_read_b64_tr_b16 v[46:47], v19 offset:9216
    ds_read_b64_tr_b16 v[48:49], v20 offset:8192
    ds_read_b64_tr_b16 v[50:51], v20 offset:9216
    s_waitcnt lgkmcnt(6)
    v_mfma_f32_32x32x16_bf16 v[120:135], v[68:71], v[212:215], v[120:135]
    ds_read_b64_tr_b16 v[52:53], v21 offset:8192
    ds_read_b64_tr_b16 v[54:55], v21 offset:9216
    s_waitcnt vmcnt(6)
    s_waitcnt lgkmcnt(6)
    v_mfma_f32_32x32x16_bf16 v[72:87], v[40:43], v[216:219], v[72:87]
    buffer_load_dwordx4 v[212:215], v14, s[4:7], s37 offen offset:1024 sc1
    s_add_u32 s37, s37, 2048
    s_waitcnt lgkmcnt(4)
    v_mfma_f32_32x32x16_bf16 v[88:103], v[44:47], v[216:219], v[88:103]
    ds_read_b64_tr_b16 v[56:57], v18 offset:12288
    ds_read_b64_tr_b16 v[58:59], v18 offset:13312
    s_barrier
    s_add_u32 s60, s44, 24576
    s_cmp_gt_u32 s60, 122880
    s_cselect_b32 s60, 0, s60
    s_sub_u32 s45, s60, s44
    s_mov_b32 s44, s60
    ds_read_b64_tr_b16 v[60:61], v19 offset:12288
    ds_read_b64_tr_b16 v[62:63], v19 offset:13312
    s_waitcnt lgkmcnt(6)
    v_mfma_f32_32x32x16_bf16 v[104:119], v[48:51], v[216:219], v[104:119]
    ds_read_b64_tr_b16 v[64:65], v20 offset:12288
    ds_read_b64_tr_b16 v[66:67], v20 offset:13312
    ds_read_b64_tr_b16 v[68:69], v21 offset:12288
    ds_read_b64_tr_b16 v[70:71], v21 offset:13312
    s_waitcnt lgkmcnt(8)
    v_mfma_f32_32x32x16_bf16 v[120:135], v[52:55], v[216:219], v[120:135]
    v_add_u32 v18, s45, v18
    v_add_u32 v19, s45, v19
    v_add_u32 v20, s45, v20
    v_add_u32 v21, s45, v21
    s_waitcnt vmcnt(6)
    s_waitcnt lgkmcnt(6)
    v_mfma_f32_32x32x16_bf16 v[72:87], v[56:59], v[220:223], v[72:87]
    buffer_load_dwordx4 v[216:219], v14, s[4:7], s37 offen offset:0 sc1
    s_waitcnt lgkmcnt(4)
    v_mfma_f32_32x32x16_bf16 v[88:103], v[60:63], v[220:223], v[88:103]
    ds_read_b64_tr_b16 v[40:41], v18 offset:0
    ds_read_b64_tr_b16 v[42:43], v18 offset:1024
    ds_read_b64_tr_b16 v[44:45], v19 offset:0
    s_waitcnt lgkmcnt(5)
    v_mfma_f32_32x32x16_bf16 v[104:119], v[64:67], v[220:223], v[104:119]
    ds_read_b64_tr_b16 v[46:47], v19 offset:1024
    ds_read_b64_tr_b16 v[48:49], v20 offset:0
    ds_read_b64_tr_b16 v[50:51], v20 offset:1024
    s_waitcnt lgkmcnt(6)
    v_mfma_f32_32x32x16_bf16 v[120:135], v[68:71], v[220:223], v[120:135]
    ds_read_b64_tr_b16 v[52:53], v21 offset:0
    ds_read_b64_tr_b16 v[54:55], v21 offset:1024
    s_sub_u32 s50, s50, 1
    s_cmp_lg_u32 s50, 0
    s_cbranch_scc1 L_ch0_kernel_loop_11
    s_waitcnt  lgkmcnt(0)
    s_nop 7
    v_mul_f32 v30, s51, v30
    v_pk_mul_f32 v[72:73], v[30:31], v[72:73] op_sel_hi:[0,1]
    v_pk_mul_f32 v[74:75], v[30:31], v[74:75] op_sel_hi:[0,1]
    v_cvt_pk_bf16_f32 v72, v72, v73
    v_cvt_pk_bf16_f32 v73, v74, v75
    buffer_store_dwordx2 v[72:73], v136, s[16:19], 0 offen
    v_pk_mul_f32 v[76:77], v[30:31], v[76:77] op_sel_hi:[0,1]
    v_pk_mul_f32 v[78:79], v[30:31], v[78:79] op_sel_hi:[0,1]
    v_cvt_pk_bf16_f32 v76, v76, v77
    v_cvt_pk_bf16_f32 v77, v78, v79
    buffer_store_dwordx2 v[76:77], v137, s[16:19], 0 offen
    v_pk_mul_f32 v[80:81], v[30:31], v[80:81] op_sel_hi:[0,1]
    v_pk_mul_f32 v[82:83], v[30:31], v[82:83] op_sel_hi:[0,1]
    v_cvt_pk_bf16_f32 v80, v80, v81
    v_cvt_pk_bf16_f32 v81, v82, v83
    buffer_store_dwordx2 v[80:81], v138, s[16:19], 0 offen
    v_pk_mul_f32 v[84:85], v[30:31], v[84:85] op_sel_hi:[0,1]
    v_pk_mul_f32 v[86:87], v[30:31], v[86:87] op_sel_hi:[0,1]
    v_cvt_pk_bf16_f32 v84, v84, v85
    v_cvt_pk_bf16_f32 v85, v86, v87
    buffer_store_dwordx2 v[84:85], v139, s[16:19], 0 offen
    v_pk_mul_f32 v[88:89], v[30:31], v[88:89] op_sel_hi:[0,1]
    v_pk_mul_f32 v[90:91], v[30:31], v[90:91] op_sel_hi:[0,1]
    v_cvt_pk_bf16_f32 v88, v88, v89
    v_cvt_pk_bf16_f32 v89, v90, v91
    buffer_store_dwordx2 v[88:89], v140, s[16:19], 0 offen
    v_pk_mul_f32 v[92:93], v[30:31], v[92:93] op_sel_hi:[0,1]
    v_pk_mul_f32 v[94:95], v[30:31], v[94:95] op_sel_hi:[0,1]
    v_cvt_pk_bf16_f32 v92, v92, v93
    v_cvt_pk_bf16_f32 v93, v94, v95
    buffer_store_dwordx2 v[92:93], v141, s[16:19], 0 offen
    v_pk_mul_f32 v[96:97], v[30:31], v[96:97] op_sel_hi:[0,1]
    v_pk_mul_f32 v[98:99], v[30:31], v[98:99] op_sel_hi:[0,1]
    v_cvt_pk_bf16_f32 v96, v96, v97
    v_cvt_pk_bf16_f32 v97, v98, v99
    buffer_store_dwordx2 v[96:97], v142, s[16:19], 0 offen
    v_pk_mul_f32 v[100:101], v[30:31], v[100:101] op_sel_hi:[0,1]
    v_pk_mul_f32 v[102:103], v[30:31], v[102:103] op_sel_hi:[0,1]
    v_cvt_pk_bf16_f32 v100, v100, v101
    v_cvt_pk_bf16_f32 v101, v102, v103
    buffer_store_dwordx2 v[100:101], v143, s[16:19], 0 offen
    v_pk_mul_f32 v[104:105], v[30:31], v[104:105] op_sel_hi:[0,1]
    v_pk_mul_f32 v[106:107], v[30:31], v[106:107] op_sel_hi:[0,1]
    v_cvt_pk_bf16_f32 v104, v104, v105
    v_cvt_pk_bf16_f32 v105, v106, v107
    buffer_store_dwordx2 v[104:105], v144, s[16:19], 0 offen
    v_pk_mul_f32 v[108:109], v[30:31], v[108:109] op_sel_hi:[0,1]
    v_pk_mul_f32 v[110:111], v[30:31], v[110:111] op_sel_hi:[0,1]
    v_cvt_pk_bf16_f32 v108, v108, v109
    v_cvt_pk_bf16_f32 v109, v110, v111
    buffer_store_dwordx2 v[108:109], v145, s[16:19], 0 offen
    v_pk_mul_f32 v[112:113], v[30:31], v[112:113] op_sel_hi:[0,1]
    v_pk_mul_f32 v[114:115], v[30:31], v[114:115] op_sel_hi:[0,1]
    v_cvt_pk_bf16_f32 v112, v112, v113
    v_cvt_pk_bf16_f32 v113, v114, v115
    buffer_store_dwordx2 v[112:113], v146, s[16:19], 0 offen
    v_pk_mul_f32 v[116:117], v[30:31], v[116:117] op_sel_hi:[0,1]
    v_pk_mul_f32 v[118:119], v[30:31], v[118:119] op_sel_hi:[0,1]
    v_cvt_pk_bf16_f32 v116, v116, v117
    v_cvt_pk_bf16_f32 v117, v118, v119
    buffer_store_dwordx2 v[116:117], v147, s[16:19], 0 offen
    v_pk_mul_f32 v[120:121], v[30:31], v[120:121] op_sel_hi:[0,1]
    v_pk_mul_f32 v[122:123], v[30:31], v[122:123] op_sel_hi:[0,1]
    v_cvt_pk_bf16_f32 v120, v120, v121
    v_cvt_pk_bf16_f32 v121, v122, v123
    buffer_store_dwordx2 v[120:121], v148, s[16:19], 0 offen
    v_pk_mul_f32 v[124:125], v[30:31], v[124:125] op_sel_hi:[0,1]
    v_pk_mul_f32 v[126:127], v[30:31], v[126:127] op_sel_hi:[0,1]
    v_cvt_pk_bf16_f32 v124, v124, v125
    v_cvt_pk_bf16_f32 v125, v126, v127
    buffer_store_dwordx2 v[124:125], v149, s[16:19], 0 offen
    v_pk_mul_f32 v[128:129], v[30:31], v[128:129] op_sel_hi:[0,1]
    v_pk_mul_f32 v[130:131], v[30:31], v[130:131] op_sel_hi:[0,1]
    v_cvt_pk_bf16_f32 v128, v128, v129
    v_cvt_pk_bf16_f32 v129, v130, v131
    buffer_store_dwordx2 v[128:129], v150, s[16:19], 0 offen
    v_pk_mul_f32 v[132:133], v[30:31], v[132:133] op_sel_hi:[0,1]
    v_pk_mul_f32 v[134:135], v[30:31], v[134:135] op_sel_hi:[0,1]
    v_cvt_pk_bf16_f32 v132, v132, v133
    v_cvt_pk_bf16_f32 v133, v134, v135
    buffer_store_dwordx2 v[132:133], v151, s[16:19], 0 offen
    s_endpgm
L_ch0_kernel_v:
    s_sub_u32 s47, s71, 10
    s_add_u32 s16, s28, 0x400000
    s_addc_u32 s17, s29, 0
    s_mov_b32 s18, 0x500000
    s_mov_b32 s19, 0x00020000
    v_lshrrev_b32 v5, 5, v1
    v_and_b32 v6, 31, v1
    s_lshl_b32 s46, s47, 7
    s_mul_i32 s48, s42, 2560
    s_add_u32 s48, s48, 1280
    v_mul_u32_u24 v5, 320, v5
    s_add_u32 s49, s35, 0
    s_and_b32 s49, s49, 3
    s_lshl_b32 s49, s49, 5
    s_add_u32 s49, s49, s46
    v_add_u32 v3, s49, v6
    v_mul_u32_u24 v4, 3277, v3
    v_lshrrev_b32 v4, 16, v4
    v_mul_u32_u24 v7, 20, v4
    v_sub_u32 v3, v3, v7
    v_mul_u32_u24 v136, 163840, v4
    v_lshl_add_u32 v136, v3, 4, v136
    v_add3_u32 v136, v136, v5, s48
    s_add_u32 s49, s35, 1
    s_and_b32 s49, s49, 3
    s_lshl_b32 s49, s49, 5
    s_add_u32 s49, s49, s46
    v_add_u32 v3, s49, v6
    v_mul_u32_u24 v4, 3277, v3
    v_lshrrev_b32 v4, 16, v4
    v_mul_u32_u24 v7, 20, v4
    v_sub_u32 v3, v3, v7
    v_mul_u32_u24 v137, 163840, v4
    v_lshl_add_u32 v137, v3, 4, v137
    v_add3_u32 v137, v137, v5, s48
    s_add_u32 s49, s35, 2
    s_and_b32 s49, s49, 3
    s_lshl_b32 s49, s49, 5
    s_add_u32 s49, s49, s46
    v_add_u32 v3, s49, v6
    v_mul_u32_u24 v4, 3277, v3
    v_lshrrev_b32 v4, 16, v4
    v_mul_u32_u24 v7, 20, v4
    v_sub_u32 v3, v3, v7
    v_mul_u32_u24 v138, 163840, v4
    v_lshl_add_u32 v138, v3, 4, v138
    v_add3_u32 v138, v138, v5, s48
    s_add_u32 s49, s35, 3
    s_and_b32 s49, s49, 3
    s_lshl_b32 s49, s49, 5
    s_add_u32 s49, s49, s46
    v_add_u32 v3, s49, v6
    v_mul_u32_u24 v4, 3277, v3
    v_lshrrev_b32 v4, 16, v4
    v_mul_u32_u24 v7, 20, v4
    v_sub_u32 v3, v3, v7
    v_mul_u32_u24 v139, 163840, v4
    v_lshl_add_u32 v139, v3, 4, v139
    v_add3_u32 v139, v139, v5, s48
    s_waitcnt vmcnt(0)
    s_lshl_b32 s63, s35, 10
    s_add_u32 s63, s63, 147456
    v_and_b32 v6, 31, v1
    v_lshlrev_b32 v6, 2, v6
    v_add_u32 v6, s63, v6
    s_add_u32 s49, s35, 0
    s_and_b32 s49, s49, 3
    s_lshl_b32 s49, s49, 7
    v_add_u32 v5, s49, v6
    ds_read_b32 v184, v5
    s_add_u32 s49, s35, 1
    s_and_b32 s49, s49, 3
    s_lshl_b32 s49, s49, 7
    v_add_u32 v5, s49, v6
    ds_read_b32 v186, v5
    s_add_u32 s49, s35, 2
    s_and_b32 s49, s49, 3
    s_lshl_b32 s49, s49, 7
    v_add_u32 v5, s49, v6
    ds_read_b32 v188, v5
    s_add_u32 s49, s35, 3
    s_and_b32 s49, s49, 3
    s_lshl_b32 s49, s49, 7
    v_add_u32 v5, s49, v6
    ds_read_b32 v190, v5
    s_waitcnt lgkmcnt(0)
    s_lshl_b32 s62, s42, 7
    s_add_u32 s62, s62, 16384
    s_mov_b32 s63, 0
L_ch0_kernel_poll_12:
    buffer_load_dword v12, v13, s[52:55], s62 offen sc1
    s_waitcnt vmcnt(0)
    v_readfirstlane_b32 s61, v12
    s_add_u32 s63, s63, 1
    s_cmp_ge_u32 s61, 16
    s_cbranch_scc1 L_ch0_kernel_go_13
    s_cmp_ge_u32 s63, 0x400000
    s_cbranch_scc1 L_ch0_kernel_go_13
    s_sleep 1
    s_branch L_ch0_kernel_poll_12
L_ch0_kernel_go_13:
    s_lshl_b32 s62, s42, 11
    buffer_load_dwordx4 v[152:155], v16, s[12:15], s62 offen sc1
    buffer_load_dwordx4 v[156:159], v16, s[12:15], s62 offen offset:16 sc1
    s_mul_i32 s37, s42, 40960
    buffer_load_dwordx4 v[192:195], v14, s[4:7], s37 offen offset:0 sc1
    buffer_load_dwordx4 v[196:199], v14, s[4:7], s37 offen offset:1024 sc1
    s_add_u32 s37, s37, 2048
    buffer_load_dwordx4 v[200:203], v14, s[4:7], s37 offen offset:0 sc1
    buffer_load_dwordx4 v[204:207], v14, s[4:7], s37 offen offset:1024 sc1
    s_add_u32 s37, s37, 2048
    buffer_load_dwordx4 v[208:211], v14, s[4:7], s37 offen offset:0 sc1
    buffer_load_dwordx4 v[212:215], v14, s[4:7], s37 offen offset:1024 sc1
    s_add_u32 s37, s37, 2048
    buffer_load_dwordx4 v[216:219], v14, s[4:7], s37 offen offset:0 sc1
    s_waitcnt vmcnt(7)
    v_add_f32 v26, v152, v154
    v_add_f32 v28, v153, v155
    v_add_f32 v27, v156, v158
    v_add_f32 v29, v157, v159
    v_add_f32 v26, v26, v27
    v_add_f32 v28, v28, v29
    v_mov_b32 v3, v26
    v_mov_b32 v4, v28
    s_nop 1
    v_permlane32_swap_b32 v26, v3
    v_permlane32_swap_b32 v28, v4
    s_nop 1
    v_add_f32 v26, v26, v3
    v_add_f32 v28, v28, v4
    v_mul_f32 v26, 0x3acccccd, v26
    v_mul_f32 v28, 0x3acccccd, v28
    v_fma_f32 v28, -v26, v26, v28
    v_max_f32 v28, 0, v28
    v_add_f32 v28, 0x3727c5ac, v28
    v_rsq_f32 v30, v28
    s_nop 0
    v_sub_f32 v31, 0, v26
    ds_write_b32 v6, v30 offset:512
    ds_write_b32 v6, v31 offset:640
    v_lshrrev_b32 v3, 5, v1
    v_lshlrev_b32 v3, 4, v3
    s_lshl_b32 s63, s35, 10
    s_add_u32 s63, s63, 147456
    v_add_u32 v3, s63, v3
    s_waitcnt lgkmcnt(0)
    ds_read_b128 v[152:155], v3 offset:512
    ds_read_b128 v[168:171], v3 offset:640
    ds_read_b128 v[156:159], v3 offset:544
    ds_read_b128 v[172:175], v3 offset:672
    ds_read_b128 v[160:163], v3 offset:576
    ds_read_b128 v[176:179], v3 offset:704
    ds_read_b128 v[164:167], v3 offset:608
    ds_read_b128 v[180:183], v3 offset:736
    s_waitcnt lgkmcnt(0)
    v_pk_mul_f32 v[72:73], v[184:185], v[168:169] op_sel_hi:[0,1]
    v_pk_mul_f32 v[74:75], v[184:185], v[170:171] op_sel_hi:[0,1]
    v_pk_mul_f32 v[76:77], v[184:185], v[172:173] op_sel_hi:[0,1]
    v_pk_mul_f32 v[78:79], v[184:185], v[174:175] op_sel_hi:[0,1]
    v_pk_mul_f32 v[80:81], v[184:185], v[176:177] op_sel_hi:[0,1]
    v_pk_mul_f32 v[82:83], v[184:185], v[178:179] op_sel_hi:[0,1]
    v_pk_mul_f32 v[84:85], v[184:185], v[180:181] op_sel_hi:[0,1]
    v_pk_mul_f32 v[86:87], v[184:185], v[182:183] op_sel_hi:[0,1]
    v_pk_mul_f32 v[88:89], v[186:187], v[168:169] op_sel_hi:[0,1]
    v_pk_mul_f32 v[90:91], v[186:187], v[170:171] op_sel_hi:[0,1]
    v_pk_mul_f32 v[92:93], v[186:187], v[172:173] op_sel_hi:[0,1]
    v_pk_mul_f32 v[94:95], v[186:187], v[174:175] op_sel_hi:[0,1]
    v_pk_mul_f32 v[96:97], v[186:187], v[176:177] op_sel_hi:[0,1]
    v_pk_mul_f32 v[98:99], v[186:187], v[178:179] op_sel_hi:[0,1]
    v_pk_mul_f32 v[100:101], v[186:187], v[180:181] op_sel_hi:[0,1]
    v_pk_mul_f32 v[102:103], v[186:187], v[182:183] op_sel_hi:[0,1]
    v_pk_mul_f32 v[104:105], v[188:189], v[168:169] op_sel_hi:[0,1]
    v_pk_mul_f32 v[106:107], v[188:189], v[170:171] op_sel_hi:[0,1]
    v_pk_mul_f32 v[108:109], v[188:189], v[172:173] op_sel_hi:[0,1]
    v_pk_mul_f32 v[110:111], v[188:189], v[174:175] op_sel_hi:[0,1]
    v_pk_mul_f32 v[112:113], v[188:189], v[176:177] op_sel_hi:[0,1]
    v_pk_mul_f32 v[114:115], v[188:189], v[178:179] op_sel_hi:[0,1]
    v_pk_mul_f32 v[116:117], v[188:189], v[180:181] op_sel_hi:[0,1]
    v_pk_mul_f32 v[118:119], v[188:189], v[182:183] op_sel_hi:[0,1]
    v_pk_mul_f32 v[120:121], v[190:191], v[168:169] op_sel_hi:[0,1]
    v_pk_mul_f32 v[122:123], v[190:191], v[170:171] op_sel_hi:[0,1]
    v_pk_mul_f32 v[124:125], v[190:191], v[172:173] op_sel_hi:[0,1]
    v_pk_mul_f32 v[126:127], v[190:191], v[174:175] op_sel_hi:[0,1]
    v_pk_mul_f32 v[128:129], v[190:191], v[176:177] op_sel_hi:[0,1]
    v_pk_mul_f32 v[130:131], v[190:191], v[178:179] op_sel_hi:[0,1]
    v_pk_mul_f32 v[132:133], v[190:191], v[180:181] op_sel_hi:[0,1]
    v_pk_mul_f32 v[134:135], v[190:191], v[182:183] op_sel_hi:[0,1]
    s_mov_b32 s50, 5
    ds_read_b64_tr_b16 v[40:41], v18 offset:0
    ds_read_b64_tr_b16 v[42:43], v18 offset:1024
    ds_read_b64_tr_b16 v[44:45], v19 offset:0
    ds_read_b64_tr_b16 v[46:47], v19 offset:1024
    ds_read_b64_tr_b16 v[48:49], v20 offset:0
    ds_read_b64_tr_b16 v[50:51], v20 offset:1024
    ds_read_b64_tr_b16 v[52:53], v21 offset:0
    ds_read_b64_tr_b16 v[54:55], v21 offset:1024
L_ch0_kernel_loop_14:
    s_waitcnt vmcnt(6)
    s_waitcnt lgkmcnt(6)
    v_mfma_f32_32x32x16_bf16 v[72:87], v[192:195], v[40:43], v[72:87]
    buffer_load_dwordx4 v[220:223], v14, s[4:7], s37 offen offset:1024 sc1
    s_add_u32 s37, s37, 2048
    s_waitcnt lgkmcnt(4)
    v_mfma_f32_32x32x16_bf16 v[88:103], v[192:195], v[44:47], v[88:103]
    ds_read_b64_tr_b16 v[56:57], v18 offset:4096
    ds_read_b64_tr_b16 v[58:59], v18 offset:5120
    ds_read_b64_tr_b16 v[60:61], v19 offset:4096
    s_waitcnt lgkmcnt(5)
    v_mfma_f32_32x32x16_bf16 v[104:119], v[192:195], v[48:51], v[104:119]
    ds_read_b64_tr_b16 v[62:63], v19 offset:5120
    ds_read_b64_tr_b16 v[64:65], v20 offset:4096
    ds_read_b64_tr_b16 v[66:67], v20 offset:5120
    s_waitcnt lgkmcnt(6)
    v_mfma_f32_32x32x16_bf16 v[120:135], v[192:195], v[52:55], v[120:135]
    ds_read_b64_tr_b16 v[68:69], v21 offset:4096
    ds_read_b64_tr_b16 v[70:71], v21 offset:5120
    s_cmp_eq_u32 s50, 1
    s_cselect_b32 s37, 0x7f000000, s37
    s_waitcnt vmcnt(6)
    s_waitcnt lgkmcnt(6)
    v_mfma_f32_32x32x16_bf16 v[72:87], v[196:199], v[56:59], v[72:87]
    buffer_load_dwordx4 v[192:195], v14, s[4:7], s37 offen offset:0 sc1
    s_waitcnt lgkmcnt(4)
    v_mfma_f32_32x32x16_bf16 v[88:103], v[196:199], v[60:63], v[88:103]
    ds_read_b64_tr_b16 v[40:41], v18 offset:8192
    ds_read_b64_tr_b16 v[42:43], v18 offset:9216
    ds_read_b64_tr_b16 v[44:45], v19 offset:8192
    s_waitcnt lgkmcnt(5)
    v_mfma_f32_32x32x16_bf16 v[104:119], v[196:199], v[64:67], v[104:119]
    ds_read_b64_tr_b16 v[46:47], v19 offset:9216
    ds_read_b64_tr_b16 v[48:49], v20 offset:8192
    ds_read_b64_tr_b16 v[50:51], v20 offset:9216
    s_waitcnt lgkmcnt(6)
    v_mfma_f32_32x32x16_bf16 v[120:135], v[196:199], v[68:71], v[120:135]
    ds_read_b64_tr_b16 v[52:53], v21 offset:8192
    ds_read_b64_tr_b16 v[54:55], v21 offset:9216
    s_waitcnt vmcnt(6)
    s_waitcnt lgkmcnt(6)
    v_mfma_f32_32x32x16_bf16 v[72:87], v[200:203], v[40:43], v[72:87]
    buffer_load_dwordx4 v[196:199], v14, s[4:7], s37 offen offset:1024 sc1
    s_add_u32 s37, s37, 2048
    s_waitcnt lgkmcnt(4)
    v_mfma_f32_32x32x16_bf16 v[88:103], v[200:203], v[44:47], v[88:103]
    ds_read_b64_tr_b16 v[56:57], v18 offset:12288
    ds_read_b64_tr_b16 v[58:59], v18 offset:13312
    s_barrier
    s_add_u32 s60, s44, 24576
    s_cmp_gt_u32 s60, 122880
    s_cselect_b32 s60, 0, s60
    s_sub_u32 s45, s60, s44
    s_mov_b32 s44, s60
    ds_read_b64_tr_b16 v[60:61], v19 offset:12288
    ds_read_b64_tr_b16 v[62:63], v19 offset:13312
    s_waitcnt lgkmcnt(6)
    v_mfma_f32_32x32x16_bf16 v[104:119], v[200:203], v[48:51], v[104:119]
    ds_read_b64_tr_b16 v[64:65], v20 offset:12288
    ds_read_b64_tr_b16 v[66:67], v20 offset:13312
    ds_read_b64_tr_b16 v[68:69], v21 offset:12288
    ds_read_b64_tr_b16 v[70:71], v21 offset:13312
    s_waitcnt lgkmcnt(8)
    v_mfma_f32_32x32x16_bf16 v[120:135], v[200:203], v[52:55], v[120:135]
    v_add_u32 v18, s45, v18
    v_add_u32 v19, s45, v19
    v_add_u32 v20, s45, v20
    v_add_u32 v21, s45, v21
    s_waitcnt vmcnt(6)
    s_waitcnt lgkmcnt(6)
    v_mfma_f32_32x32x16_bf16 v[72:87], v[204:207], v[56:59], v[72:87]
    buffer_load_dwordx4 v[200:203], v14, s[4:7], s37 offen offset:0 sc1
    s_waitcnt lgkmcnt(4)
    v_mfma_f32_32x32x16_bf16 v[88:103], v[204:207], v[60:63], v[88:103]
    ds_read_b64_tr_b16 v[40:41], v18 offset:0
    ds_read_b64_tr_b16 v[42:43], v18 offset:1024
    ds_read_b64_tr_b16 v[44:45], v19 offset:0
    s_waitcnt lgkmcnt(5)
    v_mfma_f32_32x32x16_bf16 v[104:119], v[204:207], v[64:67], v[104:119]
    ds_read_b64_tr_b16 v[46:47], v19 offset:1024
    ds_read_b64_tr_b16 v[48:49], v20 offset:0
    ds_read_b64_tr_b16 v[50:51], v20 offset:1024
    s_waitcnt lgkmcnt(6)
    v_mfma_f32_32x32x16_bf16 v[120:135], v[204:207], v[68:71], v[120:135]
    ds_read_b64_tr_b16 v[52:53], v21 offset:0
    ds_read_b64_tr_b16 v[54:55], v21 offset:1024
    s_waitcnt vmcnt(6)
    s_waitcnt lgkmcnt(6)
    v_mfma_f32_32x32x16_bf16 v[72:87], v[208:211], v[40:43], v[72:87]
    buffer_load_dwordx4 v[204:207], v14, s[4:7], s37 offen offset:1024 sc1
    s_add_u32 s37, s37, 2048
    s_waitcnt lgkmcnt(4)
    v_mfma_f32_32x32x16_bf16 v[88:103], v[208:211], v[44:47], v[88:103]
    ds_read_b64_tr_b16 v[56:57], v18 offset:4096
    ds_read_b64_tr_b16 v[58:59], v18 offset:5120
    ds_read_b64_tr_b16 v[60:61], v19 offset:4096
    s_waitcnt lgkmcnt(5)
    v_mfma_f32_32x32x16_bf16 v[104:119], v[208:211], v[48:51], v[104:119]
    ds_read_b64_tr_b16 v[62:63], v19 offset:5120
    ds_read_b64_tr_b16 v[64:65], v20 offset:4096
    ds_read_b64_tr_b16 v[66:67], v20 offset:5120
    s_waitcnt lgkmcnt(6)
    v_mfma_f32_32x32x16_bf16 v[120:135], v[208:211], v[52:55], v[120:135]
    ds_read_b64_tr_b16 v[68:69], v21 offset:4096
    ds_read_b64_tr_b16 v[70:71], v21 offset:5120
    s_waitcnt vmcnt(6)
    s_waitcnt lgkmcnt(6)
    v_mfma_f32_32x32x16_bf16 v[72:87], v[212:215], v[56:59], v[72:87]
    buffer_load_dwordx4 v[208:211], v14, s[4:7], s37 offen offset:0 sc1
    s_waitcnt lgkmcnt(4)
    v_mfma_f32_32x32x16_bf16 v[88:103], v[212:215], v[60:63], v[88:103]
    ds_read_b64_tr_b16 v[40:41], v18 offset:8192
    ds_read_b64_tr_b16 v[42:43], v18 offset:9216
    ds_read_b64_tr_b16 v[44:45], v19 offset:8192
    s_waitcnt lgkmcnt(5)
    v_mfma_f32_32x32x16_bf16 v[104:119], v[212:215], v[64:67], v[104:119]
    ds_read_b64_tr_b16 v[46:47], v19 offset:9216
    ds_read_b64_tr_b16 v[48:49], v20 offset:8192
    ds_read_b64_tr_b16 v[50:51], v20 offset:9216
    s_waitcnt lgkmcnt(6)
    v_mfma_f32_32x32x16_bf16 v[120:135], v[212:215], v[68:71], v[120:135]
    ds_read_b64_tr_b16 v[52:53], v21 offset:8192
    ds_read_b64_tr_b16 v[54:55], v21 offset:9216
    s_waitcnt vmcnt(6)
    s_waitcnt lgkmcnt(6)
    v_mfma_f32_32x32x16_bf16 v[72:87], v[216:219], v[40:43], v[72:87]
    buffer_load_dwordx4 v[212:215], v14, s[4:7], s37 offen offset:1024 sc1
    s_add_u32 s37, s37, 2048
    s_waitcnt lgkmcnt(4)
    v_mfma_f32_32x32x16_bf16 v[88:103], v[216:219], v[44:47], v[88:103]
    ds_read_b64_tr_b16 v[56:57], v18 offset:12288
    ds_read_b64_tr_b16 v[58:59], v18 offset:13312
    s_barrier
    s_add_u32 s60, s44, 24576
    s_cmp_gt_u32 s60, 122880
    s_cselect_b32 s60, 0, s60
    s_sub_u32 s45, s60, s44
    s_mov_b32 s44, s60
    ds_read_b64_tr_b16 v[60:61], v19 offset:12288
    ds_read_b64_tr_b16 v[62:63], v19 offset:13312
    s_waitcnt lgkmcnt(6)
    v_mfma_f32_32x32x16_bf16 v[104:119], v[216:219], v[48:51], v[104:119]
    ds_read_b64_tr_b16 v[64:65], v20 offset:12288
    ds_read_b64_tr_b16 v[66:67], v20 offset:13312
    ds_read_b64_tr_b16 v[68:69], v21 offset:12288
    ds_read_b64_tr_b16 v[70:71], v21 offset:13312
    s_waitcnt lgkmcnt(8)
    v_mfma_f32_32x32x16_bf16 v[120:135], v[216:219], v[52:55], v[120:135]
    v_add_u32 v18, s45, v18
    v_add_u32 v19, s45, v19
    v_add_u32 v20, s45, v20
    v_add_u32 v21, s45, v21
    s_waitcnt vmcnt(6)
    s_waitcnt lgkmcnt(6)
    v_mfma_f32_32x32x16_bf16 v[72:87], v[220:223], v[56:59], v[72:87]
    buffer_load_dwordx4 v[216:219], v14, s[4:7], s37 offen offset:0 sc1
    s_waitcnt lgkmcnt(4)
    v_mfma_f32_32x32x16_bf16 v[88:103], v[220:223], v[60:63], v[88:103]
    ds_read_b64_tr_b16 v[40:41], v18 offset:0
    ds_read_b64_tr_b16 v[42:43], v18 offset:1024
    ds_read_b64_tr_b16 v[44:45], v19 offset:0
    s_waitcnt lgkmcnt(5)
    v_mfma_f32_32x32x16_bf16 v[104:119], v[220:223], v[64:67], v[104:119]
    ds_read_b64_tr_b16 v[46:47], v19 offset:1024
    ds_read_b64_tr_b16 v[48:49], v20 offset:0
    ds_read_b64_tr_b16 v[50:51], v20 offset:1024
    s_waitcnt lgkmcnt(6)
    v_mfma_f32_32x32x16_bf16 v[120:135], v[220:223], v[68:71], v[120:135]
    ds_read_b64_tr_b16 v[52:53], v21 offset:0
    ds_read_b64_tr_b16 v[54:55], v21 offset:1024
    s_sub_u32 s50, s50, 1
    s_cmp_lg_u32 s50, 0
    s_cbranch_scc1 L_ch0_kernel_loop_14
    s_waitcnt  lgkmcnt(0)
    s_nop 7
    v_pk_mul_f32 v[72:73], v[152:153], v[72:73]
    v_pk_mul_f32 v[74:75], v[154:155], v[74:75]
    v_pk_mul_f32 v[76:77], v[156:157], v[76:77]
    v_pk_mul_f32 v[78:79], v[158:159], v[78:79]
    v_cvt_pk_bf16_f32 v72, v72, v73
    v_cvt_pk_bf16_f32 v73, v74, v75
    v_cvt_pk_bf16_f32 v74, v76, v77
    v_cvt_pk_bf16_f32 v75, v78, v79
    buffer_store_dwordx4 v[72:75], v136, s[16:19], 0 offen offset:0 sc1
    v_pk_mul_f32 v[80:81], v[160:161], v[80:81]
    v_pk_mul_f32 v[82:83], v[162:163], v[82:83]
    v_pk_mul_f32 v[84:85], v[164:165], v[84:85]
    v_pk_mul_f32 v[86:87], v[166:167], v[86:87]
    v_cvt_pk_bf16_f32 v80, v80, v81
    v_cvt_pk_bf16_f32 v81, v82, v83
    v_cvt_pk_bf16_f32 v82, v84, v85
    v_cvt_pk_bf16_f32 v83, v86, v87
    buffer_store_dwordx4 v[80:83], v136, s[16:19], 0 offen offset:640 sc1
    v_pk_mul_f32 v[88:89], v[152:153], v[88:89]
    v_pk_mul_f32 v[90:91], v[154:155], v[90:91]
    v_pk_mul_f32 v[92:93], v[156:157], v[92:93]
    v_pk_mul_f32 v[94:95], v[158:159], v[94:95]
    v_cvt_pk_bf16_f32 v88, v88, v89
    v_cvt_pk_bf16_f32 v89, v90, v91
    v_cvt_pk_bf16_f32 v90, v92, v93
    v_cvt_pk_bf16_f32 v91, v94, v95
    buffer_store_dwordx4 v[88:91], v137, s[16:19], 0 offen offset:0 sc1
    v_pk_mul_f32 v[96:97], v[160:161], v[96:97]
    v_pk_mul_f32 v[98:99], v[162:163], v[98:99]
    v_pk_mul_f32 v[100:101], v[164:165], v[100:101]
    v_pk_mul_f32 v[102:103], v[166:167], v[102:103]
    v_cvt_pk_bf16_f32 v96, v96, v97
    v_cvt_pk_bf16_f32 v97, v98, v99
    v_cvt_pk_bf16_f32 v98, v100, v101
    v_cvt_pk_bf16_f32 v99, v102, v103
    buffer_store_dwordx4 v[96:99], v137, s[16:19], 0 offen offset:640 sc1
    v_pk_mul_f32 v[104:105], v[152:153], v[104:105]
    v_pk_mul_f32 v[106:107], v[154:155], v[106:107]
    v_pk_mul_f32 v[108:109], v[156:157], v[108:109]
    v_pk_mul_f32 v[110:111], v[158:159], v[110:111]
    v_cvt_pk_bf16_f32 v104, v104, v105
    v_cvt_pk_bf16_f32 v105, v106, v107
    v_cvt_pk_bf16_f32 v106, v108, v109
    v_cvt_pk_bf16_f32 v107, v110, v111
    buffer_store_dwordx4 v[104:107], v138, s[16:19], 0 offen offset:0 sc1
    v_pk_mul_f32 v[112:113], v[160:161], v[112:113]
    v_pk_mul_f32 v[114:115], v[162:163], v[114:115]
    v_pk_mul_f32 v[116:117], v[164:165], v[116:117]
    v_pk_mul_f32 v[118:119], v[166:167], v[118:119]
    v_cvt_pk_bf16_f32 v112, v112, v113
    v_cvt_pk_bf16_f32 v113, v114, v115
    v_cvt_pk_bf16_f32 v114, v116, v117
    v_cvt_pk_bf16_f32 v115, v118, v119
    buffer_store_dwordx4 v[112:115], v138, s[16:19], 0 offen offset:640 sc1
    v_pk_mul_f32 v[120:121], v[152:153], v[120:121]
    v_pk_mul_f32 v[122:123], v[154:155], v[122:123]
    v_pk_mul_f32 v[124:125], v[156:157], v[124:125]
    v_pk_mul_f32 v[126:127], v[158:159], v[126:127]
    v_cvt_pk_bf16_f32 v120, v120, v121
    v_cvt_pk_bf16_f32 v121, v122, v123
    v_cvt_pk_bf16_f32 v122, v124, v125
    v_cvt_pk_bf16_f32 v123, v126, v127
    buffer_store_dwordx4 v[120:123], v139, s[16:19], 0 offen offset:0 sc1
    v_pk_mul_f32 v[128:129], v[160:161], v[128:129]
    v_pk_mul_f32 v[130:131], v[162:163], v[130:131]
    v_pk_mul_f32 v[132:133], v[164:165], v[132:133]
    v_pk_mul_f32 v[134:135], v[166:167], v[134:135]
    v_cvt_pk_bf16_f32 v128, v128, v129
    v_cvt_pk_bf16_f32 v129, v130, v131
    v_cvt_pk_bf16_f32 v130, v132, v133
    v_cvt_pk_bf16_f32 v131, v134, v135
    buffer_store_dwordx4 v[128:131], v139, s[16:19], 0 offen offset:640 sc1
    s_endpgm
L_ch0_kernel_end:
    s_endpgm
.section .rodata,"a"
.p2align 6
.amdhsa_kernel ch0_kernel
  .amdhsa_next_free_vgpr 240
  .amdhsa_next_free_sgpr 100
  .amdhsa_accum_offset 240
  .amdhsa_group_segment_fixed_size 0
  .amdhsa_kernarg_size 80
  .amdhsa_user_sgpr_count 2
  .amdhsa_user_sgpr_kernarg_segment_ptr 1
  .amdhsa_system_sgpr_workgroup_id_x 1
.end_amdhsa_kernel
.text
.globl ch1_kernel
.p2align 8
.type ch1_kernel,@function
ch1_kernel:
    s_cmp_ge_u32 s2, 256
    s_cbranch_scc1 L_ch1_kernel_end
    s_load_dwordx2 s[28:29], s[0:1], 72
    s_load_dwordx4 s[20:23], s[0:1], 0
    s_load_dwordx2 s[24:25], s[0:1], 56
    v_lshrrev_b32 v2, 6, v0
    s_and_b32 s30, s2, 7
    s_lshr_b32 s31, s2, 3
    v_and_b32 v1, 63, v0
    v_readfirstlane_b32 s64, v2
    v_and_b32 v2, 3, v2
    v_lshlrev_b32 v14, 4, v1
    s_lshr_b32 s66, s30, 1
    s_lshl_b32 s66, s66, 3
    s_and_b32 s33, s31, 7
    s_add_u32 s66, s66, s33
    s_and_b32 s67, s30, 1
    s_lshl_b32 s67, s67, 2
    s_lshr_b32 s34, s31, 3
    s_add_u32 s67, s67, s34
    s_and_b32 s68, s30, 1
    s_lshl_b32 s68, s68, 3
    s_add_u32 s68, s68, s33
    s_lshr_b32 s69, s30, 1
    s_lshl_b32 s69, s69, 2
    s_add_u32 s69, s69, s34
    s_lshr_b32 s70, s30, 1
    s_lshl_b32 s70, s70, 2
    s_and_b32 s33, s31, 3
    s_add_u32 s70, s70, s33
    s_and_b32 s71, s30, 1
    s_lshl_b32 s71, s71, 3
    s_lshr_b32 s34, s31, 2
    s_add_u32 s71, s71, s34
    s_and_b32 s35, s64, 3
    s_cmp_lt_u32 s64, 4
    s_cbranch_scc1 L_ch1_kernel_cons
    s_mul_i32 s40, s35, 5120
    s_mul_i32 s41, s35, 6144
    s_lshl_b32 s42, s35, 12
    s_mul_i32 s36, s67, 102400
    s_add_u32 s36, s36, s40
    s_add_u32 s36, s36, 0x400000
    s_mul_i32 s37, s69, 245760
    s_add_u32 s37, s37, s41
    s_mul_i32 s38, s67, 245760
    s_add_u32 s38, s38, s40
    s_add_u32 s38, s38, 0x500000
    s_lshl_b32 s39, s71, 8
    s_waitcnt lgkmcnt(0)
    s_add_u32 s8, s28, 0x2400000
    s_addc_u32 s9, s29, 0
    s_mov_b32 s10, 0x6e0000
    s_mov_b32 s11, 0x00020000
    s_mov_b32 s12, s22
    s_mov_b32 s13, s23
    s_mov_b32 s14, 0x258000
    s_mov_b32 s15, 0x00020000
    s_add_u32 m0, s40, 0
    s_add_u32 s43, s36, 4096
    buffer_load_dwordx4 v14, s[8:11], s36 offen offset:0 lds
    buffer_load_dwordx4 v14, s[8:11], s36 offen offset:1024 lds
    buffer_load_dwordx4 v14, s[8:11], s36 offen offset:2048 lds
    buffer_load_dwordx4 v14, s[8:11], s36 offen offset:3072 lds
    s_add_u32 m0, s40, 4096
    s_add_u32 s36, s36, 20480
    buffer_load_dwordx4 v14, s[8:11], s43 offen lds
    s_add_u32 m0, s40, 24576
    s_add_u32 s43, s36, 4096
    buffer_load_dwordx4 v14, s[8:11], s36 offen offset:0 lds
    buffer_load_dwordx4 v14, s[8:11], s36 offen offset:1024 lds
    buffer_load_dwordx4 v14, s[8:11], s36 offen offset:2048 lds
    buffer_load_dwordx4 v14, s[8:11], s36 offen offset:3072 lds
    s_add_u32 m0, s40, 28672
    s_add_u32 s36, s36, 20480
    buffer_load_dwordx4 v14, s[8:11], s43 offen lds
    s_waitcnt vmcnt(5)
    s_barrier
    s_add_u32 m0, s40, 49152
    s_add_u32 s43, s36, 4096
    buffer_load_dwordx4 v14, s[8:11], s36 offen offset:0 lds
    buffer_load_dwordx4 v14, s[8:11], s36 offen offset:1024 lds
    buffer_load_dwordx4 v14, s[8:11], s36 offen offset:2048 lds
    buffer_load_dwordx4 v14, s[8:11], s36 offen offset:3072 lds
    s_add_u32 m0, s40, 53248
    s_add_u32 s36, s36, 20480
    buffer_load_dwordx4 v14, s[8:11], s43 offen lds
    s_add_u32 m0, s40, 73728
    s_add_u32 s43, s36, 4096
    buffer_load_dwordx4 v14, s[8:11], s36 offen offset:0 lds
    buffer_load_dwordx4 v14, s[8:11], s36 offen offset:1024 lds
    buffer_load_dwordx4 v14, s[8:11], s36 offen offset:2048 lds
    buffer_load_dwordx4 v14, s[8:11], s36 offen offset:3072 lds
    s_add_u32 m0, s40, 77824
    s_add_u32 s36, s36, 20480
    buffer_load_dwordx4 v14, s[8:11], s43 offen lds
    s_add_u32 m0, s40, 98304
    s_add_u32 s43, s36, 4096
    buffer_load_dwordx4 v14, s[8:11], s36 offen offset:0 lds
    buffer_load_dwordx4 v14, s[8:11], s36 offen offset:1024 lds
    buffer_load_dwordx4 v14, s[8:11], s36 offen offset:2048 lds
    buffer_load_dwordx4 v14, s[8:11], s36 offen offset:3072 lds
    s_add_u32 m0, s40, 102400
    s_add_u32 s36, s36, 20480
    buffer_load_dwordx4 v14, s[8:11], s43 offen lds
    s_waitcnt vmcnt(15)
    s_barrier
    s_add_u32 m0, s41, 122880
    s_add_u32 s43, s37, 4096
    buffer_load_dwordx4 v14, s[8:11], s37 offen offset:0 lds
    buffer_load_dwordx4 v14, s[8:11], s37 offen offset:1024 lds
    buffer_load_dwordx4 v14, s[8:11], s37 offen offset:2048 lds
    buffer_load_dwordx4 v14, s[8:11], s37 offen offset:3072 lds
    s_add_u32 m0, s41, 126976
    s_add_u32 s37, s37, 24576
    buffer_load_dwordx4 v14, s[8:11], s43 offen offset:0 lds
    buffer_load_dwordx4 v14, s[8:11], s43 offen offset:1024 lds
    s_waitcnt vmcnt(16)
    s_barrier
    s_add_u32 m0, s41, 0
    s_add_u32 s43, s37, 4096
    buffer_load_dwordx4 v14, s[8:11], s37 offen offset:0 lds
    buffer_load_dwordx4 v14, s[8:11], s37 offen offset:1024 lds
    buffer_load_dwordx4 v14, s[8:11], s37 offen offset:2048 lds
    buffer_load_dwordx4 v14, s[8:11], s37 offen offset:3072 lds
    s_add_u32 m0, s41, 4096
    s_add_u32 s37, s37, 24576
    buffer_load_dwordx4 v14, s[8:11], s43 offen offset:0 lds
    buffer_load_dwordx4 v14, s[8:11], s43 offen offset:1024 lds
    s_waitcnt vmcnt(17)
    s_barrier
    s_add_u32 m0, s41, 24576
    s_add_u32 s43, s37, 4096
    buffer_load_dwordx4 v14, s[8:11], s37 offen offset:0 lds
    buffer_load_dwordx4 v14, s[8:11], s37 offen offset:1024 lds
    buffer_load_dwordx4 v14, s[8:11], s37 offen offset:2048 lds
    buffer_load_dwordx4 v14, s[8:11], s37 offen offset:3072 lds
    s_add_u32 m0, s41, 28672
    s_add_u32 s37, s37, 24576
    buffer_load_dwordx4 v14, s[8:11], s43 offen offset:0 lds
    buffer_load_dwordx4 v14, s[8:11], s43 offen offset:1024 lds
    s_waitcnt vmcnt(18)
    s_barrier
    s_add_u32 m0, s41, 49152
    s_add_u32 s43, s37, 4096
    buffer_load_dwordx4 v14, s[8:11], s37 offen offset:0 lds
    buffer_load_dwordx4 v14, s[8:11], s37 offen offset:1024 lds
    buffer_load_dwordx4 v14, s[8:11], s37 offen offset:2048 lds
    buffer_load_dwordx4 v14, s[8:11], s37 offen offset:3072 lds
    s_add_u32 m0, s41, 53248
    s_add_u32 s37, s37, 24576
    buffer_load_dwordx4 v14, s[8:11], s43 offen offset:0 lds
    buffer_load_dwordx4 v14, s[8:11], s43 offen offset:1024 lds
    s_waitcnt vmcnt(18)
    s_barrier
    s_add_u32 m0, s41, 73728
    s_add_u32 s43, s37, 4096
    buffer_load_dwordx4 v14, s[8:11], s37 offen offset:0 lds
    buffer_load_dwordx4 v14, s[8:11], s37 offen offset:1024 lds
    buffer_load_dwordx4 v14, s[8:11], s37 offen offset:2048 lds
    buffer_load_dwordx4 v14, s[8:11], s37 offen offset:3072 lds
    s_add_u32 m0, s41, 77824
    s_add_u32 s37, s37, 24576
    buffer_load_dwordx4 v14, s[8:11], s43 offen offset:0 lds
    buffer_load_dwordx4 v14, s[8:11], s43 offen offset:1024 lds
    s_waitcnt vmcnt(18)
    s_barrier
    s_add_u32 m0, s41, 98304
    s_add_u32 s43, s37, 4096
    buffer_load_dwordx4 v14, s[8:11], s37 offen offset:0 lds
    buffer_load_dwordx4 v14, s[8:11], s37 offen offset:1024 lds
    buffer_load_dwordx4 v14, s[8:11], s37 offen offset:2048 lds
    buffer_load_dwordx4 v14, s[8:11], s37 offen offset:3072 lds
    s_add_u32 m0, s41, 102400
    s_add_u32 s37, s37, 24576
    buffer_load_dwordx4 v14, s[8:11], s43 offen offset:0 lds
    buffer_load_dwordx4 v14, s[8:11], s43 offen offset:1024 lds
    s_waitcnt vmcnt(18)
    s_barrier
    s_add_u32 m0, s41, 122880
    s_add_u32 s43, s37, 4096
    buffer_load_dwordx4 v14, s[8:11], s37 offen offset:0 lds
    buffer_load_dwordx4 v14, s[8:11], s37 offen offset:1024 lds
    buffer_load_dwordx4 v14, s[8:11], s37 offen offset:2048 lds
    buffer_load_dwordx4 v14, s[8:11], s37 offen offset:3072 lds
    s_add_u32 m0, s41, 126976
    s_add_u32 s37, s37, 24576
    buffer_load_dwordx4 v14, s[8:11], s43 offen offset:0 lds
    buffer_load_dwordx4 v14, s[8:11], s43 offen offset:1024 lds
    s_waitcnt vmcnt(18)
    s_barrier
    s_add_u32 m0, s41, 0
    s_add_u32 s43, s37, 4096
    buffer_load_dwordx4 v14, s[8:11], s37 offen offset:0 lds
    buffer_load_dwordx4 v14, s[8:11], s37 offen offset:1024 lds
    buffer_load_dwordx4 v14, s[8:11], s37 offen offset:2048 lds
    buffer_load_dwordx4 v14, s[8:11], s37 offen offset:3072 lds
    s_add_u32 m0, s41, 4096
    s_add_u32 s37, s37, 24576
    buffer_load_dwordx4 v14, s[8:11], s43 offen offset:0 lds
    buffer_load_dwordx4 v14, s[8:11], s43 offen offset:1024 lds
    s_waitcnt vmcnt(18)
    s_barrier
    s_add_u32 m0, s41, 24576
    s_add_u32 s43, s37, 4096
    buffer_load_dwordx4 v14, s[8:11], s37 offen offset:0 lds
    buffer_load_dwordx4 v14, s[8:11], s37 offen offset:1024 lds
    buffer_load_dwordx4 v14, s[8:11], s37 offen offset:2048 lds
    buffer_load_dwordx4 v14, s[8:11], s37 offen offset:3072 lds
    s_add_u32 m0, s41, 28672
    s_add_u32 s37, s37, 24576
    buffer_load_dwordx4 v14, s[8:11], s43 offen offset:0 lds
    buffer_load_dwordx4 v14, s[8:11], s43 offen offset:1024 lds
    s_waitcnt vmcnt(18)
    s_barrier
    s_add_u32 m0, s41, 49152
    s_add_u32 s43, s37, 4096
    buffer_load_dwordx4 v14, s[8:11], s37 offen offset:0 lds
    buffer_load_dwordx4 v14, s[8:11], s37 offen offset:1024 lds
    buffer_load_dwordx4 v14, s[8:11], s37 offen offset:2048 lds
    buffer_load_dwordx4 v14, s[8:11], s37 offen offset:3072 lds
    s_add_u32 m0, s41, 53248
    s_add_u32 s37, s37, 24576
    buffer_load_dwordx4 v14, s[8:11], s43 offen offset:0 lds
    buffer_load_dwordx4 v14, s[8:11], s43 offen offset:1024 lds
    s_waitcnt vmcnt(18)
    s_barrier
    s_add_u32 m0, s40, 73728
    s_add_u32 s43, s38, 4096
    buffer_load_dwordx4 v14, s[8:11], s38 offen offset:0 lds
    buffer_load_dwordx4 v14, s[8:11], s38 offen offset:1024 lds
    buffer_load_dwordx4 v14, s[8:11], s38 offen offset:2048 lds
    buffer_load_dwordx4 v14, s[8:11], s38 offen offset:3072 lds
    s_add_u32 m0, s40, 77824
    s_add_u32 s38, s38, 20480
    buffer_load_dwordx4 v14, s[8:11], s43 offen lds
    s_waitcnt vmcnt(17)
    s_barrier
    s_add_u32 m0, s40, 98304
    s_add_u32 s43, s38, 4096
    buffer_load_dwordx4 v14, s[8:11], s38 offen offset:0 lds
    buffer_load_dwordx4 v14, s[8:11], s38 offen offset:1024 lds
    buffer_load_dwordx4 v14, s[8:11], s38 offen offset:2048 lds
    buffer_load_dwordx4 v14, s[8:11], s38 offen offset:3072 lds
    s_add_u32 m0, s40, 102400
    s_add_u32 s38, s38, 20480
    buffer_load_dwordx4 v14, s[8:11], s43 offen lds
    s_waitcnt vmcnt(16)
    s_barrier
    s_add_u32 m0, s40, 122880
    s_add_u32 s43, s38, 4096
    buffer_load_dwordx4 v14, s[8:11], s38 offen offset:0 lds
    buffer_load_dwordx4 v14, s[8:11], s38 offen offset:1024 lds
    buffer_load_dwordx4 v14, s[8:11], s38 offen offset:2048 lds
    buffer_load_dwordx4 v14, s[8:11], s38 offen offset:3072 lds
    s_add_u32 m0, s40, 126976
    s_add_u32 s38, s38, 20480
    buffer_load_dwordx4 v14, s[8:11], s43 offen lds
    s_waitcnt vmcnt(15)
    s_barrier
    s_add_u32 m0, s40, 0
    s_add_u32 s43, s38, 4096
    buffer_load_dwordx4 v14, s[8:11], s38 offen offset:0 lds
    buffer_load_dwordx4 v14, s[8:11], s38 offen offset:1024 lds
    buffer_load_dwordx4 v14, s[8:11], s38 offen offset:2048 lds
    buffer_load_dwordx4 v14, s[8:11], s38 offen offset:3072 lds
    s_add_u32 m0, s40, 4096
    s_add_u32 s38, s38, 20480
    buffer_load_dwordx4 v14, s[8:11], s43 offen lds
    s_waitcnt vmcnt(15)
    s_barrier
    s_add_u32 m0, s40, 24576
    s_add_u32 s43, s38, 4096
    buffer_load_dwordx4 v14, s[8:11], s38 offen offset:0 lds
    buffer_load_dwordx4 v14, s[8:11], s38 offen offset:1024 lds
    buffer_load_dwordx4 v14, s[8:11], s38 offen offset:2048 lds
    buffer_load_dwordx4 v14, s[8:11], s38 offen offset:3072 lds
    s_add_u32 m0, s40, 28672
    s_add_u32 s38, s38, 20480
    buffer_load_dwordx4 v14, s[8:11], s43 offen lds
    s_waitcnt vmcnt(15)
    s_barrier
    s_add_u32 m0, s40, 49152
    s_add_u32 s43, s38, 4096
    buffer_load_dwordx4 v14, s[8:11], s38 offen offset:0 lds
    buffer_load_dwordx4 v14, s[8:11], s38 offen offset:1024 lds
    buffer_load_dwordx4 v14, s[8:11], s38 offen offset:2048 lds
    buffer_load_dwordx4 v14, s[8:11], s38 offen offset:3072 lds
    s_add_u32 m0, s40, 53248
    s_add_u32 s38, s38, 20480
    buffer_load_dwordx4 v14, s[8:11], s43 offen lds
    s_waitcnt vmcnt(15)
    s_barrier
    s_add_u32 m0, s40, 73728
    s_add_u32 s43, s38, 4096
    buffer_load_dwordx4 v14, s[8:11], s38 offen offset:0 lds
    buffer_load_dwordx4 v14, s[8:11], s38 offen offset:1024 lds
    buffer_load_dwordx4 v14, s[8:11], s38 offen offset:2048 lds
    buffer_load_dwordx4 v14, s[8:11], s38 offen offset:3072 lds
    s_add_u32 m0, s40, 77824
    s_add_u32 s38, s38, 20480
    buffer_load_dwordx4 v14, s[8:11], s43 offen lds
    s_waitcnt vmcnt(15)
    s_barrier
    s_add_u32 m0, s40, 98304
    s_add_u32 s43, s38, 4096
    buffer_load_dwordx4 v14, s[8:11], s38 offen offset:0 lds
    buffer_load_dwordx4 v14, s[8:11], s38 offen offset:1024 lds
    buffer_load_dwordx4 v14, s[8:11], s38 offen offset:2048 lds
    buffer_load_dwordx4 v14, s[8:11], s38 offen offset:3072 lds
    s_add_u32 m0, s40, 102400
    s_add_u32 s38, s38, 20480
    buffer_load_dwordx4 v14, s[8:11], s43 offen lds
    s_waitcnt vmcnt(15)
    s_barrier
    s_add_u32 m0, s40, 122880
    s_add_u32 s43, s38, 4096
    buffer_load_dwordx4 v14, s[8:11], s38 offen offset:0 lds
    buffer_load_dwordx4 v14, s[8:11], s38 offen offset:1024 lds
    buffer_load_dwordx4 v14, s[8:11], s38 offen offset:2048 lds
    buffer_load_dwordx4 v14, s[8:11], s38 offen offset:3072 lds
    s_add_u32 m0, s40, 126976
    s_add_u32 s38, s38, 20480
    buffer_load_dwordx4 v14, s[8:11], s43 offen lds
    s_waitcnt vmcnt(15)
    s_barrier
    s_add_u32 m0, s40, 0
    s_add_u32 s43, s38, 4096
    buffer_load_dwordx4 v14, s[8:11], s38 offen offset:0 lds
    buffer_load_dwordx4 v14, s[8:11], s38 offen offset:1024 lds
    buffer_load_dwordx4 v14, s[8:11], s38 offen offset:2048 lds
    buffer_load_dwordx4 v14, s[8:11], s38 offen offset:3072 lds
    s_add_u32 m0, s40, 4096
    s_add_u32 s38, s38, 20480
    buffer_load_dwordx4 v14, s[8:11], s43 offen lds
    s_waitcnt vmcnt(15)
    s_barrier
    s_add_u32 m0, s40, 24576
    s_add_u32 s43, s38, 4096
    buffer_load_dwordx4 v14, s[8:11], s38 offen offset:0 lds
    buffer_load_dwordx4 v14, s[8:11], s38 offen offset:1024 lds
    buffer_load_dwordx4 v14, s[8:11], s38 offen offset:2048 lds
    buffer_load_dwordx4 v14, s[8:11], s38 offen offset:3072 lds
    s_add_u32 m0, s40, 28672
    s_add_u32 s38, s38, 20480
    buffer_load_dwordx4 v14, s[8:11], s43 offen lds
    s_waitcnt vmcnt(15)
    s_barrier
    s_add_u32 m0, s40, 49152
    s_add_u32 s43, s38, 4096
    buffer_load_dwordx4 v14, s[8:11], s38 offen offset:0 lds
    buffer_load_dwordx4 v14, s[8:11], s38 offen offset:1024 lds
    buffer_load_dwordx4 v14, s[8:11], s38 offen offset:2048 lds
    buffer_load_dwordx4 v14, s[8:11], s38 offen offset:3072 lds
    s_add_u32 m0, s40, 53248
    s_add_u32 s38, s38, 20480
    buffer_load_dwordx4 v14, s[8:11], s43 offen lds
    s_waitcnt vmcnt(15)
    s_barrier
    s_waitcnt vmcnt(10)
    s_barrier
    s_waitcnt vmcnt(5)
    s_barrier
    s_waitcnt vmcnt(0)
    s_barrier
    s_barrier
    s_endpgm
L_ch1_kernel_cons:
    s_setprio 3
    s_mov_b32 s44, 0
    s_mov_b32 s60, 24576
    v_mov_b32 v15, 1
    v_mov_b32 v13, 0
    s_waitcnt lgkmcnt(0)
    s_add_u32 s52, s28, 0x3000000
    s_addc_u32 s53, s29, 0
    s_mov_b32 s54, 0x10000
    s_mov_b32 s55, 0x00020000
    s_mov_b32 s44, 0
    s_lshr_b32 s42, s35, 1
    s_and_b32 s43, s35, 1
    s_lshl_b32 s46, s66, 1
    s_add_u32 s46, s46, s42
    v_and_b32 v3, 15, v1
    s_lshl_b32 s45, s43, 4
    v_add_u32 v3, s45, v3
    v_lshrrev_b32 v4, 4, v1
    v_lshrrev_b32 v5, 1, v4
    v_lshlrev_b32 v29, 9, v5
    v_and_b32 v5, 1, v4
    v_lshl_add_u32 v29, v5, 3, v29
    v_lshl_add_u32 v29, v3, 4, v29
    v_lshrrev_b32 v5, 1, v4
    v_lshlrev_b32 v28, 9, v5
    v_and_b32 v5, 1, v4
    v_lshl_add_u32 v28, v5, 3, v28
    v_lshl_add_u32 v28, v3, 4, v28
    s_mul_i32 s47, s46, 40960
    s_mul_i32 s48, s67, 5120
    s_add_u32 s47, s47, s48
    s_mul_i32 s48, s46, 40960
    s_mul_i32 s49, s67, 160
    s_add_u32 s48, s48, s49
    s_add_u32 s49, s47, 4096
    v_lshlrev_b32 v7, 6, v3
    v_lshrrev_b32 v5, 2, v1
    v_mul_u32_u24 v5, 160, v5
    v_and_b32 v6, 3, v1
    v_lshl_add_u32 v16, v6, 3, v5
    v_add_u32 v16, s44, v16
    v_lshlrev_b32 v5, 4, v3
    v_lshl_add_u32 v17, v4, 9, v5
    s_mul_i32 s37, s46, 40960
    s_lshl_b32 s50, s46, 11
    s_lshl_b32 s43, s67, 3
    s_add_u32 s50, s50, s43
    s_add_u32 s4, s28, 0xa00000
    s_addc_u32 s5, s29, 0
    s_mov_b32 s6, 0x280000
    s_mov_b32 s7, 0x00020000
    s_add_u32 s12, s28, 0x1200000
    s_addc_u32 s13, s29, 0
    s_mov_b32 s14, 0x280000
    s_mov_b32 s15, 0x00020000
    s_add_u32 s16, s28, 0x5e00000
    s_addc_u32 s17, s29, 0
    s_mov_b32 s18, 0x280000
    s_mov_b32 s19, 0x00020000
    s_add_u32 s56, s28, 0x7000000
    s_addc_u32 s57, s29, 0
    s_mov_b32 s58, 0x20000
    s_mov_b32 s59, 0x00020000
    buffer_load_dwordx2 v[18:19], v29, s[12:15], s47 offen offset:0 sc1
    buffer_load_dwordx2 v[20:21], v29, s[12:15], s47 offen offset:1024 sc1
    buffer_load_dwordx2 v[22:23], v29, s[12:15], s47 offen offset:2048 sc1
    buffer_load_dwordx2 v[24:25], v29, s[12:15], s47 offen offset:3072 sc1
    buffer_load_dwordx2 v[26:27], v29, s[12:15], s49 offen sc1
    buffer_load_dwordx4 v[112:115], v17, s[4:7], s37 offen offset:0 sc1
    buffer_load_dwordx4 v[116:119], v17, s[4:7], s37 offen offset:2048 sc1
    s_add_u32 s37, s37, 4096
    buffer_load_dwordx4 v[120:123], v17, s[4:7], s37 offen offset:0 sc1
    buffer_load_dwordx4 v[124:127], v17, s[4:7], s37 offen offset:2048 sc1
    s_add_u32 s37, s37, 4096
    buffer_load_dwordx4 v[128:131], v17, s[4:7], s37 offen offset:0 sc1
    buffer_load_dwordx4 v[132:135], v17, s[4:7], s37 offen offset:2048 sc1
    s_add_u32 s37, s37, 4096
    buffer_load_dwordx4 v[136:139], v17, s[4:7], s37 offen offset:0 sc1
    buffer_load_dwordx4 v[140:143], v17, s[4:7], s37 offen offset:2048 sc1
    s_add_u32 s37, s37, 4096
    buffer_load_dwordx4 v[144:147], v17, s[4:7], s37 offen offset:0 sc1
    buffer_load_dwordx4 v[148:151], v17, s[4:7], s37 offen offset:2048 sc1
    s_add_u32 s37, s37, 4096
    buffer_load_dwordx4 v[152:155], v17, s[4:7], s37 offen offset:0 sc1
    buffer_load_dwordx4 v[156:159], v17, s[4:7], s37 offen offset:2048 sc1
    s_add_u32 s37, s37, 4096
    buffer_load_dwordx4 v[160:163], v17, s[4:7], s37 offen offset:0 sc1
    buffer_load_dwordx4 v[164:167], v17, s[4:7], s37 offen offset:2048 sc1
    s_add_u32 s37, s37, 4096
    buffer_load_dwordx4 v[168:171], v17, s[4:7], s37 offen offset:0 sc1
    buffer_load_dwordx4 v[172:175], v17, s[4:7], s37 offen offset:2048 sc1
    s_add_u32 s37, s37, 4096
    buffer_load_dwordx4 v[176:179], v17, s[4:7], s37 offen offset:0 sc1
    buffer_load_dwordx4 v[180:183], v17, s[4:7], s37 offen offset:2048 sc1
    s_add_u32 s37, s37, 4096
    buffer_load_dwordx4 v[184:187], v17, s[4:7], s37 offen offset:0 sc1
    buffer_load_dwordx4 v[188:191], v17, s[4:7], s37 offen offset:2048 sc1
    s_add_u32 s37, s37, 4096
    s_waitcnt vmcnt(20)
    v_lshlrev_b32 v72, 16, v18
    v_and_b32 v73, 0xffff0000, v18
    v_lshlrev_b32 v74, 16, v19
    v_and_b32 v75, 0xffff0000, v19
    v_lshlrev_b32 v76, 16, v20
    v_and_b32 v77, 0xffff0000, v20
    v_lshlrev_b32 v78, 16, v21
    v_and_b32 v79, 0xffff0000, v21
    v_lshlrev_b32 v80, 16, v22
    v_and_b32 v81, 0xffff0000, v22
    v_lshlrev_b32 v82, 16, v23
    v_and_b32 v83, 0xffff0000, v23
    v_lshlrev_b32 v84, 16, v24
    v_and_b32 v85, 0xffff0000, v24
    v_lshlrev_b32 v86, 16, v25
    v_and_b32 v87, 0xffff0000, v25
    v_lshlrev_b32 v88, 16, v26
    v_and_b32 v89, 0xffff0000, v26
    v_lshlrev_b32 v90, 16, v27
    v_and_b32 v91, 0xffff0000, v27
    s_barrier
    ds_read_b64_tr_b16 v[32:33], v16 offset:0
    ds_read_b64_tr_b16 v[34:35], v16 offset:2560
    ds_read_b64_tr_b16 v[36:37], v16 offset:32
    ds_read_b64_tr_b16 v[38:39], v16 offset:2592
    ds_read_b64_tr_b16 v[40:41], v16 offset:64
    ds_read_b64_tr_b16 v[42:43], v16 offset:2624
    ds_read_b64_tr_b16 v[44:45], v16 offset:96
    ds_read_b64_tr_b16 v[46:47], v16 offset:2656
    ds_read_b64_tr_b16 v[48:49], v16 offset:128
    ds_read_b64_tr_b16 v[50:51], v16 offset:2688
    s_waitcnt vmcnt(19)
    s_waitcnt lgkmcnt(8)
    v_mfma_f32_16x16x32_bf16 v[72:75], v[32:35], v[112:115], v[72:75]
    ds_read_b64_tr_b16 v[52:53], v16 offset:5120
    ds_read_b64_tr_b16 v[54:55], v16 offset:7680
    s_waitcnt lgkmcnt(8)
    v_mfma_f32_16x16x32_bf16 v[76:79], v[36:39], v[112:115], v[76:79]
    ds_read_b64_tr_b16 v[56:57], v16 offset:5152
    ds_read_b64_tr_b16 v[58:59], v16 offset:7712
    s_waitcnt lgkmcnt(8)
    v_mfma_f32_16x16x32_bf16 v[80:83], v[40:43], v[112:115], v[80:83]
    ds_read_b64_tr_b16 v[60:61], v16 offset:5184
    ds_read_b64_tr_b16 v[62:63], v16 offset:7744
    s_waitcnt lgkmcnt(8)
    v_mfma_f32_16x16x32_bf16 v[84:87], v[44:47], v[112:115], v[84:87]
    ds_read_b64_tr_b16 v[64:65], v16 offset:5216
    ds_read_b64_tr_b16 v[66:67], v16 offset:7776
    s_waitcnt lgkmcnt(8)
    v_mfma_f32_16x16x32_bf16 v[88:91], v[48:51], v[112:115], v[88:91]
    ds_read_b64_tr_b16 v[68:69], v16 offset:5248
    ds_read_b64_tr_b16 v[70:71], v16 offset:7808
    s_waitcnt vmcnt(18)
    s_waitcnt lgkmcnt(8)
    v_mfma_f32_16x16x32_bf16 v[72:75], v[52:55], v[116:119], v[72:75]
    ds_read_b64_tr_b16 v[32:33], v16 offset:10240
    ds_read_b64_tr_b16 v[34:35], v16 offset:12800
    s_waitcnt lgkmcnt(8)
    v_mfma_f32_16x16x32_bf16 v[76:79], v[56:59], v[116:119], v[76:79]
    ds_read_b64_tr_b16 v[36:37], v16 offset:10272
    ds_read_b64_tr_b16 v[38:39], v16 offset:12832
    s_waitcnt lgkmcnt(8)
    v_mfma_f32_16x16x32_bf16 v[80:83], v[60:63], v[116:119], v[80:83]
    ds_read_b64_tr_b16 v[40:41], v16 offset:10304
    ds_read_b64_tr_b16 v[42:43], v16 offset:12864
    s_waitcnt lgkmcnt(8)
    v_mfma_f32_16x16x32_bf16 v[84:87], v[64:67], v[116:119], v[84:87]
    ds_read_b64_tr_b16 v[44:45], v16 offset:10336
    ds_read_b64_tr_b16 v[46:47], v16 offset:12896
    s_waitcnt lgkmcnt(8)
    v_mfma_f32_16x16x32_bf16 v[88:91], v[68:71], v[116:119], v[88:91]
    ds_read_b64_tr_b16 v[48:49], v16 offset:10368
    ds_read_b64_tr_b16 v[50:51], v16 offset:12928
    s_waitcnt vmcnt(17)
    s_waitcnt lgkmcnt(8)
    v_mfma_f32_16x16x32_bf16 v[72:75], v[32:35], v[120:123], v[72:75]
    ds_read_b64_tr_b16 v[52:53], v16 offset:15360
    ds_read_b64_tr_b16 v[54:55], v16 offset:17920
    s_waitcnt lgkmcnt(8)
    v_mfma_f32_16x16x32_bf16 v[76:79], v[36:39], v[120:123], v[76:79]
    ds_read_b64_tr_b16 v[56:57], v16 offset:15392
    ds_read_b64_tr_b16 v[58:59], v16 offset:17952
    s_waitcnt lgkmcnt(8)
    v_mfma_f32_16x16x32_bf16 v[80:83], v[40:43], v[120:123], v[80:83]
    ds_read_b64_tr_b16 v[60:61], v16 offset:15424
    ds_read_b64_tr_b16 v[62:63], v16 offset:17984
    s_waitcnt lgkmcnt(8)
    v_mfma_f32_16x16x32_bf16 v[84:87], v[44:47], v[120:123], v[84:87]
    ds_read_b64_tr_b16 v[64:65], v16 offset:15456
    ds_read_b64_tr_b16 v[66:67], v16 offset:18016
    s_waitcnt lgkmcnt(8)
    v_mfma_f32_16x16x32_bf16 v[88:91], v[48:51], v[120:123], v[88:91]
    ds_read_b64_tr_b16 v[68:69], v16 offset:15488
    ds_read_b64_tr_b16 v[70:71], v16 offset:18048
    s_barrier
    s_add_u32 s60, s44, 24576
    s_cmp_gt_u32 s60, 122880
    s_cselect_b32 s60, 0, s60
    s_sub_u32 s45, s60, s44
    s_mov_b32 s44, s60
    v_add_u32 v16, s45, v16
    s_waitcnt vmcnt(16)
    s_waitcnt lgkmcnt(8)
    v_mfma_f32_16x16x32_bf16 v[72:75], v[52:55], v[124:127], v[72:75]
    ds_read_b64_tr_b16 v[32:33], v16 offset:0
    ds_read_b64_tr_b16 v[34:35], v16 offset:2560
    s_waitcnt lgkmcnt(8)
    v_mfma_f32_16x16x32_bf16 v[76:79], v[56:59], v[124:127], v[76:79]
    ds_read_b64_tr_b16 v[36:37], v16 offset:32
    ds_read_b64_tr_b16 v[38:39], v16 offset:2592
    s_waitcnt lgkmcnt(8)
    v_mfma_f32_16x16x32_bf16 v[80:83], v[60:63], v[124:127], v[80:83]
    ds_read_b64_tr_b16 v[40:41], v16 offset:64
    ds_read_b64_tr_b16 v[42:43], v16 offset:2624
    s_waitcnt lgkmcnt(8)
    v_mfma_f32_16x16x32_bf16 v[84:87], v[64:67], v[124:127], v[84:87]
    ds_read_b64_tr_b16 v[44:45], v16 offset:96
    ds_read_b64_tr_b16 v[46:47], v16 offset:2656
    s_waitcnt lgkmcnt(8)
    v_mfma_f32_16x16x32_bf16 v[88:91], v[68:71], v[124:127], v[88:91]
    ds_read_b64_tr_b16 v[48:49], v16 offset:128
    ds_read_b64_tr_b16 v[50:51], v16 offset:2688
    s_waitcnt vmcnt(15)
    s_waitcnt lgkmcnt(8)
    v_mfma_f32_16x16x32_bf16 v[72:75], v[32:35], v[128:131], v[72:75]
    ds_read_b64_tr_b16 v[52:53], v16 offset:5120
    ds_read_b64_tr_b16 v[54:55], v16 offset:7680
    s_waitcnt lgkmcnt(8)
    v_mfma_f32_16x16x32_bf16 v[76:79], v[36:39], v[128:131], v[76:79]
    ds_read_b64_tr_b16 v[56:57], v16 offset:5152
    ds_read_b64_tr_b16 v[58:59], v16 offset:7712
    s_waitcnt lgkmcnt(8)
    v_mfma_f32_16x16x32_bf16 v[80:83], v[40:43], v[128:131], v[80:83]
    ds_read_b64_tr_b16 v[60:61], v16 offset:5184
    ds_read_b64_tr_b16 v[62:63], v16 offset:7744
    s_waitcnt lgkmcnt(8)
    v_mfma_f32_16x16x32_bf16 v[84:87], v[44:47], v[128:131], v[84:87]
    ds_read_b64_tr_b16 v[64:65], v16 offset:5216
    ds_read_b64_tr_b16 v[66:67], v16 offset:7776
    s_waitcnt lgkmcnt(8)
    v_mfma_f32_16x16x32_bf16 v[88:91], v[48:51], v[128:131], v[88:91]
    ds_read_b64_tr_b16 v[68:69], v16 offset:5248
    ds_read_b64_tr_b16 v[70:71], v16 offset:7808
    s_waitcnt vmcnt(14)
    s_waitcnt lgkmcnt(8)
    v_mfma_f32_16x16x32_bf16 v[72:75], v[52:55], v[132:135], v[72:75]
    ds_read_b64_tr_b16 v[32:33], v16 offset:10240
    ds_read_b64_tr_b16 v[34:35], v16 offset:12800
    s_waitcnt lgkmcnt(8)
    v_mfma_f32_16x16x32_bf16 v[76:79], v[56:59], v[132:135], v[76:79]
    ds_read_b64_tr_b16 v[36:37], v16 offset:10272
    ds_read_b64_tr_b16 v[38:39], v16 offset:12832
    s_waitcnt lgkmcnt(8)
    v_mfma_f32_16x16x32_bf16 v[80:83], v[60:63], v[132:135], v[80:83]
    ds_read_b64_tr_b16 v[40:41], v16 offset:10304
    ds_read_b64_tr_b16 v[42:43], v16 offset:12864
    s_waitcnt lgkmcnt(8)
    v_mfma_f32_16x16x32_bf16 v[84:87], v[64:67], v[132:135], v[84:87]
    ds_read_b64_tr_b16 v[44:45], v16 offset:10336
    ds_read_b64_tr_b16 v[46:47], v16 offset:12896
    s_waitcnt lgkmcnt(8)
    v_mfma_f32_16x16x32_bf16 v[88:91], v[68:71], v[132:135], v[88:91]
    ds_read_b64_tr_b16 v[48:49], v16 offset:10368
    ds_read_b64_tr_b16 v[50:51], v16 offset:12928
    s_waitcnt vmcnt(13)
    s_waitcnt lgkmcnt(8)
    v_mfma_f32_16x16x32_bf16 v[72:75], v[32:35], v[136:139], v[72:75]
    ds_read_b64_tr_b16 v[52:53], v16 offset:15360
    ds_read_b64_tr_b16 v[54:55], v16 offset:17920
    s_waitcnt lgkmcnt(8)
    v_mfma_f32_16x16x32_bf16 v[76:79], v[36:39], v[136:139], v[76:79]
    ds_read_b64_tr_b16 v[56:57], v16 offset:15392
    ds_read_b64_tr_b16 v[58:59], v16 offset:17952
    s_waitcnt lgkmcnt(8)
    v_mfma_f32_16x16x32_bf16 v[80:83], v[40:43], v[136:139], v[80:83]
    ds_read_b64_tr_b16 v[60:61], v16 offset:15424
    ds_read_b64_tr_b16 v[62:63], v16 offset:17984
    s_waitcnt lgkmcnt(8)
    v_mfma_f32_16x16x32_bf16 v[84:87], v[44:47], v[136:139], v[84:87]
    ds_read_b64_tr_b16 v[64:65], v16 offset:15456
    ds_read_b64_tr_b16 v[66:67], v16 offset:18016
    s_waitcnt lgkmcnt(8)
    v_mfma_f32_16x16x32_bf16 v[88:91], v[48:51], v[136:139], v[88:91]
    ds_read_b64_tr_b16 v[68:69], v16 offset:15488
    ds_read_b64_tr_b16 v[70:71], v16 offset:18048
    s_barrier
    s_add_u32 s60, s44, 24576
    s_cmp_gt_u32 s60, 122880
    s_cselect_b32 s60, 0, s60
    s_sub_u32 s45, s60, s44
    s_mov_b32 s44, s60
    v_add_u32 v16, s45, v16
    s_waitcnt vmcnt(12)
    s_waitcnt lgkmcnt(8)
    v_mfma_f32_16x16x32_bf16 v[72:75], v[52:55], v[140:143], v[72:75]
    ds_read_b64_tr_b16 v[32:33], v16 offset:0
    ds_read_b64_tr_b16 v[34:35], v16 offset:2560
    s_waitcnt lgkmcnt(8)
    v_mfma_f32_16x16x32_bf16 v[76:79], v[56:59], v[140:143], v[76:79]
    ds_read_b64_tr_b16 v[36:37], v16 offset:32
    ds_read_b64_tr_b16 v[38:39], v16 offset:2592
    s_waitcnt lgkmcnt(8)
    v_mfma_f32_16x16x32_bf16 v[80:83], v[60:63], v[140:143], v[80:83]
    ds_read_b64_tr_b16 v[40:41], v16 offset:64
    ds_read_b64_tr_b16 v[42:43], v16 offset:2624
    s_waitcnt lgkmcnt(8)
    v_mfma_f32_16x16x32_bf16 v[84:87], v[64:67], v[140:143], v[84:87]
    ds_read_b64_tr_b16 v[44:45], v16 offset:96
    ds_read_b64_tr_b16 v[46:47], v16 offset:2656
    s_waitcnt lgkmcnt(8)
    v_mfma_f32_16x16x32_bf16 v[88:91], v[68:71], v[140:143], v[88:91]
    ds_read_b64_tr_b16 v[48:49], v16 offset:128
    ds_read_b64_tr_b16 v[50:51], v16 offset:2688
    s_waitcnt vmcnt(11)
    s_waitcnt lgkmcnt(8)
    v_mfma_f32_16x16x32_bf16 v[72:75], v[32:35], v[144:147], v[72:75]
    ds_read_b64_tr_b16 v[52:53], v16 offset:5120
    ds_read_b64_tr_b16 v[54:55], v16 offset:7680
    s_waitcnt lgkmcnt(8)
    v_mfma_f32_16x16x32_bf16 v[76:79], v[36:39], v[144:147], v[76:79]
    ds_read_b64_tr_b16 v[56:57], v16 offset:5152
    ds_read_b64_tr_b16 v[58:59], v16 offset:7712
    s_waitcnt lgkmcnt(8)
    v_mfma_f32_16x16x32_bf16 v[80:83], v[40:43], v[144:147], v[80:83]
    ds_read_b64_tr_b16 v[60:61], v16 offset:5184
    ds_read_b64_tr_b16 v[62:63], v16 offset:7744
    s_waitcnt lgkmcnt(8)
    v_mfma_f32_16x16x32_bf16 v[84:87], v[44:47], v[144:147], v[84:87]
    ds_read_b64_tr_b16 v[64:65], v16 offset:5216
    ds_read_b64_tr_b16 v[66:67], v16 offset:7776
    s_waitcnt lgkmcnt(8)
    v_mfma_f32_16x16x32_bf16 v[88:91], v[48:51], v[144:147], v[88:91]
    ds_read_b64_tr_b16 v[68:69], v16 offset:5248
    ds_read_b64_tr_b16 v[70:71], v16 offset:7808
    s_waitcnt vmcnt(10)
    s_waitcnt lgkmcnt(8)
    v_mfma_f32_16x16x32_bf16 v[72:75], v[52:55], v[148:151], v[72:75]
    ds_read_b64_tr_b16 v[32:33], v16 offset:10240
    ds_read_b64_tr_b16 v[34:35], v16 offset:12800
    s_waitcnt lgkmcnt(8)
    v_mfma_f32_16x16x32_bf16 v[76:79], v[56:59], v[148:151], v[76:79]
    ds_read_b64_tr_b16 v[36:37], v16 offset:10272
    ds_read_b64_tr_b16 v[38:39], v16 offset:12832
    s_waitcnt lgkmcnt(8)
    v_mfma_f32_16x16x32_bf16 v[80:83], v[60:63], v[148:151], v[80:83]
    ds_read_b64_tr_b16 v[40:41], v16 offset:10304
    ds_read_b64_tr_b16 v[42:43], v16 offset:12864
    s_waitcnt lgkmcnt(8)
    v_mfma_f32_16x16x32_bf16 v[84:87], v[64:67], v[148:151], v[84:87]
    ds_read_b64_tr_b16 v[44:45], v16 offset:10336
    ds_read_b64_tr_b16 v[46:47], v16 offset:12896
    s_waitcnt lgkmcnt(8)
    v_mfma_f32_16x16x32_bf16 v[88:91], v[68:71], v[148:151], v[88:91]
    ds_read_b64_tr_b16 v[48:49], v16 offset:10368
    ds_read_b64_tr_b16 v[50:51], v16 offset:12928
    s_waitcnt vmcnt(9)
    s_waitcnt lgkmcnt(8)
    v_mfma_f32_16x16x32_bf16 v[72:75], v[32:35], v[152:155], v[72:75]
    ds_read_b64_tr_b16 v[52:53], v16 offset:15360
    ds_read_b64_tr_b16 v[54:55], v16 offset:17920
    s_waitcnt lgkmcnt(8)
    v_mfma_f32_16x16x32_bf16 v[76:79], v[36:39], v[152:155], v[76:79]
    ds_read_b64_tr_b16 v[56:57], v16 offset:15392
    ds_read_b64_tr_b16 v[58:59], v16 offset:17952
    s_waitcnt lgkmcnt(8)
    v_mfma_f32_16x16x32_bf16 v[80:83], v[40:43], v[152:155], v[80:83]
    ds_read_b64_tr_b16 v[60:61], v16 offset:15424
    ds_read_b64_tr_b16 v[62:63], v16 offset:17984
    s_waitcnt lgkmcnt(8)
    v_mfma_f32_16x16x32_bf16 v[84:87], v[44:47], v[152:155], v[84:87]
    ds_read_b64_tr_b16 v[64:65], v16 offset:15456
    ds_read_b64_tr_b16 v[66:67], v16 offset:18016
    s_waitcnt lgkmcnt(8)
    v_mfma_f32_16x16x32_bf16 v[88:91], v[48:51], v[152:155], v[88:91]
    ds_read_b64_tr_b16 v[68:69], v16 offset:15488
    ds_read_b64_tr_b16 v[70:71], v16 offset:18048
    s_barrier
    s_add_u32 s60, s44, 24576
    s_cmp_gt_u32 s60, 122880
    s_cselect_b32 s60, 0, s60
    s_sub_u32 s45, s60, s44
    s_mov_b32 s44, s60
    v_add_u32 v16, s45, v16
    s_waitcnt vmcnt(8)
    s_waitcnt lgkmcnt(8)
    v_mfma_f32_16x16x32_bf16 v[72:75], v[52:55], v[156:159], v[72:75]
    ds_read_b64_tr_b16 v[32:33], v16 offset:0
    ds_read_b64_tr_b16 v[34:35], v16 offset:2560
    s_waitcnt lgkmcnt(8)
    v_mfma_f32_16x16x32_bf16 v[76:79], v[56:59], v[156:159], v[76:79]
    ds_read_b64_tr_b16 v[36:37], v16 offset:32
    ds_read_b64_tr_b16 v[38:39], v16 offset:2592
    s_waitcnt lgkmcnt(8)
    v_mfma_f32_16x16x32_bf16 v[80:83], v[60:63], v[156:159], v[80:83]
    ds_read_b64_tr_b16 v[40:41], v16 offset:64
    ds_read_b64_tr_b16 v[42:43], v16 offset:2624
    s_waitcnt lgkmcnt(8)
    v_mfma_f32_16x16x32_bf16 v[84:87], v[64:67], v[156:159], v[84:87]
    ds_read_b64_tr_b16 v[44:45], v16 offset:96
    ds_read_b64_tr_b16 v[46:47], v16 offset:2656
    s_waitcnt lgkmcnt(8)
    v_mfma_f32_16x16x32_bf16 v[88:91], v[68:71], v[156:159], v[88:91]
    ds_read_b64_tr_b16 v[48:49], v16 offset:128
    ds_read_b64_tr_b16 v[50:51], v16 offset:2688
    s_waitcnt vmcnt(7)
    s_waitcnt lgkmcnt(8)
    v_mfma_f32_16x16x32_bf16 v[72:75], v[32:35], v[160:163], v[72:75]
    ds_read_b64_tr_b16 v[52:53], v16 offset:5120
    ds_read_b64_tr_b16 v[54:55], v16 offset:7680
    s_waitcnt lgkmcnt(8)
    v_mfma_f32_16x16x32_bf16 v[76:79], v[36:39], v[160:163], v[76:79]
    ds_read_b64_tr_b16 v[56:57], v16 offset:5152
    ds_read_b64_tr_b16 v[58:59], v16 offset:7712
    s_waitcnt lgkmcnt(8)
    v_mfma_f32_16x16x32_bf16 v[80:83], v[40:43], v[160:163], v[80:83]
    ds_read_b64_tr_b16 v[60:61], v16 offset:5184
    ds_read_b64_tr_b16 v[62:63], v16 offset:7744
    s_waitcnt lgkmcnt(8)
    v_mfma_f32_16x16x32_bf16 v[84:87], v[44:47], v[160:163], v[84:87]
    ds_read_b64_tr_b16 v[64:65], v16 offset:5216
    ds_read_b64_tr_b16 v[66:67], v16 offset:7776
    s_waitcnt lgkmcnt(8)
    v_mfma_f32_16x16x32_bf16 v[88:91], v[48:51], v[160:163], v[88:91]
    ds_read_b64_tr_b16 v[68:69], v16 offset:5248
    ds_read_b64_tr_b16 v[70:71], v16 offset:7808
    s_waitcnt vmcnt(6)
    s_waitcnt lgkmcnt(8)
    v_mfma_f32_16x16x32_bf16 v[72:75], v[52:55], v[164:167], v[72:75]
    ds_read_b64_tr_b16 v[32:33], v16 offset:10240
    ds_read_b64_tr_b16 v[34:35], v16 offset:12800
    s_waitcnt lgkmcnt(8)
    v_mfma_f32_16x16x32_bf16 v[76:79], v[56:59], v[164:167], v[76:79]
    ds_read_b64_tr_b16 v[36:37], v16 offset:10272
    ds_read_b64_tr_b16 v[38:39], v16 offset:12832
    s_waitcnt lgkmcnt(8)
    v_mfma_f32_16x16x32_bf16 v[80:83], v[60:63], v[164:167], v[80:83]
    ds_read_b64_tr_b16 v[40:41], v16 offset:10304
    ds_read_b64_tr_b16 v[42:43], v16 offset:12864
    s_waitcnt lgkmcnt(8)
    v_mfma_f32_16x16x32_bf16 v[84:87], v[64:67], v[164:167], v[84:87]
    ds_read_b64_tr_b16 v[44:45], v16 offset:10336
    ds_read_b64_tr_b16 v[46:47], v16 offset:12896
    s_waitcnt lgkmcnt(8)
    v_mfma_f32_16x16x32_bf16 v[88:91], v[68:71], v[164:167], v[88:91]
    ds_read_b64_tr_b16 v[48:49], v16 offset:10368
    ds_read_b64_tr_b16 v[50:51], v16 offset:12928
    s_waitcnt vmcnt(5)
    s_waitcnt lgkmcnt(8)
    v_mfma_f32_16x16x32_bf16 v[72:75], v[32:35], v[168:171], v[72:75]
    ds_read_b64_tr_b16 v[52:53], v16 offset:15360
    ds_read_b64_tr_b16 v[54:55], v16 offset:17920
    s_waitcnt lgkmcnt(8)
    v_mfma_f32_16x16x32_bf16 v[76:79], v[36:39], v[168:171], v[76:79]
    ds_read_b64_tr_b16 v[56:57], v16 offset:15392
    ds_read_b64_tr_b16 v[58:59], v16 offset:17952
    s_waitcnt lgkmcnt(8)
    v_mfma_f32_16x16x32_bf16 v[80:83], v[40:43], v[168:171], v[80:83]
    ds_read_b64_tr_b16 v[60:61], v16 offset:15424
    ds_read_b64_tr_b16 v[62:63], v16 offset:17984
    s_waitcnt lgkmcnt(8)
    v_mfma_f32_16x16x32_bf16 v[84:87], v[44:47], v[168:171], v[84:87]
    ds_read_b64_tr_b16 v[64:65], v16 offset:15456
    ds_read_b64_tr_b16 v[66:67], v16 offset:18016
    s_waitcnt lgkmcnt(8)
    v_mfma_f32_16x16x32_bf16 v[88:91], v[48:51], v[168:171], v[88:91]
    ds_read_b64_tr_b16 v[68:69], v16 offset:15488
    ds_read_b64_tr_b16 v[70:71], v16 offset:18048
    s_barrier
    s_add_u32 s60, s44, 24576
    s_cmp_gt_u32 s60, 122880
    s_cselect_b32 s60, 0, s60
    s_sub_u32 s45, s60, s44
    s_mov_b32 s44, s60
    v_add_u32 v16, s45, v16
    s_waitcnt vmcnt(4)
    s_waitcnt lgkmcnt(8)
    v_mfma_f32_16x16x32_bf16 v[72:75], v[52:55], v[172:175], v[72:75]
    ds_read_b64_tr_b16 v[32:33], v16 offset:0
    ds_read_b64_tr_b16 v[34:35], v16 offset:2560
    s_waitcnt lgkmcnt(8)
    v_mfma_f32_16x16x32_bf16 v[76:79], v[56:59], v[172:175], v[76:79]
    ds_read_b64_tr_b16 v[36:37], v16 offset:32
    ds_read_b64_tr_b16 v[38:39], v16 offset:2592
    s_waitcnt lgkmcnt(8)
    v_mfma_f32_16x16x32_bf16 v[80:83], v[60:63], v[172:175], v[80:83]
    ds_read_b64_tr_b16 v[40:41], v16 offset:64
    ds_read_b64_tr_b16 v[42:43], v16 offset:2624
    s_waitcnt lgkmcnt(8)
    v_mfma_f32_16x16x32_bf16 v[84:87], v[64:67], v[172:175], v[84:87]
    ds_read_b64_tr_b16 v[44:45], v16 offset:96
    ds_read_b64_tr_b16 v[46:47], v16 offset:2656
    s_waitcnt lgkmcnt(8)
    v_mfma_f32_16x16x32_bf16 v[88:91], v[68:71], v[172:175], v[88:91]
    ds_read_b64_tr_b16 v[48:49], v16 offset:128
    ds_read_b64_tr_b16 v[50:51], v16 offset:2688
    s_waitcnt vmcnt(3)
    s_waitcnt lgkmcnt(8)
    v_mfma_f32_16x16x32_bf16 v[72:75], v[32:35], v[176:179], v[72:75]
    ds_read_b64_tr_b16 v[52:53], v16 offset:5120
    ds_read_b64_tr_b16 v[54:55], v16 offset:7680
    s_waitcnt lgkmcnt(8)
    v_mfma_f32_16x16x32_bf16 v[76:79], v[36:39], v[176:179], v[76:79]
    ds_read_b64_tr_b16 v[56:57], v16 offset:5152
    ds_read_b64_tr_b16 v[58:59], v16 offset:7712
    s_waitcnt lgkmcnt(8)
    v_mfma_f32_16x16x32_bf16 v[80:83], v[40:43], v[176:179], v[80:83]
    ds_read_b64_tr_b16 v[60:61], v16 offset:5184
    ds_read_b64_tr_b16 v[62:63], v16 offset:7744
    s_waitcnt lgkmcnt(8)
    v_mfma_f32_16x16x32_bf16 v[84:87], v[44:47], v[176:179], v[84:87]
    ds_read_b64_tr_b16 v[64:65], v16 offset:5216
    ds_read_b64_tr_b16 v[66:67], v16 offset:7776
    s_waitcnt lgkmcnt(8)
    v_mfma_f32_16x16x32_bf16 v[88:91], v[48:51], v[176:179], v[88:91]
    ds_read_b64_tr_b16 v[68:69], v16 offset:5248
    ds_read_b64_tr_b16 v[70:71], v16 offset:7808
    s_waitcnt vmcnt(2)
    s_waitcnt lgkmcnt(8)
    v_mfma_f32_16x16x32_bf16 v[72:75], v[52:55], v[180:183], v[72:75]
    ds_read_b64_tr_b16 v[32:33], v16 offset:10240
    ds_read_b64_tr_b16 v[34:35], v16 offset:12800
    s_waitcnt lgkmcnt(8)
    v_mfma_f32_16x16x32_bf16 v[76:79], v[56:59], v[180:183], v[76:79]
    ds_read_b64_tr_b16 v[36:37], v16 offset:10272
    ds_read_b64_tr_b16 v[38:39], v16 offset:12832
    s_waitcnt lgkmcnt(8)
    v_mfma_f32_16x16x32_bf16 v[80:83], v[60:63], v[180:183], v[80:83]
    ds_read_b64_tr_b16 v[40:41], v16 offset:10304
    ds_read_b64_tr_b16 v[42:43], v16 offset:12864
    s_waitcnt lgkmcnt(8)
    v_mfma_f32_16x16x32_bf16 v[84:87], v[64:67], v[180:183], v[84:87]
    ds_read_b64_tr_b16 v[44:45], v16 offset:10336
    ds_read_b64_tr_b16 v[46:47], v16 offset:12896
    s_waitcnt lgkmcnt(8)
    v_mfma_f32_16x16x32_bf16 v[88:91], v[68:71], v[180:183], v[88:91]
    ds_read_b64_tr_b16 v[48:49], v16 offset:10368
    ds_read_b64_tr_b16 v[50:51], v16 offset:12928
    s_waitcnt vmcnt(1)
    s_waitcnt lgkmcnt(8)
    v_mfma_f32_16x16x32_bf16 v[72:75], v[32:35], v[184:187], v[72:75]
    ds_read_b64_tr_b16 v[52:53], v16 offset:15360
    ds_read_b64_tr_b16 v[54:55], v16 offset:17920
    s_waitcnt lgkmcnt(8)
    v_mfma_f32_16x16x32_bf16 v[76:79], v[36:39], v[184:187], v[76:79]
    ds_read_b64_tr_b16 v[56:57], v16 offset:15392
    ds_read_b64_tr_b16 v[58:59], v16 offset:17952
    s_waitcnt lgkmcnt(8)
    v_mfma_f32_16x16x32_bf16 v[80:83], v[40:43], v[184:187], v[80:83]
    ds_read_b64_tr_b16 v[60:61], v16 offset:15424
    ds_read_b64_tr_b16 v[62:63], v16 offset:17984
    s_waitcnt lgkmcnt(8)
    v_mfma_f32_16x16x32_bf16 v[84:87], v[44:47], v[184:187], v[84:87]
    ds_read_b64_tr_b16 v[64:65], v16 offset:15456
    ds_read_b64_tr_b16 v[66:67], v16 offset:18016
    s_waitcnt lgkmcnt(8)
    v_mfma_f32_16x16x32_bf16 v[88:91], v[48:51], v[184:187], v[88:91]
    ds_read_b64_tr_b16 v[68:69], v16 offset:15488
    ds_read_b64_tr_b16 v[70:71], v16 offset:18048
    s_barrier
    s_add_u32 s60, s44, 24576
    s_cmp_gt_u32 s60, 122880
    s_cselect_b32 s60, 0, s60
    s_sub_u32 s45, s60, s44
    s_mov_b32 s44, s60
    v_add_u32 v16, s45, v16
    s_waitcnt vmcnt(0)
    s_waitcnt lgkmcnt(8)
    v_mfma_f32_16x16x32_bf16 v[72:75], v[52:55], v[188:191], v[72:75]
    s_waitcnt lgkmcnt(6)
    v_mfma_f32_16x16x32_bf16 v[76:79], v[56:59], v[188:191], v[76:79]
    s_waitcnt lgkmcnt(4)
    v_mfma_f32_16x16x32_bf16 v[80:83], v[60:63], v[188:191], v[80:83]
    s_waitcnt lgkmcnt(2)
    v_mfma_f32_16x16x32_bf16 v[84:87], v[64:67], v[188:191], v[84:87]
    s_waitcnt lgkmcnt(0)
    v_mfma_f32_16x16x32_bf16 v[88:91], v[68:71], v[188:191], v[88:91]
    s_waitcnt  lgkmcnt(0)
    s_nop 7
    v_cvt_pk_bf16_f32 v92, v72, v73
    v_cvt_pk_bf16_f32 v93, v74, v75
    buffer_store_dwordx2 v[92:93], v28, s[16:19], s47 offen offset:0 sc1
    v_cvt_pk_bf16_f32 v94, v76, v77
    v_cvt_pk_bf16_f32 v95, v78, v79
    buffer_store_dwordx2 v[94:95], v28, s[16:19], s47 offen offset:1024 sc1
    v_cvt_pk_bf16_f32 v96, v80, v81
    v_cvt_pk_bf16_f32 v97, v82, v83
    buffer_store_dwordx2 v[96:97], v28, s[16:19], s47 offen offset:2048 sc1
    v_cvt_pk_bf16_f32 v98, v84, v85
    v_cvt_pk_bf16_f32 v99, v86, v87
    buffer_store_dwordx2 v[98:99], v28, s[16:19], s47 offen offset:3072 sc1
    v_cvt_pk_bf16_f32 v100, v88, v89
    v_cvt_pk_bf16_f32 v101, v90, v91
    buffer_store_dwordx2 v[100:101], v28, s[16:19], s49 offen sc1
    v_lshlrev_b32 v72, 16, v92
    v_and_b32 v73, 0xffff0000, v92
    v_lshlrev_b32 v74, 16, v93
    v_and_b32 v75, 0xffff0000, v93
    v_pk_add_f32 v[32:33], v[72:73], v[74:75]
    v_pk_mul_f32 v[34:35], v[72:73], v[72:73]
    v_pk_fma_f32 v[34:35], v[74:75], v[74:75], v[34:35]
    v_lshlrev_b32 v76, 16, v94
    v_and_b32 v77, 0xffff0000, v94
    v_lshlrev_b32 v78, 16, v95
    v_and_b32 v79, 0xffff0000, v95
    v_pk_add_f32 v[32:33], v[32:33], v[76:77]
    v_pk_fma_f32 v[34:35], v[76:77], v[76:77], v[34:35]
    v_pk_add_f32 v[32:33], v[32:33], v[78:79]
    v_pk_fma_f32 v[34:35], v[78:79], v[78:79], v[34:35]
    v_lshlrev_b32 v80, 16, v96
    v_and_b32 v81, 0xffff0000, v96
    v_lshlrev_b32 v82, 16, v97
    v_and_b32 v83, 0xffff0000, v97
    v_pk_add_f32 v[32:33], v[32:33], v[80:81]
    v_pk_fma_f32 v[34:35], v[80:81], v[80:81], v[34:35]
    v_pk_add_f32 v[32:33], v[32:33], v[82:83]
    v_pk_fma_f32 v[34:35], v[82:83], v[82:83], v[34:35]
    v_lshlrev_b32 v84, 16, v98
    v_and_b32 v85, 0xffff0000, v98
    v_lshlrev_b32 v86, 16, v99
    v_and_b32 v87, 0xffff0000, v99
    v_pk_add_f32 v[32:33], v[32:33], v[84:85]
    v_pk_fma_f32 v[34:35], v[84:85], v[84:85], v[34:35]
    v_pk_add_f32 v[32:33], v[32:33], v[86:87]
    v_pk_fma_f32 v[34:35], v[86:87], v[86:87], v[34:35]
    v_lshlrev_b32 v88, 16, v100
    v_and_b32 v89, 0xffff0000, v100
    v_lshlrev_b32 v90, 16, v101
    v_and_b32 v91, 0xffff0000, v101
    v_pk_add_f32 v[32:33], v[32:33], v[88:89]
    v_pk_fma_f32 v[34:35], v[88:89], v[88:89], v[34:35]
    v_pk_add_f32 v[32:33], v[32:33], v[90:91]
    v_pk_fma_f32 v[34:35], v[90:91], v[90:91], v[34:35]
    v_add_f32 v32, v32, v33
    v_add_f32 v33, v34, v35
    v_mov_b32 v34, v32
    v_mov_b32 v35, v33
    s_nop 1
    v_permlane16_swap_b32 v32, v34
    v_permlane16_swap_b32 v33, v35
    s_nop 1
    v_add_f32 v32, v32, v34
    v_add_f32 v33, v33, v35
    v_mov_b32 v34, v32
    v_mov_b32 v35, v33
    s_nop 1
    v_permlane32_swap_b32 v32, v34
    v_permlane32_swap_b32 v33, v35
    s_nop 1
    v_add_f32 v32, v32, v34
    v_add_f32 v33, v33, v35
    s_mov_b64 exec, 0xffff
    buffer_store_dwordx2 v[32:33], v7, s[56:59], s50 offen sc1
    s_mov_b64 exec, -1
    s_and_b32 s61, s35, 1
    s_lshl_b32 s43, s67, 1
    s_add_u32 s61, s61, s43
    s_lshl_b32 s62, s46, 7
    s_add_u32 s62, s62, 32768
    s_waitcnt vmcnt(0)
    s_mov_b64 exec, 1
    buffer_atomic_add v15, v13, s[52:55], s62 offen sc1
    s_mov_b64 exec, -1
    s_mov_b32 s44, 122880
    s_lshl_b32 s42, s68, 2
    s_add_u32 s42, s42, s35
    v_and_b32 v3, 31, v1
    v_lshlrev_b32 v3, 6, v3
    v_and_b32 v4, 32, v1
    v_add_u32 v16, v3, v4
    s_add_u32 s56, s28, 0x2080000
    s_addc_u32 s57, s29, 0
    s_mov_b32 s58, 0x5000
    s_mov_b32 s59, 0x00020000
    s_lshl_b32 s63, s35, 10
    s_add_u32 m0, s63, 147456
    s_mul_i32 s62, s69, 768
    s_add_u32 s62, s62, 8192
    buffer_load_dwordx4 v14, s[56:59], s62 offen lds
    v_lshrrev_b32 v3, 2, v1
    v_and_b32 v3, 3, v3
    v_lshrrev_b32 v5, 5, v1
    v_lshl_add_u32 v3, v5, 3, v3
    v_mul_u32_u24 v3, 192, v3
    v_and_b32 v4, 3, v1
    v_lshl_add_u32 v3, v4, 3, v3
    v_and_b32 v5, 16, v1
    v_lshl_add_u32 v18, v5, 1, v3
    v_add_u32 v18, s44, v18
    s_add_u32 s4, s28, 0x5e00000
    s_addc_u32 s5, s29, 0
    s_mov_b32 s6, 0x280000
    s_mov_b32 s7, 0x00020000
    s_add_u32 s12, s28, 0x7000000
    s_addc_u32 s13, s29, 0
    s_mov_b32 s14, 0x20000
    s_mov_b32 s15, 0x00020000
    s_add_u32 s16, s28, 0x6600000
    s_addc_u32 s17, s29, 0
    s_mov_b32 s18, 0x600000
    s_mov_b32 s19, 0x00020000
    s_mul_i32 s48, s42, 98304
    s_mul_i32 s47, s69, 6144
    s_add_u32 s48, s48, s47
    s_add_u32 s47, s48, 4096
    s_waitcnt vmcnt(0)
    s_lshl_b32 s63, s35, 10
    s_add_u32 s63, s63, 147456
    v_lshrrev_b32 v6, 5, v1
    v_lshlrev_b32 v6, 4, v6
    v_add_u32 v6, s63, v6
    ds_read_b128 v[88:91], v6 offset:0
    ds_read_b128 v[92:95], v6 offset:32
    ds_read_b128 v[96:99], v6 offset:64
    ds_read_b128 v[100:103], v6 offset:96
    ds_read_b128 v[104:107], v6 offset:128
    ds_read_b128 v[108:111], v6 offset:160
    ds_read_b128 v[112:115], v6 offset:192
    ds_read_b128 v[116:119], v6 offset:224
    ds_read_b128 v[120:123], v6 offset:256
    ds_read_b128 v[124:127], v6 offset:288
    ds_read_b128 v[128:131], v6 offset:320
    ds_read_b128 v[132:135], v6 offset:352
    s_waitcnt lgkmcnt(0)
    ds_read_b128 v[136:139], v6 offset:384
    ds_read_b128 v[140:143], v6 offset:416
    ds_read_b128 v[144:147], v6 offset:448
    ds_read_b128 v[148:151], v6 offset:480
    ds_read_b128 v[152:155], v6 offset:512
    ds_read_b128 v[156:159], v6 offset:544
    ds_read_b128 v[160:163], v6 offset:576
    ds_read_b128 v[164:167], v6 offset:608
    ds_read_b128 v[168:171], v6 offset:640
    ds_read_b128 v[172:175], v6 offset:672
    ds_read_b128 v[176:179], v6 offset:704
    ds_read_b128 v[180:183], v6 offset:736
    s_waitcnt lgkmcnt(0)
    s_waitcnt lgkmcnt(0)
    s_lshl_b32 s62, s42, 7
    s_add_u32 s62, s62, 32768
    s_mov_b32 s63, 0
L_ch1_kernel_poll_1:
    buffer_load_dword v12, v13, s[52:55], s62 offen sc1
    s_waitcnt vmcnt(0)
    v_readfirstlane_b32 s61, v12
    s_add_u32 s63, s63, 1
    s_cmp_ge_u32 s61, 16
    s_cbranch_scc1 L_ch1_kernel_go_2
    s_cmp_ge_u32 s63, 0x400000
    s_cbranch_scc1 L_ch1_kernel_go_2
    s_sleep 1
    s_branch L_ch1_kernel_poll_1
L_ch1_kernel_go_2:
    s_lshl_b32 s62, s42, 11
    buffer_load_dwordx4 v[184:187], v16, s[12:15], s62 offen sc1
    buffer_load_dwordx4 v[188:191], v16, s[12:15], s62 offen offset:16 sc1
    s_mul_i32 s37, s42, 40960
    buffer_load_dwordx4 v[192:195], v14, s[4:7], s37 offen offset:0 sc1
    buffer_load_dwordx4 v[196:199], v14, s[4:7], s37 offen offset:1024 sc1
    s_add_u32 s37, s37, 2048
    buffer_load_dwordx4 v[200:203], v14, s[4:7], s37 offen offset:0 sc1
    buffer_load_dwordx4 v[204:207], v14, s[4:7], s37 offen offset:1024 sc1
    s_add_u32 s37, s37, 2048
    buffer_load_dwordx4 v[208:211], v14, s[4:7], s37 offen offset:0 sc1
    buffer_load_dwordx4 v[212:215], v14, s[4:7], s37 offen offset:1024 sc1
    s_add_u32 s37, s37, 2048
    buffer_load_dwordx4 v[216:219], v14, s[4:7], s37 offen offset:0 sc1
    s_waitcnt vmcnt(7)
    v_add_f32 v26, v184, v186
    v_add_f32 v28, v185, v187
    v_add_f32 v27, v188, v190
    v_add_f32 v29, v189, v191
    v_add_f32 v26, v26, v27
    v_add_f32 v28, v28, v29
    v_mov_b32 v3, v26
    v_mov_b32 v4, v28
    s_nop 1
    v_permlane32_swap_b32 v26, v3
    v_permlane32_swap_b32 v28, v4
    s_nop 1
    v_add_f32 v26, v26, v3
    v_add_f32 v28, v28, v4
    v_mul_f32 v26, 0x3acccccd, v26
    v_mul_f32 v28, 0x3acccccd, v28
    v_fma_f32 v28, -v26, v26, v28
    v_max_f32 v28, 0, v28
    v_add_f32 v28, 0x3727c5ac, v28
    v_rsq_f32 v30, v28
    s_nop 0
    v_sub_f32 v31, 0, v26
    v_pk_mul_f32 v[88:89], v[30:31], v[88:89] op_sel:[1,0] op_sel_hi:[1,1]
    v_pk_mul_f32 v[90:91], v[30:31], v[90:91] op_sel:[1,0] op_sel_hi:[1,1]
    v_pk_mul_f32 v[92:93], v[30:31], v[92:93] op_sel:[1,0] op_sel_hi:[1,1]
    v_pk_mul_f32 v[94:95], v[30:31], v[94:95] op_sel:[1,0] op_sel_hi:[1,1]
    v_pk_mul_f32 v[96:97], v[30:31], v[96:97] op_sel:[1,0] op_sel_hi:[1,1]
    v_pk_mul_f32 v[98:99], v[30:31], v[98:99] op_sel:[1,0] op_sel_hi:[1,1]
    v_pk_mul_f32 v[100:101], v[30:31], v[100:101] op_sel:[1,0] op_sel_hi:[1,1]
    v_pk_mul_f32 v[102:103], v[30:31], v[102:103] op_sel:[1,0] op_sel_hi:[1,1]
    v_pk_mul_f32 v[104:105], v[30:31], v[104:105] op_sel:[1,0] op_sel_hi:[1,1]
    v_pk_mul_f32 v[106:107], v[30:31], v[106:107] op_sel:[1,0] op_sel_hi:[1,1]
    v_pk_mul_f32 v[108:109], v[30:31], v[108:109] op_sel:[1,0] op_sel_hi:[1,1]
    v_pk_mul_f32 v[110:111], v[30:31], v[110:111] op_sel:[1,0] op_sel_hi:[1,1]
    v_pk_mul_f32 v[112:113], v[30:31], v[112:113] op_sel:[1,0] op_sel_hi:[1,1]
    v_pk_mul_f32 v[114:115], v[30:31], v[114:115] op_sel:[1,0] op_sel_hi:[1,1]
    v_pk_mul_f32 v[116:117], v[30:31], v[116:117] op_sel:[1,0] op_sel_hi:[1,1]
    v_pk_mul_f32 v[118:119], v[30:31], v[118:119] op_sel:[1,0] op_sel_hi:[1,1]
    v_pk_mul_f32 v[120:121], v[30:31], v[120:121] op_sel:[1,0] op_sel_hi:[1,1]
    v_pk_mul_f32 v[122:123], v[30:31], v[122:123] op_sel:[1,0] op_sel_hi:[1,1]
    v_pk_mul_f32 v[124:125], v[30:31], v[124:125] op_sel:[1,0] op_sel_hi:[1,1]
    v_pk_mul_f32 v[126:127], v[30:31], v[126:127] op_sel:[1,0] op_sel_hi:[1,1]
    v_pk_mul_f32 v[128:129], v[30:31], v[128:129] op_sel:[1,0] op_sel_hi:[1,1]
    v_pk_mul_f32 v[130:131], v[30:31], v[130:131] op_sel:[1,0] op_sel_hi:[1,1]
    v_pk_mul_f32 v[132:133], v[30:31], v[132:133] op_sel:[1,0] op_sel_hi:[1,1]
    v_pk_mul_f32 v[134:135], v[30:31], v[134:135] op_sel:[1,0] op_sel_hi:[1,1]
    v_pk_mul_f32 v[136:137], v[30:31], v[136:137] op_sel:[1,0] op_sel_hi:[1,1]
    v_pk_mul_f32 v[138:139], v[30:31], v[138:139] op_sel:[1,0] op_sel_hi:[1,1]
    v_pk_mul_f32 v[140:141], v[30:31], v[140:141] op_sel:[1,0] op_sel_hi:[1,1]
    v_pk_mul_f32 v[142:143], v[30:31], v[142:143] op_sel:[1,0] op_sel_hi:[1,1]
    v_pk_mul_f32 v[144:145], v[30:31], v[144:145] op_sel:[1,0] op_sel_hi:[1,1]
    v_pk_mul_f32 v[146:147], v[30:31], v[146:147] op_sel:[1,0] op_sel_hi:[1,1]
    v_pk_mul_f32 v[148:149], v[30:31], v[148:149] op_sel:[1,0] op_sel_hi:[1,1]
    v_pk_mul_f32 v[150:151], v[30:31], v[150:151] op_sel:[1,0] op_sel_hi:[1,1]
    v_pk_mul_f32 v[152:153], v[30:31], v[152:153] op_sel:[1,0] op_sel_hi:[1,1]
    v_pk_mul_f32 v[154:155], v[30:31], v[154:155] op_sel:[1,0] op_sel_hi:[1,1]
    v_pk_mul_f32 v[156:157], v[30:31], v[156:157] op_sel:[1,0] op_sel_hi:[1,1]
    v_pk_mul_f32 v[158:159], v[30:31], v[158:159] op_sel:[1,0] op_sel_hi:[1,1]
    v_pk_mul_f32 v[160:161], v[30:31], v[160:161] op_sel:[1,0] op_sel_hi:[1,1]
    v_pk_mul_f32 v[162:163], v[30:31], v[162:163] op_sel:[1,0] op_sel_hi:[1,1]
    v_pk_mul_f32 v[164:165], v[30:31], v[164:165] op_sel:[1,0] op_sel_hi:[1,1]
    v_pk_mul_f32 v[166:167], v[30:31], v[166:167] op_sel:[1,0] op_sel_hi:[1,1]
    v_pk_mul_f32 v[168:169], v[30:31], v[168:169] op_sel:[1,0] op_sel_hi:[1,1]
    v_pk_mul_f32 v[170:171], v[30:31], v[170:171] op_sel:[1,0] op_sel_hi:[1,1]
    v_pk_mul_f32 v[172:173], v[30:31], v[172:173] op_sel:[1,0] op_sel_hi:[1,1]
    v_pk_mul_f32 v[174:175], v[30:31], v[174:175] op_sel:[1,0] op_sel_hi:[1,1]
    v_pk_mul_f32 v[176:177], v[30:31], v[176:177] op_sel:[1,0] op_sel_hi:[1,1]
    v_pk_mul_f32 v[178:179], v[30:31], v[178:179] op_sel:[1,0] op_sel_hi:[1,1]
    v_pk_mul_f32 v[180:181], v[30:31], v[180:181] op_sel:[1,0] op_sel_hi:[1,1]
    v_pk_mul_f32 v[182:183], v[30:31], v[182:183] op_sel:[1,0] op_sel_hi:[1,1]
    s_mov_b32 s50, 5
    ds_read_b64_tr_b16 v[40:41], v18 offset:0
    ds_read_b64_tr_b16 v[42:43], v18 offset:768
    ds_read_b64_tr_b16 v[44:45], v18 offset:64
    ds_read_b64_tr_b16 v[46:47], v18 offset:832
    ds_read_b64_tr_b16 v[48:49], v18 offset:128
    ds_read_b64_tr_b16 v[50:51], v18 offset:896
    ds_read_b64_tr_b16 v[52:53], v18 offset:12288
    ds_read_b64_tr_b16 v[54:55], v18 offset:13056
    ds_read_b64_tr_b16 v[56:57], v18 offset:12352
    ds_read_b64_tr_b16 v[58:59], v18 offset:13120
    ds_read_b64_tr_b16 v[60:61], v18 offset:12416
    ds_read_b64_tr_b16 v[62:63], v18 offset:13184
L_ch1_kernel_loop_3:
    s_waitcnt vmcnt(6)
    s_waitcnt lgkmcnt(10)
    v_mfma_f32_32x32x16_bf16 v[88:103], v[40:43], v[192:195], v[88:103]
    buffer_load_dwordx4 v[220:223], v14, s[4:7], s37 offen offset:1024 sc1
    s_add_u32 s37, s37, 2048
    s_waitcnt lgkmcnt(8)
    v_mfma_f32_32x32x16_bf16 v[104:119], v[44:47], v[192:195], v[104:119]
    ds_read_b64_tr_b16 v[64:65], v18 offset:3072
    ds_read_b64_tr_b16 v[66:67], v18 offset:3840
    ds_read_b64_tr_b16 v[68:69], v18 offset:3136
    s_waitcnt lgkmcnt(9)
    v_mfma_f32_32x32x16_bf16 v[120:135], v[48:51], v[192:195], v[120:135]
    ds_read_b64_tr_b16 v[70:71], v18 offset:3904
    ds_read_b64_tr_b16 v[72:73], v18 offset:3200
    s_waitcnt lgkmcnt(9)
    v_mfma_f32_32x32x16_bf16 v[136:151], v[52:55], v[192:195], v[136:151]
    ds_read_b64_tr_b16 v[74:75], v18 offset:3968
    ds_read_b64_tr_b16 v[76:77], v18 offset:15360
    ds_read_b64_tr_b16 v[78:79], v18 offset:16128
    s_waitcnt lgkmcnt(10)
    v_mfma_f32_32x32x16_bf16 v[152:167], v[56:59], v[192:195], v[152:167]
    ds_read_b64_tr_b16 v[80:81], v18 offset:15424
    ds_read_b64_tr_b16 v[82:83], v18 offset:16192
    s_waitcnt lgkmcnt(10)
    v_mfma_f32_32x32x16_bf16 v[168:183], v[60:63], v[192:195], v[168:183]
    ds_read_b64_tr_b16 v[84:85], v18 offset:15488
    ds_read_b64_tr_b16 v[86:87], v18 offset:16256
    s_cmp_eq_u32 s50, 1
    s_cselect_b32 s37, 0x7f000000, s37
    s_waitcnt vmcnt(6)
    s_waitcnt lgkmcnt(10)
    v_mfma_f32_32x32x16_bf16 v[88:103], v[64:67], v[196:199], v[88:103]
    buffer_load_dwordx4 v[192:195], v14, s[4:7], s37 offen offset:0 sc1
    s_waitcnt lgkmcnt(8)
    v_mfma_f32_32x32x16_bf16 v[104:119], v[68:71], v[196:199], v[104:119]
    ds_read_b64_tr_b16 v[40:41], v18 offset:6144
    ds_read_b64_tr_b16 v[42:43], v18 offset:6912
    ds_read_b64_tr_b16 v[44:45], v18 offset:6208
    s_waitcnt lgkmcnt(9)
    v_mfma_f32_32x32x16_bf16 v[120:135], v[72:75], v[196:199], v[120:135]
    ds_read_b64_tr_b16 v[46:47], v18 offset:6976
    ds_read_b64_tr_b16 v[48:49], v18 offset:6272
    s_waitcnt lgkmcnt(9)
    v_mfma_f32_32x32x16_bf16 v[136:151], v[76:79], v[196:199], v[136:151]
    ds_read_b64_tr_b16 v[50:51], v18 offset:7040
    ds_read_b64_tr_b16 v[52:53], v18 offset:18432
    ds_read_b64_tr_b16 v[54:55], v18 offset:19200
    s_waitcnt lgkmcnt(10)
    v_mfma_f32_32x32x16_bf16 v[152:167], v[80:83], v[196:199], v[152:167]
    ds_read_b64_tr_b16 v[56:57], v18 offset:18496
    ds_read_b64_tr_b16 v[58:59], v18 offset:19264
    s_waitcnt lgkmcnt(10)
    v_mfma_f32_32x32x16_bf16 v[168:183], v[84:87], v[196:199], v[168:183]
    ds_read_b64_tr_b16 v[60:61], v18 offset:18560
    ds_read_b64_tr_b16 v[62:63], v18 offset:19328
    s_waitcnt vmcnt(6)
    s_waitcnt lgkmcnt(10)
    v_mfma_f32_32x32x16_bf16 v[88:103], v[40:43], v[200:203], v[88:103]
    buffer_load_dwordx4 v[196:199], v14, s[4:7], s37 offen offset:1024 sc1
    s_add_u32 s37, s37, 2048
    s_waitcnt lgkmcnt(8)
    v_mfma_f32_32x32x16_bf16 v[104:119], v[44:47], v[200:203], v[104:119]
    ds_read_b64_tr_b16 v[64:65], v18 offset:9216
    ds_read_b64_tr_b16 v[66:67], v18 offset:9984
    s_barrier
    s_add_u32 s60, s44, 24576
    s_cmp_gt_u32 s60, 122880
    s_cselect_b32 s60, 0, s60
    s_sub_u32 s45, s60, s44
    s_mov_b32 s44, s60
    s_waitcnt lgkmcnt(8)
    v_mfma_f32_32x32x16_bf16 v[120:135], v[48:51], v[200:203], v[120:135]
    ds_read_b64_tr_b16 v[68:69], v18 offset:9280
    ds_read_b64_tr_b16 v[70:71], v18 offset:10048
    ds_read_b64_tr_b16 v[72:73], v18 offset:9344
    s_waitcnt lgkmcnt(9)
    v_mfma_f32_32x32x16_bf16 v[136:151], v[52:55], v[200:203], v[136:151]
    ds_read_b64_tr_b16 v[74:75], v18 offset:10112
    ds_read_b64_tr_b16 v[76:77], v18 offset:21504
    ds_read_b64_tr_b16 v[78:79], v18 offset:22272
    s_waitcnt lgkmcnt(10)
    v_mfma_f32_32x32x16_bf16 v[152:167], v[56:59], v[200:203], v[152:167]
    ds_read_b64_tr_b16 v[80:81], v18 offset:21568
    ds_read_b64_tr_b16 v[82:83], v18 offset:22336
    ds_read_b64_tr_b16 v[84:85], v18 offset:21632
    s_waitcnt lgkmcnt(11)
    v_mfma_f32_32x32x16_bf16 v[168:183], v[60:63], v[200:203], v[168:183]
    ds_read_b64_tr_b16 v[86:87], v18 offset:22400
    v_add_u32 v18, s45, v18
    s_waitcnt vmcnt(6)
    s_waitcnt lgkmcnt(10)
    v_mfma_f32_32x32x16_bf16 v[88:103], v[64:67], v[204:207], v[88:103]
    buffer_load_dwordx4 v[200:203], v14, s[4:7], s37 offen offset:0 sc1
    s_waitcnt lgkmcnt(8)
    v_mfma_f32_32x32x16_bf16 v[104:119], v[68:71], v[204:207], v[104:119]
    ds_read_b64_tr_b16 v[40:41], v18 offset:0
    ds_read_b64_tr_b16 v[42:43], v18 offset:768
    ds_read_b64_tr_b16 v[44:45], v18 offset:64
    s_waitcnt lgkmcnt(9)
    v_mfma_f32_32x32x16_bf16 v[120:135], v[72:75], v[204:207], v[120:135]
    ds_read_b64_tr_b16 v[46:47], v18 offset:832
    ds_read_b64_tr_b16 v[48:49], v18 offset:128
    s_waitcnt lgkmcnt(9)
    v_mfma_f32_32x32x16_bf16 v[136:151], v[76:79], v[204:207], v[136:151]
    ds_read_b64_tr_b16 v[50:51], v18 offset:896
    ds_read_b64_tr_b16 v[52:53], v18 offset:12288
    ds_read_b64_tr_b16 v[54:55], v18 offset:13056
    s_waitcnt lgkmcnt(10)
    v_mfma_f32_32x32x16_bf16 v[152:167], v[80:83], v[204:207], v[152:167]
    ds_read_b64_tr_b16 v[56:57], v18 offset:12352
    ds_read_b64_tr_b16 v[58:59], v18 offset:13120
    s_waitcnt lgkmcnt(10)
    v_mfma_f32_32x32x16_bf16 v[168:183], v[84:87], v[204:207], v[168:183]
    ds_read_b64_tr_b16 v[60:61], v18 offset:12416
    ds_read_b64_tr_b16 v[62:63], v18 offset:13184
    s_waitcnt vmcnt(6)
    s_waitcnt lgkmcnt(10)
    v_mfma_f32_32x32x16_bf16 v[88:103], v[40:43], v[208:211], v[88:103]
    buffer_load_dwordx4 v[204:207], v14, s[4:7], s37 offen offset:1024 sc1
    s_add_u32 s37, s37, 2048
    s_waitcnt lgkmcnt(8)
    v_mfma_f32_32x32x16_bf16 v[104:119], v[44:47], v[208:211], v[104:119]
    ds_read_b64_tr_b16 v[64:65], v18 offset:3072
    ds_read_b64_tr_b16 v[66:67], v18 offset:3840
    ds_read_b64_tr_b16 v[68:69], v18 offset:3136
    s_waitcnt lgkmcnt(9)
    v_mfma_f32_32x32x16_bf16 v[120:135], v[48:51], v[208:211], v[120:135]
    ds_read_b64_tr_b16 v[70:71], v18 offset:3904
    ds_read_b64_tr_b16 v[72:73], v18 offset:3200
    s_waitcnt lgkmcnt(9)
    v_mfma_f32_32x32x16_bf16 v[136:151], v[52:55], v[208:211], v[136:151]
    ds_read_b64_tr_b16 v[74:75], v18 offset:3968
    ds_read_b64_tr_b16 v[76:77], v18 offset:15360
    ds_read_b64_tr_b16 v[78:79], v18 offset:16128
    s_waitcnt lgkmcnt(10)
    v_mfma_f32_32x32x16_bf16 v[152:167], v[56:59], v[208:211], v[152:167]
    ds_read_b64_tr_b16 v[80:81], v18 offset:15424
    ds_read_b64_tr_b16 v[82:83], v18 offset:16192
    s_waitcnt lgkmcnt(10)
    v_mfma_f32_32x32x16_bf16 v[168:183], v[60:63], v[208:211], v[168:183]
    ds_read_b64_tr_b16 v[84:85], v18 offset:15488
    ds_read_b64_tr_b16 v[86:87], v18 offset:16256
    s_waitcnt vmcnt(6)
    s_waitcnt lgkmcnt(10)
    v_mfma_f32_32x32x16_bf16 v[88:103], v[64:67], v[212:215], v[88:103]
    buffer_load_dwordx4 v[208:211], v14, s[4:7], s37 offen offset:0 sc1
    s_waitcnt lgkmcnt(8)
    v_mfma_f32_32x32x16_bf16 v[104:119], v[68:71], v[212:215], v[104:119]
    ds_read_b64_tr_b16 v[40:41], v18 offset:6144
    ds_read_b64_tr_b16 v[42:43], v18 offset:6912
    ds_read_b64_tr_b16 v[44:45], v18 offset:6208
    s_waitcnt lgkmcnt(9)
    v_mfma_f32_32x32x16_bf16 v[120:135], v[72:75], v[212:215], v[120:135]
    ds_read_b64_tr_b16 v[46:47], v18 offset:6976
    ds_read_b64_tr_b16 v[48:49], v18 offset:6272
    s_waitcnt lgkmcnt(9)
    v_mfma_f32_32x32x16_bf16 v[136:151], v[76:79], v[212:215], v[136:151]
    ds_read_b64_tr_b16 v[50:51], v18 offset:7040
    ds_read_b64_tr_b16 v[52:53], v18 offset:18432
    ds_read_b64_tr_b16 v[54:55], v18 offset:19200
    s_waitcnt lgkmcnt(10)
    v_mfma_f32_32x32x16_bf16 v[152:167], v[80:83], v[212:215], v[152:167]
    ds_read_b64_tr_b16 v[56:57], v18 offset:18496
    ds_read_b64_tr_b16 v[58:59], v18 offset:19264
    s_waitcnt lgkmcnt(10)
    v_mfma_f32_32x32x16_bf16 v[168:183], v[84:87], v[212:215], v[168:183]
    ds_read_b64_tr_b16 v[60:61], v18 offset:18560
    ds_read_b64_tr_b16 v[62:63], v18 offset:19328
    s_waitcnt vmcnt(6)
    s_waitcnt lgkmcnt(10)
    v_mfma_f32_32x32x16_bf16 v[88:103], v[40:43], v[216:219], v[88:103]
    buffer_load_dwordx4 v[212:215], v14, s[4:7], s37 offen offset:1024 sc1
    s_add_u32 s37, s37, 2048
    s_waitcnt lgkmcnt(8)
    v_mfma_f32_32x32x16_bf16 v[104:119], v[44:47], v[216:219], v[104:119]
    ds_read_b64_tr_b16 v[64:65], v18 offset:9216
    ds_read_b64_tr_b16 v[66:67], v18 offset:9984
    s_barrier
    s_add_u32 s60, s44, 24576
    s_cmp_gt_u32 s60, 122880
    s_cselect_b32 s60, 0, s60
    s_sub_u32 s45, s60, s44
    s_mov_b32 s44, s60
    s_waitcnt lgkmcnt(8)
    v_mfma_f32_32x32x16_bf16 v[120:135], v[48:51], v[216:219], v[120:135]
    ds_read_b64_tr_b16 v[68:69], v18 offset:9280
    ds_read_b64_tr_b16 v[70:71], v18 offset:10048
    ds_read_b64_tr_b16 v[72:73], v18 offset:9344
    s_waitcnt lgkmcnt(9)
    v_mfma_f32_32x32x16_bf16 v[136:151], v[52:55], v[216:219], v[136:151]
    ds_read_b64_tr_b16 v[74:75], v18 offset:10112
    ds_read_b64_tr_b16 v[76:77], v18 offset:21504
    ds_read_b64_tr_b16 v[78:79], v18 offset:22272
    s_waitcnt lgkmcnt(10)
    v_mfma_f32_32x32x16_bf16 v[152:167], v[56:59], v[216:219], v[152:167]
    ds_read_b64_tr_b16 v[80:81], v18 offset:21568
    ds_read_b64_tr_b16 v[82:83], v18 offset:22336
    ds_read_b64_tr_b16 v[84:85], v18 offset:21632
    s_waitcnt lgkmcnt(11)
    v_mfma_f32_32x32x16_bf16 v[168:183], v[60:63], v[216:219], v[168:183]
    ds_read_b64_tr_b16 v[86:87], v18 offset:22400
    v_add_u32 v18, s45, v18
    s_waitcnt vmcnt(6)
    s_waitcnt lgkmcnt(10)
    v_mfma_f32_32x32x16_bf16 v[88:103], v[64:67], v[220:223], v[88:103]
    buffer_load_dwordx4 v[216:219], v14, s[4:7], s37 offen offset:0 sc1
    s_waitcnt lgkmcnt(8)
    v_mfma_f32_32x32x16_bf16 v[104:119], v[68:71], v[220:223], v[104:119]
    ds_read_b64_tr_b16 v[40:41], v18 offset:0
    ds_read_b64_tr_b16 v[42:43], v18 offset:768
    ds_read_b64_tr_b16 v[44:45], v18 offset:64
    s_waitcnt lgkmcnt(9)
    v_mfma_f32_32x32x16_bf16 v[120:135], v[72:75], v[220:223], v[120:135]
    ds_read_b64_tr_b16 v[46:47], v18 offset:832
    ds_read_b64_tr_b16 v[48:49], v18 offset:128
    s_waitcnt lgkmcnt(9)
    v_mfma_f32_32x32x16_bf16 v[136:151], v[76:79], v[220:223], v[136:151]
    ds_read_b64_tr_b16 v[50:51], v18 offset:896
    ds_read_b64_tr_b16 v[52:53], v18 offset:12288
    ds_read_b64_tr_b16 v[54:55], v18 offset:13056
    s_waitcnt lgkmcnt(10)
    v_mfma_f32_32x32x16_bf16 v[152:167], v[80:83], v[220:223], v[152:167]
    ds_read_b64_tr_b16 v[56:57], v18 offset:12352
    ds_read_b64_tr_b16 v[58:59], v18 offset:13120
    s_waitcnt lgkmcnt(10)
    v_mfma_f32_32x32x16_bf16 v[168:183], v[84:87], v[220:223], v[168:183]
    ds_read_b64_tr_b16 v[60:61], v18 offset:12416
    ds_read_b64_tr_b16 v[62:63], v18 offset:13184
    s_sub_u32 s50, s50, 1
    s_cmp_lg_u32 s50, 0
    s_cbranch_scc1 L_ch1_kernel_loop_3
    s_waitcnt  lgkmcnt(0)
    s_nop 7
    v_mul_f32 v30, v30, v30
    v_pk_mul_f32 v[136:137], v[30:31], v[136:137] op_sel_hi:[0,1]
    v_max_f32 v88, 0, v88
    v_max_f32 v89, 0, v89
    v_pk_mul_f32 v[88:89], v[88:89], v[136:137]
    v_pk_mul_f32 v[138:139], v[30:31], v[138:139] op_sel_hi:[0,1]
    v_max_f32 v90, 0, v90
    v_max_f32 v91, 0, v91
    v_pk_mul_f32 v[90:91], v[90:91], v[138:139]
    v_pk_mul_f32 v[140:141], v[30:31], v[140:141] op_sel_hi:[0,1]
    v_max_f32 v92, 0, v92
    v_max_f32 v93, 0, v93
    v_pk_mul_f32 v[92:93], v[92:93], v[140:141]
    v_pk_mul_f32 v[142:143], v[30:31], v[142:143] op_sel_hi:[0,1]
    v_max_f32 v94, 0, v94
    v_max_f32 v95, 0, v95
    v_pk_mul_f32 v[94:95], v[94:95], v[142:143]
    v_pk_mul_f32 v[144:145], v[30:31], v[144:145] op_sel_hi:[0,1]
    v_max_f32 v96, 0, v96
    v_max_f32 v97, 0, v97
    v_pk_mul_f32 v[96:97], v[96:97], v[144:145]
    v_pk_mul_f32 v[146:147], v[30:31], v[146:147] op_sel_hi:[0,1]
    v_max_f32 v98, 0, v98
    v_max_f32 v99, 0, v99
    v_pk_mul_f32 v[98:99], v[98:99], v[146:147]
    v_pk_mul_f32 v[148:149], v[30:31], v[148:149] op_sel_hi:[0,1]
    v_max_f32 v100, 0, v100
    v_max_f32 v101, 0, v101
    v_pk_mul_f32 v[100:101], v[100:101], v[148:149]
    v_pk_mul_f32 v[150:151], v[30:31], v[150:151] op_sel_hi:[0,1]
    v_max_f32 v102, 0, v102
    v_max_f32 v103, 0, v103
    v_pk_mul_f32 v[102:103], v[102:103], v[150:151]
    v_cvt_pk_bf16_f32 v136, v88, v89
    v_cvt_pk_bf16_f32 v137, v90, v91
    v_cvt_pk_bf16_f32 v138, v96, v97
    v_cvt_pk_bf16_f32 v139, v98, v99
    buffer_store_dwordx4 v[136:139], v14, s[16:19], s48 offen offset:0 sc1
    v_cvt_pk_bf16_f32 v140, v92, v93
    v_cvt_pk_bf16_f32 v141, v94, v95
    v_cvt_pk_bf16_f32 v142, v100, v101
    v_cvt_pk_bf16_f32 v143, v102, v103
    buffer_store_dwordx4 v[140:143], v14, s[16:19], s48 offen offset:1024 sc1
    v_pk_mul_f32 v[152:153], v[30:31], v[152:153] op_sel_hi:[0,1]
    v_max_f32 v104, 0, v104
    v_max_f32 v105, 0, v105
    v_pk_mul_f32 v[104:105], v[104:105], v[152:153]
    v_pk_mul_f32 v[154:155], v[30:31], v[154:155] op_sel_hi:[0,1]
    v_max_f32 v106, 0, v106
    v_max_f32 v107, 0, v107
    v_pk_mul_f32 v[106:107], v[106:107], v[154:155]
    v_pk_mul_f32 v[156:157], v[30:31], v[156:157] op_sel_hi:[0,1]
    v_max_f32 v108, 0, v108
    v_max_f32 v109, 0, v109
    v_pk_mul_f32 v[108:109], v[108:109], v[156:157]
    v_pk_mul_f32 v[158:159], v[30:31], v[158:159] op_sel_hi:[0,1]
    v_max_f32 v110, 0, v110
    v_max_f32 v111, 0, v111
    v_pk_mul_f32 v[110:111], v[110:111], v[158:159]
    v_pk_mul_f32 v[160:161], v[30:31], v[160:161] op_sel_hi:[0,1]
    v_max_f32 v112, 0, v112
    v_max_f32 v113, 0, v113
    v_pk_mul_f32 v[112:113], v[112:113], v[160:161]
    v_pk_mul_f32 v[162:163], v[30:31], v[162:163] op_sel_hi:[0,1]
    v_max_f32 v114, 0, v114
    v_max_f32 v115, 0, v115
    v_pk_mul_f32 v[114:115], v[114:115], v[162:163]
    v_pk_mul_f32 v[164:165], v[30:31], v[164:165] op_sel_hi:[0,1]
    v_max_f32 v116, 0, v116
    v_max_f32 v117, 0, v117
    v_pk_mul_f32 v[116:117], v[116:117], v[164:165]
    v_pk_mul_f32 v[166:167], v[30:31], v[166:167] op_sel_hi:[0,1]
    v_max_f32 v118, 0, v118
    v_max_f32 v119, 0, v119
    v_pk_mul_f32 v[118:119], v[118:119], v[166:167]
    v_cvt_pk_bf16_f32 v152, v104, v105
    v_cvt_pk_bf16_f32 v153, v106, v107
    v_cvt_pk_bf16_f32 v154, v112, v113
    v_cvt_pk_bf16_f32 v155, v114, v115
    buffer_store_dwordx4 v[152:155], v14, s[16:19], s48 offen offset:2048 sc1
    v_cvt_pk_bf16_f32 v156, v108, v109
    v_cvt_pk_bf16_f32 v157, v110, v111
    v_cvt_pk_bf16_f32 v158, v116, v117
    v_cvt_pk_bf16_f32 v159, v118, v119
    buffer_store_dwordx4 v[156:159], v14, s[16:19], s48 offen offset:3072 sc1
    v_pk_mul_f32 v[168:169], v[30:31], v[168:169] op_sel_hi:[0,1]
    v_max_f32 v120, 0, v120
    v_max_f32 v121, 0, v121
    v_pk_mul_f32 v[120:121], v[120:121], v[168:169]
    v_pk_mul_f32 v[170:171], v[30:31], v[170:171] op_sel_hi:[0,1]
    v_max_f32 v122, 0, v122
    v_max_f32 v123, 0, v123
    v_pk_mul_f32 v[122:123], v[122:123], v[170:171]
    v_pk_mul_f32 v[172:173], v[30:31], v[172:173] op_sel_hi:[0,1]
    v_max_f32 v124, 0, v124
    v_max_f32 v125, 0, v125
    v_pk_mul_f32 v[124:125], v[124:125], v[172:173]
    v_pk_mul_f32 v[174:175], v[30:31], v[174:175] op_sel_hi:[0,1]
    v_max_f32 v126, 0, v126
    v_max_f32 v127, 0, v127
    v_pk_mul_f32 v[126:127], v[126:127], v[174:175]
    v_pk_mul_f32 v[176:177], v[30:31], v[176:177] op_sel_hi:[0,1]
    v_max_f32 v128, 0, v128
    v_max_f32 v129, 0, v129
    v_pk_mul_f32 v[128:129], v[128:129], v[176:177]
    v_pk_mul_f32 v[178:179], v[30:31], v[178:179] op_sel_hi:[0,1]
    v_max_f32 v130, 0, v130
    v_max_f32 v131, 0, v131
    v_pk_mul_f32 v[130:131], v[130:131], v[178:179]
    v_pk_mul_f32 v[180:181], v[30:31], v[180:181] op_sel_hi:[0,1]
    v_max_f32 v132, 0, v132
    v_max_f32 v133, 0, v133
    v_pk_mul_f32 v[132:133], v[132:133], v[180:181]
    v_pk_mul_f32 v[182:183], v[30:31], v[182:183] op_sel_hi:[0,1]
    v_max_f32 v134, 0, v134
    v_max_f32 v135, 0, v135
    v_pk_mul_f32 v[134:135], v[134:135], v[182:183]
    v_cvt_pk_bf16_f32 v168, v120, v121
    v_cvt_pk_bf16_f32 v169, v122, v123
    v_cvt_pk_bf16_f32 v170, v128, v129
    v_cvt_pk_bf16_f32 v171, v130, v131
    buffer_store_dwordx4 v[168:171], v14, s[16:19], s47 offen offset:0 sc1
    v_cvt_pk_bf16_f32 v172, v124, v125
    v_cvt_pk_bf16_f32 v173, v126, v127
    v_cvt_pk_bf16_f32 v174, v132, v133
    v_cvt_pk_bf16_f32 v175, v134, v135
    buffer_store_dwordx4 v[172:175], v14, s[16:19], s47 offen offset:1024 sc1
    s_lshl_b32 s62, s42, 7
    s_add_u32 s62, s62, 40960
    s_waitcnt vmcnt(0)
    s_mov_b64 exec, 1
    buffer_atomic_add v15, v13, s[52:55], s62 offen sc1
    s_mov_b64 exec, -1
    s_mov_b32 s44, 73728
    s_lshr_b32 s42, s35, 1
    s_and_b32 s43, s35, 1
    s_lshl_b32 s46, s66, 1
    s_add_u32 s46, s46, s42
    v_and_b32 v3, 15, v1
    s_lshl_b32 s45, s43, 4
    v_add_u32 v3, s45, v3
    v_lshrrev_b32 v4, 4, v1
    v_lshrrev_b32 v5, 1, v4
    v_lshlrev_b32 v29, 9, v5
    v_and_b32 v5, 1, v4
    v_lshl_add_u32 v29, v5, 3, v29
    v_lshl_add_u32 v29, v3, 4, v29
    v_mul_u32_u24 v28, 1280, v3
    v_lshl_add_u32 v28, v4, 3, v28
    s_mul_i32 s47, s46, 40960
    s_mul_i32 s48, s67, 5120
    s_add_u32 s47, s47, s48
    s_mul_i32 s48, s46, 40960
    s_mul_i32 s49, s67, 160
    s_add_u32 s48, s48, s49
    s_add_u32 s49, s47, 4096
    v_lshlrev_b32 v7, 6, v3
    v_lshrrev_b32 v5, 2, v1
    v_mul_u32_u24 v5, 160, v5
    v_and_b32 v6, 3, v1
    v_lshl_add_u32 v16, v6, 3, v5
    v_add_u32 v16, s44, v16
    v_lshlrev_b32 v5, 4, v3
    v_lshl_add_u32 v17, v4, 9, v5
    s_mul_i32 s37, s46, 98304
    s_lshl_b32 s50, s46, 11
    s_lshl_b32 s43, s67, 3
    s_add_u32 s50, s50, s43
    s_add_u32 s4, s28, 0x6600000
    s_addc_u32 s5, s29, 0
    s_mov_b32 s6, 0x600000
    s_mov_b32 s7, 0x00020000
    s_add_u32 s12, s28, 0x5e00000
    s_addc_u32 s13, s29, 0
    s_mov_b32 s14, 0x280000
    s_mov_b32 s15, 0x00020000
    s_mov_b32 s16, s24
    s_mov_b32 s17, s25
    s_mov_b32 s18, 0x280000
    s_mov_b32 s19, 0x00020000
    buffer_load_dwordx2 v[18:19], v29, s[12:15], s47 offen offset:0 sc1
    buffer_load_dwordx2 v[20:21], v29, s[12:15], s47 offen offset:1024 sc1
    buffer_load_dwordx2 v[22:23], v29, s[12:15], s47 offen offset:2048 sc1
    buffer_load_dwordx2 v[24:25], v29, s[12:15], s47 offen offset:3072 sc1
    buffer_load_dwordx2 v[26:27], v29, s[12:15], s49 offen sc1
    s_waitcnt vmcnt(0)
    v_lshlrev_b32 v72, 16, v18
    v_and_b32 v73, 0xffff0000, v18
    v_lshlrev_b32 v74, 16, v19
    v_and_b32 v75, 0xffff0000, v19
    v_lshlrev_b32 v76, 16, v20
    v_and_b32 v77, 0xffff0000, v20
    v_lshlrev_b32 v78, 16, v21
    v_and_b32 v79, 0xffff0000, v21
    v_lshlrev_b32 v80, 16, v22
    v_and_b32 v81, 0xffff0000, v22
    v_lshlrev_b32 v82, 16, v23
    v_and_b32 v83, 0xffff0000, v23
    v_lshlrev_b32 v84, 16, v24
    v_and_b32 v85, 0xffff0000, v24
    v_lshlrev_b32 v86, 16, v25
    v_and_b32 v87, 0xffff0000, v25
    v_lshlrev_b32 v88, 16, v26
    v_and_b32 v89, 0xffff0000, v26
    v_lshlrev_b32 v90, 16, v27
    v_and_b32 v91, 0xffff0000, v27
    s_lshl_b32 s62, s46, 7
    s_add_u32 s62, s62, 40960
    s_mov_b32 s63, 0
L_ch1_kernel_poll_4:
    buffer_load_dword v12, v13, s[52:55], s62 offen sc1
    s_waitcnt vmcnt(0)
    v_readfirstlane_b32 s61, v12
    s_add_u32 s63, s63, 1
    s_cmp_ge_u32 s61, 16
    s_cbranch_scc1 L_ch1_kernel_go_5
    s_cmp_ge_u32 s63, 0x400000
    s_cbranch_scc1 L_ch1_kernel_go_5
    s_sleep 1
    s_branch L_ch1_kernel_poll_4
L_ch1_kernel_go_5:
    buffer_load_dwordx4 v[112:115], v17, s[4:7], s37 offen offset:0 sc1
    buffer_load_dwordx4 v[116:119], v17, s[4:7], s37 offen offset:2048 sc1
    s_add_u32 s37, s37, 4096
    buffer_load_dwordx4 v[120:123], v17, s[4:7], s37 offen offset:0 sc1
    buffer_load_dwordx4 v[124:127], v17, s[4:7], s37 offen offset:2048 sc1
    s_add_u32 s37, s37, 4096
    buffer_load_dwordx4 v[128:131], v17, s[4:7], s37 offen offset:0 sc1
    buffer_load_dwordx4 v[132:135], v17, s[4:7], s37 offen offset:2048 sc1
    s_add_u32 s37, s37, 4096
    buffer_load_dwordx4 v[136:139], v17, s[4:7], s37 offen offset:0 sc1
    buffer_load_dwordx4 v[140:143], v17, s[4:7], s37 offen offset:2048 sc1
    s_add_u32 s37, s37, 4096
    ds_read_b64_tr_b16 v[32:33], v16 offset:0
    ds_read_b64_tr_b16 v[34:35], v16 offset:2560
    ds_read_b64_tr_b16 v[36:37], v16 offset:32
    ds_read_b64_tr_b16 v[38:39], v16 offset:2592
    ds_read_b64_tr_b16 v[40:41], v16 offset:64
    ds_read_b64_tr_b16 v[42:43], v16 offset:2624
    ds_read_b64_tr_b16 v[44:45], v16 offset:96
    ds_read_b64_tr_b16 v[46:47], v16 offset:2656
    ds_read_b64_tr_b16 v[48:49], v16 offset:128
    ds_read_b64_tr_b16 v[50:51], v16 offset:2688
    s_mov_b32 s51, 6
L_ch1_kernel_loop_6:
    s_cmp_eq_u32 s51, 1
    s_cselect_b32 s37, 0x7f000000, s37
    s_waitcnt vmcnt(7)
    s_waitcnt lgkmcnt(8)
    v_mfma_f32_16x16x32_bf16 v[72:75], v[32:35], v[112:115], v[72:75]
    ds_read_b64_tr_b16 v[52:53], v16 offset:5120
    ds_read_b64_tr_b16 v[54:55], v16 offset:7680
    s_waitcnt lgkmcnt(8)
    v_mfma_f32_16x16x32_bf16 v[76:79], v[36:39], v[112:115], v[76:79]
    ds_read_b64_tr_b16 v[56:57], v16 offset:5152
    ds_read_b64_tr_b16 v[58:59], v16 offset:7712
    s_waitcnt lgkmcnt(8)
    v_mfma_f32_16x16x32_bf16 v[80:83], v[40:43], v[112:115], v[80:83]
    ds_read_b64_tr_b16 v[60:61], v16 offset:5184
    ds_read_b64_tr_b16 v[62:63], v16 offset:7744
    s_waitcnt lgkmcnt(8)
    v_mfma_f32_16x16x32_bf16 v[84:87], v[44:47], v[112:115], v[84:87]
    ds_read_b64_tr_b16 v[64:65], v16 offset:5216
    ds_read_b64_tr_b16 v[66:67], v16 offset:7776
    s_waitcnt lgkmcnt(8)
    v_mfma_f32_16x16x32_bf16 v[88:91], v[48:51], v[112:115], v[88:91]
    ds_read_b64_tr_b16 v[68:69], v16 offset:5248
    ds_read_b64_tr_b16 v[70:71], v16 offset:7808
    buffer_load_dwordx4 v[112:115], v17, s[4:7], s37 offen offset:0 sc1
    s_waitcnt vmcnt(7)
    s_waitcnt lgkmcnt(8)
    v_mfma_f32_16x16x32_bf16 v[72:75], v[52:55], v[116:119], v[72:75]
    ds_read_b64_tr_b16 v[32:33], v16 offset:10240
    ds_read_b64_tr_b16 v[34:35], v16 offset:12800
    s_waitcnt lgkmcnt(8)
    v_mfma_f32_16x16x32_bf16 v[76:79], v[56:59], v[116:119], v[76:79]
    ds_read_b64_tr_b16 v[36:37], v16 offset:10272
    ds_read_b64_tr_b16 v[38:39], v16 offset:12832
    s_waitcnt lgkmcnt(8)
    v_mfma_f32_16x16x32_bf16 v[80:83], v[60:63], v[116:119], v[80:83]
    ds_read_b64_tr_b16 v[40:41], v16 offset:10304
    ds_read_b64_tr_b16 v[42:43], v16 offset:12864
    s_waitcnt lgkmcnt(8)
    v_mfma_f32_16x16x32_bf16 v[84:87], v[64:67], v[116:119], v[84:87]
    ds_read_b64_tr_b16 v[44:45], v16 offset:10336
    ds_read_b64_tr_b16 v[46:47], v16 offset:12896
    s_waitcnt lgkmcnt(8)
    v_mfma_f32_16x16x32_bf16 v[88:91], v[68:71], v[116:119], v[88:91]
    ds_read_b64_tr_b16 v[48:49], v16 offset:10368
    ds_read_b64_tr_b16 v[50:51], v16 offset:12928
    buffer_load_dwordx4 v[116:119], v17, s[4:7], s37 offen offset:2048 sc1
    s_add_u32 s37, s37, 4096
    s_waitcnt vmcnt(7)
    s_waitcnt lgkmcnt(8)
    v_mfma_f32_16x16x32_bf16 v[72:75], v[32:35], v[120:123], v[72:75]
    ds_read_b64_tr_b16 v[52:53], v16 offset:15360
    ds_read_b64_tr_b16 v[54:55], v16 offset:17920
    s_waitcnt lgkmcnt(8)
    v_mfma_f32_16x16x32_bf16 v[76:79], v[36:39], v[120:123], v[76:79]
    ds_read_b64_tr_b16 v[56:57], v16 offset:15392
    ds_read_b64_tr_b16 v[58:59], v16 offset:17952
    s_waitcnt lgkmcnt(8)
    v_mfma_f32_16x16x32_bf16 v[80:83], v[40:43], v[120:123], v[80:83]
    ds_read_b64_tr_b16 v[60:61], v16 offset:15424
    ds_read_b64_tr_b16 v[62:63], v16 offset:17984
    s_waitcnt lgkmcnt(8)
    v_mfma_f32_16x16x32_bf16 v[84:87], v[44:47], v[120:123], v[84:87]
    ds_read_b64_tr_b16 v[64:65], v16 offset:15456
    ds_read_b64_tr_b16 v[66:67], v16 offset:18016
    s_waitcnt lgkmcnt(8)
    v_mfma_f32_16x16x32_bf16 v[88:91], v[48:51], v[120:123], v[88:91]
    ds_read_b64_tr_b16 v[68:69], v16 offset:15488
    ds_read_b64_tr_b16 v[70:71], v16 offset:18048
    buffer_load_dwordx4 v[120:123], v17, s[4:7], s37 offen offset:0 sc1
    s_barrier
    s_add_u32 s60, s44, 24576
    s_cmp_gt_u32 s60, 122880
    s_cselect_b32 s60, 0, s60
    s_sub_u32 s45, s60, s44
    s_mov_b32 s44, s60
    v_add_u32 v16, s45, v16
    s_waitcnt vmcnt(7)
    s_waitcnt lgkmcnt(8)
    v_mfma_f32_16x16x32_bf16 v[72:75], v[52:55], v[124:127], v[72:75]
    ds_read_b64_tr_b16 v[32:33], v16 offset:0
    ds_read_b64_tr_b16 v[34:35], v16 offset:2560
    s_waitcnt lgkmcnt(8)
    v_mfma_f32_16x16x32_bf16 v[76:79], v[56:59], v[124:127], v[76:79]
    ds_read_b64_tr_b16 v[36:37], v16 offset:32
    ds_read_b64_tr_b16 v[38:39], v16 offset:2592
    s_waitcnt lgkmcnt(8)
    v_mfma_f32_16x16x32_bf16 v[80:83], v[60:63], v[124:127], v[80:83]
    ds_read_b64_tr_b16 v[40:41], v16 offset:64
    ds_read_b64_tr_b16 v[42:43], v16 offset:2624
    s_waitcnt lgkmcnt(8)
    v_mfma_f32_16x16x32_bf16 v[84:87], v[64:67], v[124:127], v[84:87]
    ds_read_b64_tr_b16 v[44:45], v16 offset:96
    ds_read_b64_tr_b16 v[46:47], v16 offset:2656
    s_waitcnt lgkmcnt(8)
    v_mfma_f32_16x16x32_bf16 v[88:91], v[68:71], v[124:127], v[88:91]
    ds_read_b64_tr_b16 v[48:49], v16 offset:128
    ds_read_b64_tr_b16 v[50:51], v16 offset:2688
    buffer_load_dwordx4 v[124:127], v17, s[4:7], s37 offen offset:2048 sc1
    s_add_u32 s37, s37, 4096
    s_waitcnt vmcnt(7)
    s_waitcnt lgkmcnt(8)
    v_mfma_f32_16x16x32_bf16 v[72:75], v[32:35], v[128:131], v[72:75]
    ds_read_b64_tr_b16 v[52:53], v16 offset:5120
    ds_read_b64_tr_b16 v[54:55], v16 offset:7680
    s_waitcnt lgkmcnt(8)
    v_mfma_f32_16x16x32_bf16 v[76:79], v[36:39], v[128:131], v[76:79]
    ds_read_b64_tr_b16 v[56:57], v16 offset:5152
    ds_read_b64_tr_b16 v[58:59], v16 offset:7712
    s_waitcnt lgkmcnt(8)
    v_mfma_f32_16x16x32_bf16 v[80:83], v[40:43], v[128:131], v[80:83]
    ds_read_b64_tr_b16 v[60:61], v16 offset:5184
    ds_read_b64_tr_b16 v[62:63], v16 offset:7744
    s_waitcnt lgkmcnt(8)
    v_mfma_f32_16x16x32_bf16 v[84:87], v[44:47], v[128:131], v[84:87]
    ds_read_b64_tr_b16 v[64:65], v16 offset:5216
    ds_read_b64_tr_b16 v[66:67], v16 offset:7776
    s_waitcnt lgkmcnt(8)
    v_mfma_f32_16x16x32_bf16 v[88:91], v[48:51], v[128:131], v[88:91]
    ds_read_b64_tr_b16 v[68:69], v16 offset:5248
    ds_read_b64_tr_b16 v[70:71], v16 offset:7808
    buffer_load_dwordx4 v[128:131], v17, s[4:7], s37 offen offset:0 sc1
    s_waitcnt vmcnt(7)
    s_waitcnt lgkmcnt(8)
    v_mfma_f32_16x16x32_bf16 v[72:75], v[52:55], v[132:135], v[72:75]
    ds_read_b64_tr_b16 v[32:33], v16 offset:10240
    ds_read_b64_tr_b16 v[34:35], v16 offset:12800
    s_waitcnt lgkmcnt(8)
    v_mfma_f32_16x16x32_bf16 v[76:79], v[56:59], v[132:135], v[76:79]
    ds_read_b64_tr_b16 v[36:37], v16 offset:10272
    ds_read_b64_tr_b16 v[38:39], v16 offset:12832
    s_waitcnt lgkmcnt(8)
    v_mfma_f32_16x16x32_bf16 v[80:83], v[60:63], v[132:135], v[80:83]
    ds_read_b64_tr_b16 v[40:41], v16 offset:10304
    ds_read_b64_tr_b16 v[42:43], v16 offset:12864
    s_waitcnt lgkmcnt(8)
    v_mfma_f32_16x16x32_bf16 v[84:87], v[64:67], v[132:135], v[84:87]
    ds_read_b64_tr_b16 v[44:45], v16 offset:10336
    ds_read_b64_tr_b16 v[46:47], v16 offset:12896
    s_waitcnt lgkmcnt(8)
    v_mfma_f32_16x16x32_bf16 v[88:91], v[68:71], v[132:135], v[88:91]
    ds_read_b64_tr_b16 v[48:49], v16 offset:10368
    ds_read_b64_tr_b16 v[50:51], v16 offset:12928
    buffer_load_dwordx4 v[132:135], v17, s[4:7], s37 offen offset:2048 sc1
    s_add_u32 s37, s37, 4096
    s_waitcnt vmcnt(7)
    s_waitcnt lgkmcnt(8)
    v_mfma_f32_16x16x32_bf16 v[72:75], v[32:35], v[136:139], v[72:75]
    ds_read_b64_tr_b16 v[52:53], v16 offset:15360
    ds_read_b64_tr_b16 v[54:55], v16 offset:17920
    s_waitcnt lgkmcnt(8)
    v_mfma_f32_16x16x32_bf16 v[76:79], v[36:39], v[136:139], v[76:79]
    ds_read_b64_tr_b16 v[56:57], v16 offset:15392
    ds_read_b64_tr_b16 v[58:59], v16 offset:17952
    s_waitcnt lgkmcnt(8)
    v_mfma_f32_16x16x32_bf16 v[80:83], v[40:43], v[136:139], v[80:83]
    ds_read_b64_tr_b16 v[60:61], v16 offset:15424
    ds_read_b64_tr_b16 v[62:63], v16 offset:17984
    s_waitcnt lgkmcnt(8)
    v_mfma_f32_16x16x32_bf16 v[84:87], v[44:47], v[136:139], v[84:87]
    ds_read_b64_tr_b16 v[64:65], v16 offset:15456
    ds_read_b64_tr_b16 v[66:67], v16 offset:18016
    s_waitcnt lgkmcnt(8)
    v_mfma_f32_16x16x32_bf16 v[88:91], v[48:51], v[136:139], v[88:91]
    ds_read_b64_tr_b16 v[68:69], v16 offset:15488
    ds_read_b64_tr_b16 v[70:71], v16 offset:18048
    buffer_load_dwordx4 v[136:139], v17, s[4:7], s37 offen offset:0 sc1
    s_barrier
    s_add_u32 s60, s44, 24576
    s_cmp_gt_u32 s60, 122880
    s_cselect_b32 s60, 0, s60
    s_sub_u32 s45, s60, s44
    s_mov_b32 s44, s60
    v_add_u32 v16, s45, v16
    s_waitcnt vmcnt(7)
    s_waitcnt lgkmcnt(8)
    v_mfma_f32_16x16x32_bf16 v[72:75], v[52:55], v[140:143], v[72:75]
    ds_read_b64_tr_b16 v[32:33], v16 offset:0
    ds_read_b64_tr_b16 v[34:35], v16 offset:2560
    s_waitcnt lgkmcnt(8)
    v_mfma_f32_16x16x32_bf16 v[76:79], v[56:59], v[140:143], v[76:79]
    ds_read_b64_tr_b16 v[36:37], v16 offset:32
    ds_read_b64_tr_b16 v[38:39], v16 offset:2592
    s_waitcnt lgkmcnt(8)
    v_mfma_f32_16x16x32_bf16 v[80:83], v[60:63], v[140:143], v[80:83]
    ds_read_b64_tr_b16 v[40:41], v16 offset:64
    ds_read_b64_tr_b16 v[42:43], v16 offset:2624
    s_waitcnt lgkmcnt(8)
    v_mfma_f32_16x16x32_bf16 v[84:87], v[64:67], v[140:143], v[84:87]
    ds_read_b64_tr_b16 v[44:45], v16 offset:96
    ds_read_b64_tr_b16 v[46:47], v16 offset:2656
    s_waitcnt lgkmcnt(8)
    v_mfma_f32_16x16x32_bf16 v[88:91], v[68:71], v[140:143], v[88:91]
    ds_read_b64_tr_b16 v[48:49], v16 offset:128
    ds_read_b64_tr_b16 v[50:51], v16 offset:2688
    buffer_load_dwordx4 v[140:143], v17, s[4:7], s37 offen offset:2048 sc1
    s_add_u32 s37, s37, 4096
    s_sub_u32 s51, s51, 1
    s_cmp_lg_u32 s51, 0
    s_cbranch_scc1 L_ch1_kernel_loop_6
    s_waitcnt  lgkmcnt(0)
    s_nop 7
    v_cvt_pk_bf16_f32 v92, v72, v73
    v_cvt_pk_bf16_f32 v93, v74, v75
    buffer_store_dwordx2 v[92:93], v28, s[16:19], s48 offen offset:0
    v_cvt_pk_bf16_f32 v94, v76, v77
    v_cvt_pk_bf16_f32 v95, v78, v79
    buffer_store_dwordx2 v[94:95], v28, s[16:19], s48 offen offset:32
    v_cvt_pk_bf16_f32 v96, v80, v81
    v_cvt_pk_bf16_f32 v97, v82, v83
    buffer_store_dwordx2 v[96:97], v28, s[16:19], s48 offen offset:64
    v_cvt_pk_bf16_f32 v98, v84, v85
    v_cvt_pk_bf16_f32 v99, v86, v87
    buffer_store_dwordx2 v[98:99], v28, s[16:19], s48 offen offset:96
    v_cvt_pk_bf16_f32 v100, v88, v89
    v_cvt_pk_bf16_f32 v101, v90, v91
    buffer_store_dwordx2 v[100:101], v28, s[16:19], s48 offen offset:128
    s_endpgm
L_ch1_kernel_end:
    s_endpgm
.section .rodata,"a"
.p2align 6
.amdhsa_kernel ch1_kernel
  .amdhsa_next_free_vgpr 240
  .amdhsa_next_free_sgpr 100
  .amdhsa_accum_offset 240
  .amdhsa_group_segment_fixed_size 0
  .amdhsa_kernarg_size 80
  .amdhsa_user_sgpr_count 2
  .amdhsa_user_sgpr_kernarg_segment_ptr 1
  .amdhsa_system_sgpr_workgroup_id_x 1
.end_amdhsa_kernel
.text
L_text_end:
    s_endpgm
```
